```python
import torch

def _softmax(x, axis=-1):
    return torch.softmax(x, dim=axis)

def _gelu(x):
    return torch.nn.functional.gelu(x, approximate='tanh')

def _silu(x):
    return torch.nn.functional.silu(x)

def _sigmoid(x):
    return torch.sigmoid(x)

def _layernorm(x, axis=-1, eps=1e-05):
    m = x.mean(dim=axis, keepdim=True)
    v = x.var(dim=axis, keepdim=True, unbiased=False)
    return (x - m) / torch.sqrt(v + eps)

def _scatter_add(tgt, idx, src, axis=0):
    return tgt.clone().index_add_(axis, idx, src)

def _segment_sum(src, seg, n):
    out = torch.zeros((n,) + src.shape[1:], dtype=src.dtype)
    return out.index_add_(0, seg, src)

def _pad(x, pw):
    flat = tuple((v for pair in reversed(pw) for v in pair))
    return torch.nn.functional.pad(x, flat)
kernel_name = 'parallel_sum__memory_aug_recurrent_mem_tr__glu_gated_bilinear__prompt'

def setup_inputs():

    _w = lambda a: (lambda t: t.to(torch.bfloat16) if t.is_floating_point() else t)(torch.as_tensor(a))

    def _A_setup():
        B, S, Dm = (1, 2048, 640)
        H, Dh = (32, 192)
        M, seg = (8, 32)
        seg = min(seg, S)
        S = S // seg * seg
        return {'x': _w((lambda *s: torch.randn(*s, dtype=torch.bfloat16) * 0.05)(B, S, Dm)), 'mem0': _w((lambda *s: torch.randn(*s, dtype=torch.bfloat16) * 0.2)(B, M, Dm)), 'Wq': _w((lambda *s: torch.randn(*s, dtype=torch.bfloat16) * 1.6)(Dm, H, Dh) * Dm ** (-0.5)), 'Wk': _w((lambda *s: torch.randn(*s, dtype=torch.bfloat16) * 1.6)(Dm, H, Dh) * Dm ** (-0.5)), 'Wv': _w((lambda *s: torch.randn(*s, dtype=torch.bfloat16) * 0.2)(Dm, H, Dh) * Dm ** (-0.5)), 'Wo': _w((lambda *s: torch.randn(*s, dtype=torch.bfloat16) * 0.2)(H, Dh, Dm) * (H * Dh) ** (-0.5)), 'seg_len': seg}
    _A_in = _A_setup()

    def _B_setup():
        B, S, D, F = (1, 2048, 640, 1536)
        return {'x': _w((lambda *s: torch.randn(*s, dtype=torch.bfloat16) * 0.05)(B, S, D)), 'w_gate': _w((lambda *s: torch.randn(*s, dtype=torch.bfloat16) * 0.2)(D, F) * D ** (-0.5)), 'w_up': _w((lambda *s: torch.randn(*s, dtype=torch.bfloat16) * 0.2)(D, F) * D ** (-0.5)), 'w_down': _w((lambda *s: torch.randn(*s, dtype=torch.bfloat16) * 0.2)(F, D) * F ** (-0.5))}
    _B_in = _B_setup()
    return {'A_x': _A_in['x'], 'A_mem0': _A_in['mem0'], 'A_Wq': _A_in['Wq'], 'A_Wk': _A_in['Wk'], 'A_Wv': _A_in['Wv'], 'A_Wo': _A_in['Wo'], 'A_seg_len': _A_in['seg_len'], 'B_x': _B_in['x'], 'B_w_gate': _B_in['w_gate'], 'B_w_up': _B_in['w_up'], 'B_w_down': _B_in['w_down']}

def reference(A_x, A_mem0, A_Wq, A_Wk, A_Wv, A_Wo, A_seg_len, B_x, B_w_gate, B_w_up, B_w_down):

    def _A_ref(x, mem0, Wq, Wk, Wv, Wo, seg_len):
        B, S, Dm = x.shape
        H, Dh = (Wq.shape[1], Wq.shape[2])
        M = mem0.shape[1]
        scale = Dh ** (-0.5)
        n_seg = S // seg_len
        L = M + seg_len
        idx = torch.arange(L)
        mask = (idx[:, None] < M) | (idx[:, None] >= idx[None, :])
        mem = mem0
        outs = []
        for s in range(n_seg):
            xs = x[:, s * seg_len:(s + 1) * seg_len, :].clone()
            h = torch.concatenate([mem, xs], axis=1)
            q = torch.einsum('btd,dhe->bhte', h, Wq)
            k = torch.einsum('btd,dhe->bhte', h, Wk)
            v = torch.einsum('btd,dhe->bhte', h, Wv)
            scores = torch.einsum('bhqe,bhke->bhqk', q, k) * scale
            scores = torch.where(mask[None, None], scores, -1000000000.0)
            p = _softmax(scores, axis=-1)
            o = torch.einsum('bhqk,bhke->bhqe', p, v)
            o = torch.einsum('bhte,hed->btd', o, Wo)
            mem = o[:, :M, :].clone()
            outs.append(o[:, M:, :])
        return torch.concatenate(outs, axis=1)

    def _B_ref(x, w_gate, w_up, w_down):
        g = torch.einsum('bsd,df->bsf', x, w_gate)
        u = torch.einsum('bsd,df->bsf', x, w_up)
        h = g * u
        return torch.einsum('bsf,fd->bsd', h, w_down)
    x = A_x
    xn = _layernorm(x, axis=-1)
    return x + _A_ref(xn, A_mem0, A_Wq, A_Wk, A_Wv, A_Wo, A_seg_len) + _B_ref(xn, B_w_gate, B_w_up, B_w_down)
```

```asm
; @launch grid=(256,1,1) block=(512,1,1) lds=163840
.amdgcn_target "amdgcn-amd-amdhsa--gfx950"
.text
.globl parallel_sum__memory_aug_recurrent_mem_tr__glu_gated_bilinear__prompt_kernel
.p2align 8
.type parallel_sum__memory_aug_recurrent_mem_tr__glu_gated_bilinear__prompt_kernel,@function
parallel_sum__memory_aug_recurrent_mem_tr__glu_gated_bilinear__prompt_kernel:
  s_cmp_lt_u32 s2, 256
  s_cbranch_scc0 Lexit
  s_load_dwordx2 s[4:5], s[0:1], 104
  s_load_dwordx2 s[80:81], s[0:1], 96
  s_mov_b32 s6, 0x10000000
  s_mov_b32 s7, 0x20000
  s_mov_b32 s82, 256
  s_mov_b32 s83, 0x20000
  v_lshrrev_b32 v2, 6, v0
  s_nop 0
  v_readfirstlane_b32 s20, v2
  s_getreg_b32 s3, hwreg(HW_REG_XCC_ID, 0, 3)
  s_sub_u32 s46, s3, s2
  s_and_b32 s46, s46, 7
  s_lshl_b32 s38, s20, 3
  s_or_b32 s38, s38, s2
  s_cmp_lt_u32 s38, 8
  s_waitcnt lgkmcnt(0)
  s_cbranch_scc0 Ltop
  s_add_u32 s38, s46, 1
  v_mov_b32 v2, s38
  v_mov_b32 v3, 0
  s_mov_b64 exec, 1
  buffer_atomic_cmpswap v[2:3], off, s[80:83], 0
  s_mov_b64 exec, -1
  s_branch Ltop
Lrestart:
  s_cmp_lt_u32 s38, 8
  s_cbranch_scc0 Lexit
  s_mov_b32 s46, s38
  s_waitcnt vmcnt(0) lgkmcnt(0)
  s_barrier
Ltop:
  s_add_u32 s16, s2, s46
  s_and_b32 s16, s16, 7
  s_lshr_b32 s17, s2, 3
  s_cmp_lg_u32 s3, s16
  s_cselect_b32 s47, 1, 0
  s_cmp_lt_u32 s16, 4
  s_cbranch_scc1 Lrec
  s_sub_u32 s16, s16, 4
  v_lshrrev_b32 v2, 6, v0
  v_and_b32 v1, 63, v0
  v_readfirstlane_b32 s20, v2
  v_lshlrev_b32 v2, 4, v1
  s_mov_b32 s24, 200000
  s_cmp_lt_u32 s17, 12
  s_cbranch_scc1 Lw_kv
  s_cmp_lt_u32 s17, 20
  s_cbranch_scc1 Lw_qa
  s_cmp_lt_u32 s17, 31
  s_cbranch_scc0 Lw_red
  v_mov_b32 v11, 163832
  s_cmp_eq_u32 s20, 0
  s_cbranch_scc0 Lcx_3
  s_mov_b32 s39, 200000
Lcr_1:
  s_sleep 64
  buffer_load_dword v10, off, s[80:83], 0 sc1
  s_waitcnt vmcnt(0)
Lcq_2:
  s_sub_u32 s39, s39, 1
  s_cbranch_scc1 Lcd_4
  v_cmp_eq_u32 vcc, 0, v10
  s_cbranch_vccnz Lcr_1
Lcd_4:
  ds_write_b32 v11, v10
  s_waitcnt lgkmcnt(0)
Lcx_3:
  s_barrier
  ds_read_b32 v10, v11
  s_waitcnt lgkmcnt(0)
  v_readfirstlane_b32 s38, v10
  s_sub_u32 s38, s38, 1
  s_cmp_eq_u32 s38, s46
  s_cbranch_scc0 Lrestart
  s_cmp_lt_u32 s17, 23
  s_cbranch_scc1 Lw_glu
  s_branch Lw_fin
Lw_red:
  v_mov_b32 v11, 163832
  s_cmp_eq_u32 s20, 0
  s_cbranch_scc0 Lcx_7
  s_mov_b32 s39, 200000
Lcr_5:
  buffer_load_dword v10, off, s[80:83], 0 sc1
  s_waitcnt vmcnt(0)
Lcq_6:
  s_sub_u32 s39, s39, 1
  s_cbranch_scc1 Lcd_8
  v_cmp_eq_u32 vcc, 0, v10
  s_cbranch_vccnz Lcr_5
Lcd_8:
  ds_write_b32 v11, v10
  s_waitcnt lgkmcnt(0)
Lcx_7:
  s_barrier
  ds_read_b32 v10, v11
  s_waitcnt lgkmcnt(0)
  v_readfirstlane_b32 s38, v10
  s_sub_u32 s38, s38, 1
  s_cmp_eq_u32 s38, s46
  s_cbranch_scc0 Lrestart
  s_load_dwordx2 s[8:9], s[0:1], 0
  s_mov_b32 s10, 2621440
  s_mov_b32 s11, 0x20000
  s_load_dwordx2 s[12:13], s[0:1], 88
  s_mov_b32 s14, 2621440
  s_mov_b32 s15, 0x20000
  v_lshlrev_b32 v17, 4, v0
  s_lshl_b32 s38, s16, 14
  s_add_u32 s38, s38, 1835008
  s_add_u32 s39, s38, 8192
  v_mov_b32 v18, 0
  v_mov_b32 v19, 0
  v_mov_b32 v20, 0
  v_mov_b32 v21, 0
  buffer_store_dwordx4 v[18:21], v17, s[4:7], s38 offen sc1
  buffer_store_dwordx4 v[18:21], v17, s[4:7], s39 offen sc1
  s_waitcnt vmcnt(0)
  s_barrier
  s_cmp_eq_u32 s20, 0
  s_cbranch_scc0 Lw_r1
  v_mov_b32 v12, 1
  v_mov_b32 v13, 128
  s_mov_b64 exec, 1
  buffer_atomic_add v12, v13, s[80:83], 0 offen
  s_mov_b64 exec, -1
Lw_r1:
  s_cmp_eq_u32 s20, 0
  s_cbranch_scc0 Lw0_9
Lp_10:
  buffer_load_ubyte v10, off, s[80:83], 0 offset:128 sc1
  s_waitcnt vmcnt(0)
  v_cmp_gt_u32 vcc, 36, v10
  s_cbranch_vccz Lpd_11
  s_sleep 4
  s_sub_u32 s24, s24, 1
  s_cbranch_scc0 Lp_10
  s_branch Lw_fail
Lpd_11:
Lw0_9:
  s_barrier
  s_mov_b32 s22, 0
  s_mov_b32 s27, 44
  s_branch Lw_r2
Lw_rhelp:
  s_cmp_lt_u32 s20, 2
  s_cbranch_scc0 Lw_end
  s_setprio 0
  s_sub_u32 s38, s17, 8
  s_lshl_b32 s38, s38, 1
  s_add_u32 s20, s20, s38
  s_mov_b32 s22, 44
  s_mov_b32 s27, 64
  s_load_dwordx2 s[8:9], s[0:1], 0
  s_mov_b32 s10, 2621440
  s_mov_b32 s11, 0x20000
  s_load_dwordx2 s[12:13], s[0:1], 88
  s_mov_b32 s14, 2621440
  s_mov_b32 s15, 0x20000
Lw_r2:
  s_lshl_b32 s38, s20, 11
  s_add_u32 s38, s38, 1863168
  v_and_b32 v3, 15, v1
  v_lshl_add_u32 v3, v3, 7, s38
  s_lshr_b32 s39, s16, 1
  s_lshl_b32 s39, s39, 7
  s_add_u32 s38, s38, s39
  s_add_u32 s38, s38, 32
  v_bfe_u32 v8, v1, 3, 2
  v_lshl_add_u32 v6, v8, 9, s38
  v_and_b32 v8, 7, v1
  v_lshl_add_u32 v6, v8, 2, v6
  v_lshrrev_b32 v8, 5, v1
  v_lshlrev_b32 v4, 10, v8
  v_lshl_add_u32 v4, v1, 3, v4
  v_mul_u32_u24 v5, 20, v8
  v_bfe_u32 v8, v1, 3, 2
  v_mad_u32_u24 v5, v8, 40, v5
  v_and_b32 v8, 7, v1
  v_mul_u32_u24 v8, 1280, v8
  v_add_u32 v5, v5, v8
  s_mul_i32 s25, s16, 40960
  s_mul_i32 s38, s20, 5120
  s_add_u32 s25, s25, s38
  s_add_u32 s25, s25, 99614720
  s_mul_i32 s26, s16, 10240
  s_mul_i32 s38, s20, 160
  s_add_u32 s26, s26, s38
  s_mul_i32 s38, s22, 163840
  s_add_u32 s25, s25, s38
  s_mul_i32 s38, s22, 40960
  s_add_u32 s26, s26, s38
  s_cmp_eq_u32 s22, 0
  s_cselect_b64 vcc, -1, 0
  v_cndmask_b32 v3, v6, v3, vcc
  s_waitcnt lgkmcnt(0)
  buffer_load_dwordx4 v[56:59], v5, s[8:11], s26 offen
  buffer_load_dword v60, v5, s[8:11], s26 offen offset:16
  v_mov_b32 v9, 0
Lw_rloop:
  s_cmp_ge_u32 s22, 59
  s_cbranch_scc1 Lw_rgo
  v_cmp_ge_u32 vcc, s22, v9
  s_cbranch_vccz Lw_rgo
Lp_12:
  buffer_load_dword v9, v3, s[4:7], 0 offen sc1
  s_waitcnt vmcnt(0)
  v_cmp_ge_u32 vcc, s22, v9
  s_cbranch_vccz Lpd_13
  s_sleep 1
  s_sub_u32 s24, s24, 1
  s_cbranch_scc0 Lp_12
  s_branch Lw_fail
Lpd_13:
Lw_rgo:
  buffer_load_dwordx2 v[80:81], v4, s[4:7], s25 offen offset:0 sc1
  buffer_load_dwordx2 v[82:83], v4, s[4:7], s25 offen offset:2560 sc1
  buffer_load_dwordx2 v[84:85], v4, s[4:7], s25 offen offset:256 sc1
  buffer_load_dwordx2 v[86:87], v4, s[4:7], s25 offen offset:2816 sc1
  buffer_load_dwordx2 v[88:89], v4, s[4:7], s25 offen offset:512 sc1
  buffer_load_dwordx2 v[90:91], v4, s[4:7], s25 offen offset:3072 sc1
  buffer_load_dwordx2 v[92:93], v4, s[4:7], s25 offen offset:768 sc1
  buffer_load_dwordx2 v[94:95], v4, s[4:7], s25 offen offset:3328 sc1
  buffer_load_dwordx2 v[96:97], v4, s[4:7], s25 offen offset:1024 sc1
  buffer_load_dwordx2 v[98:99], v4, s[4:7], s25 offen offset:3584 sc1
  s_cmp_ge_u32 s22, 59
  s_cbranch_scc0 Lw_rnt
  s_waitcnt vmcnt(0)
  v_max3_u32 v8, v80, v82, v84
  v_max3_u32 v8, v8, v86, v88
  v_max3_u32 v8, v8, v90, v92
  v_max3_u32 v8, v8, v94, v96
  v_max3_u32 v8, v8, v98, v98
  v_cmp_eq_u32 vcc, -1, v8
  s_cbranch_vccz Lrd_14
  s_sub_u32 s24, s24, 1
  s_cbranch_scc0 Lw_rgo
  s_branch Lw_fail
Lrd_14:
Lw_rnt:
  v_lshlrev_b32 v62, 16, v56
  v_and_b32 v63, 0xffff0000, v56
  v_lshlrev_b32 v64, 16, v57
  v_and_b32 v65, 0xffff0000, v57
  v_lshlrev_b32 v66, 16, v58
  v_and_b32 v67, 0xffff0000, v58
  v_lshlrev_b32 v68, 16, v59
  v_and_b32 v69, 0xffff0000, v59
  v_lshlrev_b32 v70, 16, v60
  v_and_b32 v71, 0xffff0000, v60
  s_add_u32 s39, s26, 40960
  buffer_load_dword v9, v3, s[4:7], 0 offen sc1
  buffer_load_dwordx4 v[56:59], v5, s[8:11], s39 offen
  buffer_load_dword v60, v5, s[8:11], s39 offen offset:16
  s_waitcnt vmcnt(11)
  v_lshlrev_b32 v16, 16, v80
  v_and_b32 v17, 0xffff0000, v80
  v_lshlrev_b32 v36, 16, v82
  v_and_b32 v37, 0xffff0000, v82
  v_pk_add_f32 v[16:17], v[16:17], v[36:37]
  v_lshlrev_b32 v18, 16, v81
  v_and_b32 v19, 0xffff0000, v81
  v_lshlrev_b32 v38, 16, v83
  v_and_b32 v39, 0xffff0000, v83
  v_pk_add_f32 v[18:19], v[18:19], v[38:39]
  s_waitcnt vmcnt(9)
  v_lshlrev_b32 v20, 16, v84
  v_and_b32 v21, 0xffff0000, v84
  v_lshlrev_b32 v40, 16, v86
  v_and_b32 v41, 0xffff0000, v86
  v_pk_add_f32 v[20:21], v[20:21], v[40:41]
  v_lshlrev_b32 v22, 16, v85
  v_and_b32 v23, 0xffff0000, v85
  v_lshlrev_b32 v42, 16, v87
  v_and_b32 v43, 0xffff0000, v87
  v_pk_add_f32 v[22:23], v[22:23], v[42:43]
  s_waitcnt vmcnt(7)
  v_lshlrev_b32 v24, 16, v88
  v_and_b32 v25, 0xffff0000, v88
  v_lshlrev_b32 v44, 16, v90
  v_and_b32 v45, 0xffff0000, v90
  v_pk_add_f32 v[24:25], v[24:25], v[44:45]
  v_lshlrev_b32 v26, 16, v89
  v_and_b32 v27, 0xffff0000, v89
  v_lshlrev_b32 v46, 16, v91
  v_and_b32 v47, 0xffff0000, v91
  v_pk_add_f32 v[26:27], v[26:27], v[46:47]
  s_waitcnt vmcnt(5)
  v_lshlrev_b32 v28, 16, v92
  v_and_b32 v29, 0xffff0000, v92
  v_lshlrev_b32 v48, 16, v94
  v_and_b32 v49, 0xffff0000, v94
  v_pk_add_f32 v[28:29], v[28:29], v[48:49]
  v_lshlrev_b32 v30, 16, v93
  v_and_b32 v31, 0xffff0000, v93
  v_lshlrev_b32 v50, 16, v95
  v_and_b32 v51, 0xffff0000, v95
  v_pk_add_f32 v[30:31], v[30:31], v[50:51]
  s_waitcnt vmcnt(3)
  v_lshlrev_b32 v32, 16, v96
  v_and_b32 v33, 0xffff0000, v96
  v_lshlrev_b32 v52, 16, v98
  v_and_b32 v53, 0xffff0000, v98
  v_pk_add_f32 v[32:33], v[32:33], v[52:53]
  v_lshlrev_b32 v34, 16, v97
  v_and_b32 v35, 0xffff0000, v97
  v_lshlrev_b32 v54, 16, v99
  v_and_b32 v55, 0xffff0000, v99
  v_pk_add_f32 v[34:35], v[34:35], v[54:55]
  v_permlane32_swap_b32 v16, v26
  v_permlane32_swap_b32 v17, v27
  v_permlane32_swap_b32 v18, v28
  v_permlane32_swap_b32 v19, v29
  v_permlane32_swap_b32 v20, v30
  v_permlane32_swap_b32 v21, v31
  v_permlane32_swap_b32 v22, v32
  v_permlane32_swap_b32 v23, v33
  v_permlane32_swap_b32 v24, v34
  v_permlane32_swap_b32 v25, v35
  v_pk_add_f32 v[16:17], v[16:17], v[26:27]
  v_pk_add_f32 v[18:19], v[18:19], v[28:29]
  v_pk_add_f32 v[20:21], v[20:21], v[30:31]
  v_pk_add_f32 v[22:23], v[22:23], v[32:33]
  v_pk_add_f32 v[24:25], v[24:25], v[34:35]
  v_pk_add_f32 v[16:17], v[16:17], v[62:63]
  v_pk_add_f32 v[18:19], v[18:19], v[64:65]
  v_pk_add_f32 v[20:21], v[20:21], v[66:67]
  v_pk_add_f32 v[22:23], v[22:23], v[68:69]
  v_pk_add_f32 v[24:25], v[24:25], v[70:71]
  v_cvt_pk_bf16_f32 v72, v16, v17
  v_cvt_pk_bf16_f32 v73, v18, v19
  v_cvt_pk_bf16_f32 v74, v20, v21
  v_cvt_pk_bf16_f32 v75, v22, v23
  v_cvt_pk_bf16_f32 v76, v24, v25
  buffer_store_dwordx4 v[72:75], v5, s[12:15], s26 offen nt
  buffer_store_dword v76, v5, s[12:15], s26 offen offset:16 nt
  s_add_u32 s25, s25, 163840
  s_add_u32 s26, s26, 40960
  s_add_u32 s22, s22, 1
  s_cmp_lt_u32 s22, s27
  s_waitcnt vmcnt(2)
  s_cbranch_scc1 Lw_rloop
  s_branch Lw_end
Lw_kv:
  s_load_dwordx4 s[84:87], s[0:1], 24
  s_mov_b32 s10, 7864320
  s_mov_b32 s11, 0x20000
  s_cmp_ge_u32 s17, 6
  s_cselect_b32 s37, 6, 0
  s_waitcnt lgkmcnt(0)
  s_cselect_b32 s8, s86, s84
  s_cselect_b32 s9, s87, s85
  s_sub_u32 s18, s17, s37
  s_mul_i32 s34, s16, 3072
  s_lshl_b32 s38, s18, 9
  s_add_u32 s34, s34, s38
  v_lshrrev_b32 v4, 4, v1
  s_lshr_b32 s38, s20, 1
  s_and_b32 s38, s38, 1
  s_lshl_b32 s38, s38, 2
  v_or_b32 v5, s38, v4
  v_lshlrev_b32 v5, 1, v5
  v_and_b32 v6, 15, v1
  v_xor_b32 v5, v5, v6
  s_lshl_b32 s38, s20, 2
  v_add_u32 v4, s38, v4
  v_mul_u32_u24 v4, 12288, v4
  v_lshl_add_u32 v3, v5, 4, v4
  v_cmp_gt_u32 s[42:43], 8, v5
  s_lshl_b32 s35, s20, 10
  s_add_u32 s38, s34, 0
  s_add_u32 m0, s35, 0
  s_nop 0
  buffer_load_dwordx4 v3, s[8:11], s38 offen lds
  s_add_u32 s38, s38, 256
  s_add_u32 m0, s35, 8192
  s_nop 0
  buffer_load_dwordx4 v3, s[8:11], s38 offen lds
  s_add_u32 s38, s34, 393216
  s_add_u32 m0, s35, 16384
  s_nop 0
  buffer_load_dwordx4 v3, s[8:11], s38 offen lds
  s_add_u32 s38, s38, 256
  s_add_u32 m0, s35, 24576
  s_nop 0
  buffer_load_dwordx4 v3, s[8:11], s38 offen lds
  s_add_u32 s38, s34, 786432
  s_add_u32 m0, s35, 32768
  s_nop 0
  buffer_load_dwordx4 v3, s[8:11], s38 offen lds
  s_add_u32 s38, s38, 256
  s_add_u32 m0, s35, 40960
  s_nop 0
  buffer_load_dwordx4 v3, s[8:11], s38 offen lds
  s_add_u32 s38, s34, 1179648
  s_add_u32 m0, s35, 49152
  s_nop 0
  buffer_load_dwordx4 v3, s[8:11], s38 offen lds
  s_add_u32 s38, s38, 256
  s_add_u32 m0, s35, 57344
  s_nop 0
  buffer_load_dwordx4 v3, s[8:11], s38 offen lds
  s_add_u32 s38, s34, 1572864
  s_add_u32 m0, s35, 65536
  s_nop 0
  buffer_load_dwordx4 v3, s[8:11], s38 offen lds
  s_add_u32 s38, s38, 256
  s_add_u32 m0, s35, 73728
  s_nop 0
  buffer_load_dwordx4 v3, s[8:11], s38 offen lds
  s_add_u32 s38, s34, 1966080
  s_add_u32 m0, s35, 81920
  s_nop 0
  buffer_load_dwordx4 v3, s[8:11], s38 offen lds
  s_add_u32 s38, s38, 256
  s_add_u32 m0, s35, 90112
  s_nop 0
  buffer_load_dwordx4 v3, s[8:11], s38 offen lds
  s_add_u32 s38, s34, 2359296
  s_add_u32 m0, s35, 98304
  s_nop 0
  buffer_load_dwordx4 v3, s[8:11], s38 offen lds
  s_add_u32 s38, s38, 256
  s_add_u32 m0, s35, 106496
  s_nop 0
  buffer_load_dwordx4 v3, s[8:11], s38 offen lds
  s_add_u32 s38, s34, 2752512
  s_add_u32 m0, s35, 114688
  s_nop 0
  buffer_load_dwordx4 v3, s[8:11], s38 offen lds
  s_add_u32 s38, s38, 256
  s_add_u32 m0, s35, 122880
  s_nop 0
  buffer_load_dwordx4 v3, s[8:11], s38 offen lds
  v_bfe_u32 v6, v1, 4, 2
  v_lshlrev_b32 v6, 11, v6
  v_bfe_u32 v8, v1, 2, 2
  v_lshl_add_u32 v6, v8, 8, v6
  v_bfe_u32 v8, v1, 2, 3
  s_and_b32 s38, s20, 3
  s_lshl_b32 s38, s38, 1
  v_xor_b32 v8, s38, v8
  v_lshl_add_u32 v6, v8, 5, v6
  v_and_b32 v9, 3, v1
  v_lshl_add_u32 v6, v9, 3, v6
  s_lshr_b32 s38, s20, 2
  s_lshl_b32 s38, s38, 13
  v_add_u32 v6, s38, v6
  v_xor_b32 v7, 32, v6
  s_waitcnt vmcnt(8)
  s_barrier
  ds_read_b64_tr_b16 v[96:97], v6 offset:0
  ds_read_b64_tr_b16 v[98:99], v6 offset:1024
  ds_read_b64_tr_b16 v[176:177], v7 offset:0
  ds_read_b64_tr_b16 v[178:179], v7 offset:1024
  ds_read_b64_tr_b16 v[100:101], v6 offset:16384
  ds_read_b64_tr_b16 v[102:103], v6 offset:17408
  ds_read_b64_tr_b16 v[180:181], v7 offset:16384
  ds_read_b64_tr_b16 v[182:183], v7 offset:17408
  ds_read_b64_tr_b16 v[104:105], v6 offset:32768
  ds_read_b64_tr_b16 v[106:107], v6 offset:33792
  ds_read_b64_tr_b16 v[184:185], v7 offset:32768
  ds_read_b64_tr_b16 v[186:187], v7 offset:33792
  ds_read_b64_tr_b16 v[108:109], v6 offset:49152
  ds_read_b64_tr_b16 v[110:111], v6 offset:50176
  ds_read_b64_tr_b16 v[188:189], v7 offset:49152
  ds_read_b64_tr_b16 v[190:191], v7 offset:50176
  v_xor_b32 v6, 0x10000, v6
  v_xor_b32 v7, 0x10000, v7
  s_waitcnt lgkmcnt(0)
  s_barrier
  s_cmp_eq_u32 s20, 0
  s_cbranch_scc0 Lw_knr
  buffer_load_dword v10, off, s[80:83], 0 sc1
Lw_knr:
  s_add_u32 s38, s34, 3145728
  s_add_u32 m0, s35, 0
  s_nop 0
  buffer_load_dwordx4 v3, s[8:11], s38 offen lds
  s_add_u32 s38, s38, 256
  s_add_u32 m0, s35, 8192
  s_nop 0
  buffer_load_dwordx4 v3, s[8:11], s38 offen lds
  s_add_u32 s38, s34, 3538944
  s_add_u32 m0, s35, 16384
  s_nop 0
  buffer_load_dwordx4 v3, s[8:11], s38 offen lds
  s_add_u32 s38, s38, 256
  s_add_u32 m0, s35, 24576
  s_nop 0
  buffer_load_dwordx4 v3, s[8:11], s38 offen lds
  s_add_u32 s38, s34, 3932160
  s_add_u32 m0, s35, 32768
  s_nop 0
  buffer_load_dwordx4 v3, s[8:11], s38 offen lds
  s_add_u32 s38, s38, 256
  s_add_u32 m0, s35, 40960
  s_nop 0
  buffer_load_dwordx4 v3, s[8:11], s38 offen lds
  s_add_u32 s38, s34, 4325376
  s_add_u32 m0, s35, 49152
  s_nop 0
  buffer_load_dwordx4 v3, s[8:11], s38 offen lds
  s_add_u32 s38, s38, 256
  s_add_u32 m0, s35, 57344
  s_nop 0
  buffer_load_dwordx4 v3, s[8:11], s38 offen lds
  s_waitcnt vmcnt(8)
  v_mov_b32 v11, 163832
  s_cmp_eq_u32 s20, 0
  s_cbranch_scc0 Lcx_17
  s_mov_b32 s39, 200000
  s_branch Lcq_16
Lcr_15:
  buffer_load_dword v10, off, s[80:83], 0 sc1
  s_waitcnt vmcnt(0)
Lcq_16:
  s_sub_u32 s39, s39, 1
  s_cbranch_scc1 Lcd_18
  v_cmp_eq_u32 vcc, 0, v10
  s_cbranch_vccnz Lcr_15
Lcd_18:
  ds_write_b32 v11, v10
  s_waitcnt lgkmcnt(0)
Lcx_17:
  s_barrier
  ds_read_b32 v10, v11
  s_waitcnt lgkmcnt(0)
  v_readfirstlane_b32 s38, v10
  s_sub_u32 s38, s38, 1
  s_cmp_eq_u32 s38, s46
  s_cbranch_scc0 Lrestart
  ds_read_b64_tr_b16 v[112:113], v6 offset:0
  ds_read_b64_tr_b16 v[114:115], v6 offset:1024
  ds_read_b64_tr_b16 v[192:193], v7 offset:0
  ds_read_b64_tr_b16 v[194:195], v7 offset:1024
  ds_read_b64_tr_b16 v[116:117], v6 offset:16384
  ds_read_b64_tr_b16 v[118:119], v6 offset:17408
  ds_read_b64_tr_b16 v[196:197], v7 offset:16384
  ds_read_b64_tr_b16 v[198:199], v7 offset:17408
  ds_read_b64_tr_b16 v[120:121], v6 offset:32768
  ds_read_b64_tr_b16 v[122:123], v6 offset:33792
  ds_read_b64_tr_b16 v[200:201], v7 offset:32768
  ds_read_b64_tr_b16 v[202:203], v7 offset:33792
  ds_read_b64_tr_b16 v[124:125], v6 offset:49152
  ds_read_b64_tr_b16 v[126:127], v6 offset:50176
  ds_read_b64_tr_b16 v[204:205], v7 offset:49152
  ds_read_b64_tr_b16 v[206:207], v7 offset:50176
  v_xor_b32 v6, 0x10000, v6
  v_xor_b32 v7, 0x10000, v7
  s_waitcnt lgkmcnt(0)
  s_barrier
  s_add_u32 s38, s34, 4718592
  s_add_u32 m0, s35, 65536
  s_nop 0
  buffer_load_dwordx4 v3, s[8:11], s38 offen lds
  s_add_u32 s38, s38, 256
  s_add_u32 m0, s35, 73728
  s_nop 0
  buffer_load_dwordx4 v3, s[8:11], s38 offen lds
  s_add_u32 s38, s34, 5111808
  s_add_u32 m0, s35, 81920
  s_nop 0
  buffer_load_dwordx4 v3, s[8:11], s38 offen lds
  s_add_u32 s38, s38, 256
  s_add_u32 m0, s35, 90112
  s_nop 0
  buffer_load_dwordx4 v3, s[8:11], s38 offen lds
  s_add_u32 s38, s34, 5505024
  s_add_u32 m0, s35, 98304
  s_nop 0
  buffer_load_dwordx4 v3, s[8:11], s38 offen lds
  s_add_u32 s38, s38, 256
  s_add_u32 m0, s35, 106496
  s_nop 0
  buffer_load_dwordx4 v3, s[8:11], s38 offen lds
  s_add_u32 s38, s34, 5898240
  s_add_u32 m0, s35, 114688
  s_nop 0
  buffer_load_dwordx4 v3, s[8:11], s38 offen lds
  s_add_u32 s38, s38, 256
  s_add_u32 m0, s35, 122880
  s_nop 0
  buffer_load_dwordx4 v3, s[8:11], s38 offen lds
  s_waitcnt vmcnt(8)
  s_barrier
  ds_read_b64_tr_b16 v[128:129], v6 offset:0
  ds_read_b64_tr_b16 v[130:131], v6 offset:1024
  ds_read_b64_tr_b16 v[208:209], v7 offset:0
  ds_read_b64_tr_b16 v[210:211], v7 offset:1024
  ds_read_b64_tr_b16 v[132:133], v6 offset:16384
  ds_read_b64_tr_b16 v[134:135], v6 offset:17408
  ds_read_b64_tr_b16 v[212:213], v7 offset:16384
  ds_read_b64_tr_b16 v[214:215], v7 offset:17408
  ds_read_b64_tr_b16 v[136:137], v6 offset:32768
  ds_read_b64_tr_b16 v[138:139], v6 offset:33792
  ds_read_b64_tr_b16 v[216:217], v7 offset:32768
  ds_read_b64_tr_b16 v[218:219], v7 offset:33792
  ds_read_b64_tr_b16 v[140:141], v6 offset:49152
  ds_read_b64_tr_b16 v[142:143], v6 offset:50176
  ds_read_b64_tr_b16 v[220:221], v7 offset:49152
  ds_read_b64_tr_b16 v[222:223], v7 offset:50176
  v_xor_b32 v6, 0x10000, v6
  v_xor_b32 v7, 0x10000, v7
  s_waitcnt lgkmcnt(0)
  s_barrier
  buffer_load_ubyte v10, off, s[80:83], 0 offset:128 sc1
  s_add_u32 s38, s34, 6291456
  s_add_u32 m0, s35, 0
  s_nop 0
  buffer_load_dwordx4 v3, s[8:11], s38 offen lds
  s_add_u32 s38, s38, 256
  s_add_u32 m0, s35, 8192
  s_nop 0
  buffer_load_dwordx4 v3, s[8:11], s38 offen lds
  s_add_u32 s38, s34, 6684672
  s_add_u32 m0, s35, 16384
  s_nop 0
  buffer_load_dwordx4 v3, s[8:11], s38 offen lds
  s_add_u32 s38, s38, 256
  s_add_u32 m0, s35, 24576
  s_nop 0
  buffer_load_dwordx4 v3, s[8:11], s38 offen lds
  s_add_u32 s38, s34, 7077888
  s_add_u32 m0, s35, 32768
  s_nop 0
  buffer_load_dwordx4 v3, s[8:11], s38 offen lds
  s_add_u32 s38, s38, 256
  s_add_u32 m0, s35, 40960
  s_nop 0
  buffer_load_dwordx4 v3, s[8:11], s38 offen lds
  s_add_u32 s38, s34, 7471104
  s_add_u32 m0, s35, 49152
  s_nop 0
  buffer_load_dwordx4 v3, s[8:11], s38 offen lds
  s_add_u32 s38, s38, 256
  s_add_u32 m0, s35, 57344
  s_nop 0
  buffer_load_dwordx4 v3, s[8:11], s38 offen lds
  s_waitcnt vmcnt(8)
  s_barrier
  ds_read_b64_tr_b16 v[144:145], v6 offset:0
  ds_read_b64_tr_b16 v[146:147], v6 offset:1024
  ds_read_b64_tr_b16 v[224:225], v7 offset:0
  ds_read_b64_tr_b16 v[226:227], v7 offset:1024
  ds_read_b64_tr_b16 v[148:149], v6 offset:16384
  ds_read_b64_tr_b16 v[150:151], v6 offset:17408
  ds_read_b64_tr_b16 v[228:229], v7 offset:16384
  ds_read_b64_tr_b16 v[230:231], v7 offset:17408
  ds_read_b64_tr_b16 v[152:153], v6 offset:32768
  ds_read_b64_tr_b16 v[154:155], v6 offset:33792
  ds_read_b64_tr_b16 v[232:233], v7 offset:32768
  ds_read_b64_tr_b16 v[234:235], v7 offset:33792
  ds_read_b64_tr_b16 v[156:157], v6 offset:49152
  ds_read_b64_tr_b16 v[158:159], v6 offset:50176
  ds_read_b64_tr_b16 v[236:237], v7 offset:49152
  ds_read_b64_tr_b16 v[238:239], v7 offset:50176
  v_xor_b32 v6, 0x10000, v6
  v_xor_b32 v7, 0x10000, v7
  s_waitcnt lgkmcnt(0)
  s_mul_i32 s35, s20, 10240
  s_add_u32 s28, s35, 14680064
  s_mov_b32 s30, 81920
  s_mov_b32 s31, 122880
  s_mov_b32 s32, 0
  s_barrier
  v_cmp_le_u32 vcc, 36, v10
  s_cmp_lt_u32 s20, 4
  s_cselect_b64 s[44:45], vcc, 0
  s_cmp_eq_u64 s[44:45], 0
  s_cbranch_scc1 Lw_kl
  s_add_u32 m0, s30, s35
  s_add_u32 s38, s28, 4096
  s_add_u32 s39, s28, 8192
  buffer_load_dwordx4 v2, s[4:7], s28 offen offset:0 sc1 lds
  buffer_load_dwordx4 v2, s[4:7], s28 offen offset:1024 sc1 lds
  buffer_load_dwordx4 v2, s[4:7], s28 offen offset:2048 sc1 lds
  buffer_load_dwordx4 v2, s[4:7], s28 offen offset:3072 sc1 lds
  s_add_u32 m0, m0, 4096
  s_nop 0
  buffer_load_dwordx4 v2, s[4:7], s38 offen offset:0 sc1 lds
  buffer_load_dwordx4 v2, s[4:7], s38 offen offset:1024 sc1 lds
  buffer_load_dwordx4 v2, s[4:7], s38 offen offset:2048 sc1 lds
  buffer_load_dwordx4 v2, s[4:7], s38 offen offset:3072 sc1 lds
  s_add_u32 m0, m0, 4096
  s_nop 0
  buffer_load_dwordx4 v2, s[4:7], s39 offen offset:0 sc1 lds
  buffer_load_dwordx4 v2, s[4:7], s39 offen offset:1024 sc1 lds
  s_add_u32 s28, s28, 40960
  s_add_u32 m0, s31, s35
  s_add_u32 s38, s28, 4096
  s_add_u32 s39, s28, 8192
  buffer_load_dwordx4 v2, s[4:7], s28 offen offset:0 sc1 lds
  buffer_load_dwordx4 v2, s[4:7], s28 offen offset:1024 sc1 lds
  buffer_load_dwordx4 v2, s[4:7], s28 offen offset:2048 sc1 lds
  buffer_load_dwordx4 v2, s[4:7], s28 offen offset:3072 sc1 lds
  s_add_u32 m0, m0, 4096
  s_nop 0
  buffer_load_dwordx4 v2, s[4:7], s38 offen offset:0 sc1 lds
  buffer_load_dwordx4 v2, s[4:7], s38 offen offset:1024 sc1 lds
  buffer_load_dwordx4 v2, s[4:7], s38 offen offset:2048 sc1 lds
  buffer_load_dwordx4 v2, s[4:7], s38 offen offset:3072 sc1 lds
  s_add_u32 m0, m0, 4096
  s_nop 0
  buffer_load_dwordx4 v2, s[4:7], s39 offen offset:0 sc1 lds
  buffer_load_dwordx4 v2, s[4:7], s39 offen offset:1024 sc1 lds
  s_add_u32 s28, s28, 40960
  s_waitcnt vmcnt(20)
  s_branch Lw_km
Lw_kl:
  s_waitcnt vmcnt(0)
Lw_km:
  s_barrier
  ds_read_b64_tr_b16 v[160:161], v6 offset:0
  ds_read_b64_tr_b16 v[162:163], v6 offset:1024
  ds_read_b64_tr_b16 v[240:241], v7 offset:0
  ds_read_b64_tr_b16 v[242:243], v7 offset:1024
  ds_read_b64_tr_b16 v[164:165], v6 offset:16384
  ds_read_b64_tr_b16 v[166:167], v6 offset:17408
  ds_read_b64_tr_b16 v[244:245], v7 offset:16384
  ds_read_b64_tr_b16 v[246:247], v7 offset:17408
  ds_read_b64_tr_b16 v[168:169], v6 offset:32768
  ds_read_b64_tr_b16 v[170:171], v6 offset:33792
  ds_read_b64_tr_b16 v[248:249], v7 offset:32768
  ds_read_b64_tr_b16 v[250:251], v7 offset:33792
  ds_read_b64_tr_b16 v[172:173], v6 offset:49152
  ds_read_b64_tr_b16 v[174:175], v6 offset:50176
  ds_read_b64_tr_b16 v[252:253], v7 offset:49152
  ds_read_b64_tr_b16 v[254:255], v7 offset:50176
  v_xor_b32 v6, 0x10000, v6
  v_xor_b32 v7, 0x10000, v7
  s_waitcnt lgkmcnt(0)
  s_cmp_lt_u32 s20, 4
  s_cbranch_scc0 Lw_kx
  s_cmp_eq_u64 s[44:45], 0
  s_cbranch_scc0 Lw_kx
Lp_19:
  buffer_load_ubyte v10, off, s[80:83], 0 offset:128 sc1
  s_waitcnt vmcnt(0)
  v_cmp_gt_u32 vcc, 36, v10
  s_cbranch_vccz Lpd_20
  s_sleep 4
  s_sub_u32 s24, s24, 1
  s_cbranch_scc0 Lp_19
  s_branch Lw_fail
Lpd_20:
  s_add_u32 m0, s30, s35
  s_add_u32 s38, s28, 4096
  s_add_u32 s39, s28, 8192
  buffer_load_dwordx4 v2, s[4:7], s28 offen offset:0 sc1 lds
  buffer_load_dwordx4 v2, s[4:7], s28 offen offset:1024 sc1 lds
  buffer_load_dwordx4 v2, s[4:7], s28 offen offset:2048 sc1 lds
  buffer_load_dwordx4 v2, s[4:7], s28 offen offset:3072 sc1 lds
  s_add_u32 m0, m0, 4096
  s_nop 0
  buffer_load_dwordx4 v2, s[4:7], s38 offen offset:0 sc1 lds
  buffer_load_dwordx4 v2, s[4:7], s38 offen offset:1024 sc1 lds
  buffer_load_dwordx4 v2, s[4:7], s38 offen offset:2048 sc1 lds
  buffer_load_dwordx4 v2, s[4:7], s38 offen offset:3072 sc1 lds
  s_add_u32 m0, m0, 4096
  s_nop 0
  buffer_load_dwordx4 v2, s[4:7], s39 offen offset:0 sc1 lds
  buffer_load_dwordx4 v2, s[4:7], s39 offen offset:1024 sc1 lds
  s_add_u32 s28, s28, 40960
  s_add_u32 m0, s31, s35
  s_add_u32 s38, s28, 4096
  s_add_u32 s39, s28, 8192
  buffer_load_dwordx4 v2, s[4:7], s28 offen offset:0 sc1 lds
  buffer_load_dwordx4 v2, s[4:7], s28 offen offset:1024 sc1 lds
  buffer_load_dwordx4 v2, s[4:7], s28 offen offset:2048 sc1 lds
  buffer_load_dwordx4 v2, s[4:7], s28 offen offset:3072 sc1 lds
  s_add_u32 m0, m0, 4096
  s_nop 0
  buffer_load_dwordx4 v2, s[4:7], s38 offen offset:0 sc1 lds
  buffer_load_dwordx4 v2, s[4:7], s38 offen offset:1024 sc1 lds
  buffer_load_dwordx4 v2, s[4:7], s38 offen offset:2048 sc1 lds
  buffer_load_dwordx4 v2, s[4:7], s38 offen offset:3072 sc1 lds
  s_add_u32 m0, m0, 4096
  s_nop 0
  buffer_load_dwordx4 v2, s[4:7], s39 offen offset:0 sc1 lds
  buffer_load_dwordx4 v2, s[4:7], s39 offen offset:1024 sc1 lds
  s_add_u32 s28, s28, 40960
Lw_kx:
  s_lshl_b32 s38, s18, 3
  s_add_u32 s38, s38, s20
  s_mul_i32 s39, s16, 12
  s_add_u32 s39, s39, s17
  s_lshl_b32 s39, s39, 7
  s_add_u32 s39, s39, 1835008
  s_cmp_eq_u32 s20, 0
  s_cselect_b32 s39, s39, 0x40000000
  v_mov_b32 v4, 0x40000000
  v_writelane_b32 v4, s39, 0
  s_mul_i32 s41, s16, 24
  s_lshr_b32 s39, s38, 1
  s_add_u32 s41, s41, s39
  s_lshl_b32 s29, s41, 13
  s_add_u32 s29, s29, 17825792
  s_and_b32 s38, s38, 1
  s_cmp_ge_u32 s17, 6
  s_cbranch_scc1 Lw_v
  s_lshl_b32 s38, s38, 10
  s_add_u32 s29, s29, s38
  s_mov_b32 s25, 122880
  s_mov_b32 s26, 135168
  s_mov_b32 s27, 147456
  s_mov_b32 s22, 0
  s_waitcnt vmcnt(10)
  v_add_u32 v3, s30, v2
  s_barrier
  ds_read_b128 v[32:35], v3 offset:0
  ds_read_b128 v[36:39], v3 offset:1024
  ds_read_b128 v[40:43], v3 offset:2048
  ds_read_b128 v[44:47], v3 offset:3072
  ds_read_b128 v[48:51], v3 offset:4096
  ds_read_b128 v[52:55], v3 offset:5120
  s_waitcnt lgkmcnt(4)
  v_mfma_f32_16x16x32_bf16 v[16:19], v[96:99], v[32:35], 0
  ds_read_b128 v[56:59], v3 offset:6144
  v_mfma_f32_16x16x32_bf16 v[24:27], v[176:179], v[32:35], 0
  ds_read_b128 v[60:63], v3 offset:7168
  v_mfma_f32_16x16x32_bf16 v[20:23], v[96:99], v[36:39], 0
  v_mfma_f32_16x16x32_bf16 v[28:31], v[176:179], v[36:39], 0
  s_waitcnt lgkmcnt(4)
  v_mfma_f32_16x16x32_bf16 v[16:19], v[100:103], v[40:43], v[16:19]
  ds_read_b128 v[32:35], v3 offset:8192
  v_mfma_f32_16x16x32_bf16 v[24:27], v[180:183], v[40:43], v[24:27]
  ds_read_b128 v[36:39], v3 offset:9216
  v_mfma_f32_16x16x32_bf16 v[20:23], v[100:103], v[44:47], v[20:23]
  v_mfma_f32_16x16x32_bf16 v[28:31], v[180:183], v[44:47], v[28:31]
  s_waitcnt lgkmcnt(4)
  v_mfma_f32_16x16x32_bf16 v[16:19], v[104:107], v[48:51], v[16:19]
  ds_read_b128 v[40:43], v3 offset:10240
  v_mfma_f32_16x16x32_bf16 v[24:27], v[184:187], v[48:51], v[24:27]
  ds_read_b128 v[44:47], v3 offset:11264
  v_mfma_f32_16x16x32_bf16 v[20:23], v[104:107], v[52:55], v[20:23]
  v_mfma_f32_16x16x32_bf16 v[28:31], v[184:187], v[52:55], v[28:31]
  s_waitcnt lgkmcnt(4)
  v_mfma_f32_16x16x32_bf16 v[16:19], v[108:111], v[56:59], v[16:19]
  ds_read_b128 v[48:51], v3 offset:12288
  v_mfma_f32_16x16x32_bf16 v[24:27], v[188:191], v[56:59], v[24:27]
  ds_read_b128 v[52:55], v3 offset:13312
  v_mfma_f32_16x16x32_bf16 v[20:23], v[108:111], v[60:63], v[20:23]
  v_mfma_f32_16x16x32_bf16 v[28:31], v[188:191], v[60:63], v[28:31]
  s_waitcnt lgkmcnt(4)
  v_mfma_f32_16x16x32_bf16 v[16:19], v[112:115], v[32:35], v[16:19]
  ds_read_b128 v[56:59], v3 offset:14336
  v_mfma_f32_16x16x32_bf16 v[24:27], v[192:195], v[32:35], v[24:27]
  ds_read_b128 v[60:63], v3 offset:15360
  v_mfma_f32_16x16x32_bf16 v[20:23], v[112:115], v[36:39], v[20:23]
  v_mfma_f32_16x16x32_bf16 v[28:31], v[192:195], v[36:39], v[28:31]
  s_waitcnt lgkmcnt(4)
  v_mfma_f32_16x16x32_bf16 v[16:19], v[116:119], v[40:43], v[16:19]
  ds_read_b128 v[32:35], v3 offset:16384
  v_mfma_f32_16x16x32_bf16 v[24:27], v[196:199], v[40:43], v[24:27]
  ds_read_b128 v[36:39], v3 offset:17408
  v_mfma_f32_16x16x32_bf16 v[20:23], v[116:119], v[44:47], v[20:23]
  v_mfma_f32_16x16x32_bf16 v[28:31], v[196:199], v[44:47], v[28:31]
  s_waitcnt lgkmcnt(4)
  v_mfma_f32_16x16x32_bf16 v[16:19], v[120:123], v[48:51], v[16:19]
  ds_read_b128 v[40:43], v3 offset:18432
  v_mfma_f32_16x16x32_bf16 v[24:27], v[200:203], v[48:51], v[24:27]
  ds_read_b128 v[44:47], v3 offset:19456
  v_mfma_f32_16x16x32_bf16 v[20:23], v[120:123], v[52:55], v[20:23]
  v_mfma_f32_16x16x32_bf16 v[28:31], v[200:203], v[52:55], v[28:31]
  s_waitcnt lgkmcnt(4)
  v_mfma_f32_16x16x32_bf16 v[16:19], v[124:127], v[56:59], v[16:19]
  ds_read_b128 v[48:51], v3 offset:20480
  v_mfma_f32_16x16x32_bf16 v[24:27], v[204:207], v[56:59], v[24:27]
  ds_read_b128 v[52:55], v3 offset:21504
  v_mfma_f32_16x16x32_bf16 v[20:23], v[124:127], v[60:63], v[20:23]
  v_mfma_f32_16x16x32_bf16 v[28:31], v[204:207], v[60:63], v[28:31]
  s_waitcnt lgkmcnt(4)
  v_mfma_f32_16x16x32_bf16 v[16:19], v[128:131], v[32:35], v[16:19]
  ds_read_b128 v[56:59], v3 offset:22528
  v_mfma_f32_16x16x32_bf16 v[24:27], v[208:211], v[32:35], v[24:27]
  ds_read_b128 v[60:63], v3 offset:23552
  v_mfma_f32_16x16x32_bf16 v[20:23], v[128:131], v[36:39], v[20:23]
  v_mfma_f32_16x16x32_bf16 v[28:31], v[208:211], v[36:39], v[28:31]
  s_waitcnt lgkmcnt(4)
  v_mfma_f32_16x16x32_bf16 v[16:19], v[132:135], v[40:43], v[16:19]
  ds_read_b128 v[32:35], v3 offset:24576
  v_mfma_f32_16x16x32_bf16 v[24:27], v[212:215], v[40:43], v[24:27]
  ds_read_b128 v[36:39], v3 offset:25600
  v_mfma_f32_16x16x32_bf16 v[20:23], v[132:135], v[44:47], v[20:23]
  v_mfma_f32_16x16x32_bf16 v[28:31], v[212:215], v[44:47], v[28:31]
  s_waitcnt lgkmcnt(4)
  v_mfma_f32_16x16x32_bf16 v[16:19], v[136:139], v[48:51], v[16:19]
  ds_read_b128 v[40:43], v3 offset:26624
  v_mfma_f32_16x16x32_bf16 v[24:27], v[216:219], v[48:51], v[24:27]
  ds_read_b128 v[44:47], v3 offset:27648
  v_mfma_f32_16x16x32_bf16 v[20:23], v[136:139], v[52:55], v[20:23]
  v_mfma_f32_16x16x32_bf16 v[28:31], v[216:219], v[52:55], v[28:31]
  s_waitcnt lgkmcnt(4)
  v_mfma_f32_16x16x32_bf16 v[16:19], v[140:143], v[56:59], v[16:19]
  ds_read_b128 v[48:51], v3 offset:28672
  v_mfma_f32_16x16x32_bf16 v[24:27], v[220:223], v[56:59], v[24:27]
  ds_read_b128 v[52:55], v3 offset:29696
  v_mfma_f32_16x16x32_bf16 v[20:23], v[140:143], v[60:63], v[20:23]
  v_mfma_f32_16x16x32_bf16 v[28:31], v[220:223], v[60:63], v[28:31]
  s_waitcnt lgkmcnt(4)
  v_mfma_f32_16x16x32_bf16 v[16:19], v[144:147], v[32:35], v[16:19]
  ds_read_b128 v[56:59], v3 offset:30720
  v_mfma_f32_16x16x32_bf16 v[24:27], v[224:227], v[32:35], v[24:27]
  ds_read_b128 v[60:63], v3 offset:31744
  v_mfma_f32_16x16x32_bf16 v[20:23], v[144:147], v[36:39], v[20:23]
  v_mfma_f32_16x16x32_bf16 v[28:31], v[224:227], v[36:39], v[28:31]
  s_waitcnt lgkmcnt(4)
  v_mfma_f32_16x16x32_bf16 v[16:19], v[148:151], v[40:43], v[16:19]
  ds_read_b128 v[32:35], v3 offset:32768
  v_mfma_f32_16x16x32_bf16 v[24:27], v[228:231], v[40:43], v[24:27]
  ds_read_b128 v[36:39], v3 offset:33792
  v_mfma_f32_16x16x32_bf16 v[20:23], v[148:151], v[44:47], v[20:23]
  v_mfma_f32_16x16x32_bf16 v[28:31], v[228:231], v[44:47], v[28:31]
  s_waitcnt lgkmcnt(4)
  v_mfma_f32_16x16x32_bf16 v[16:19], v[152:155], v[48:51], v[16:19]
  ds_read_b128 v[40:43], v3 offset:34816
  v_mfma_f32_16x16x32_bf16 v[24:27], v[232:235], v[48:51], v[24:27]
  ds_read_b128 v[44:47], v3 offset:35840
  v_mfma_f32_16x16x32_bf16 v[20:23], v[152:155], v[52:55], v[20:23]
  v_mfma_f32_16x16x32_bf16 v[28:31], v[232:235], v[52:55], v[28:31]
  s_waitcnt lgkmcnt(4)
  v_mfma_f32_16x16x32_bf16 v[16:19], v[156:159], v[56:59], v[16:19]
  ds_read_b128 v[48:51], v3 offset:36864
  v_mfma_f32_16x16x32_bf16 v[24:27], v[236:239], v[56:59], v[24:27]
  ds_read_b128 v[52:55], v3 offset:37888
  v_mfma_f32_16x16x32_bf16 v[20:23], v[156:159], v[60:63], v[20:23]
  v_mfma_f32_16x16x32_bf16 v[28:31], v[236:239], v[60:63], v[28:31]
  s_waitcnt lgkmcnt(4)
  v_mfma_f32_16x16x32_bf16 v[16:19], v[160:163], v[32:35], v[16:19]
  ds_read_b128 v[56:59], v3 offset:38912
  v_mfma_f32_16x16x32_bf16 v[24:27], v[240:243], v[32:35], v[24:27]
  ds_read_b128 v[60:63], v3 offset:39936
  v_mfma_f32_16x16x32_bf16 v[20:23], v[160:163], v[36:39], v[20:23]
  v_mfma_f32_16x16x32_bf16 v[28:31], v[240:243], v[36:39], v[28:31]
  s_waitcnt lgkmcnt(4)
  v_mfma_f32_16x16x32_bf16 v[16:19], v[164:167], v[40:43], v[16:19]
  v_mfma_f32_16x16x32_bf16 v[24:27], v[244:247], v[40:43], v[24:27]
  v_mfma_f32_16x16x32_bf16 v[20:23], v[164:167], v[44:47], v[20:23]
  v_mfma_f32_16x16x32_bf16 v[28:31], v[244:247], v[44:47], v[28:31]
  s_waitcnt lgkmcnt(2)
  v_mfma_f32_16x16x32_bf16 v[16:19], v[168:171], v[48:51], v[16:19]
  v_mfma_f32_16x16x32_bf16 v[24:27], v[248:251], v[48:51], v[24:27]
  v_mfma_f32_16x16x32_bf16 v[20:23], v[168:171], v[52:55], v[20:23]
  v_mfma_f32_16x16x32_bf16 v[28:31], v[248:251], v[52:55], v[28:31]
  s_waitcnt lgkmcnt(0)
  v_mfma_f32_16x16x32_bf16 v[16:19], v[172:175], v[56:59], v[16:19]
  v_mfma_f32_16x16x32_bf16 v[24:27], v[252:255], v[56:59], v[24:27]
  v_mfma_f32_16x16x32_bf16 v[20:23], v[172:175], v[60:63], v[20:23]
  v_mfma_f32_16x16x32_bf16 v[28:31], v[252:255], v[60:63], v[28:31]
  s_mov_b32 s38, s30
  s_mov_b32 s30, s31
  s_mov_b32 s31, s32
  s_mov_b32 s32, s38
  s_add_u32 s22, s22, 1
  s_waitcnt vmcnt(0)
  v_add_u32 v3, s30, v2
  s_barrier
  ds_read_b128 v[32:35], v3 offset:0
  ds_read_b128 v[36:39], v3 offset:1024
  ds_read_b128 v[40:43], v3 offset:2048
  ds_read_b128 v[44:47], v3 offset:3072
  ds_read_b128 v[48:51], v3 offset:4096
  ds_read_b128 v[52:55], v3 offset:5120
  v_cvt_pk_bf16_f32 v64, v16, v17
  v_cvt_pk_bf16_f32 v65, v18, v19
  v_cvt_pk_bf16_f32 v66, v24, v25
  v_cvt_pk_bf16_f32 v67, v26, v27
  buffer_store_dwordx4 v[64:67], v2, s[4:7], s29 offen offset:0 sc1
  v_cvt_pk_bf16_f32 v68, v20, v21
  v_cvt_pk_bf16_f32 v69, v22, v23
  v_cvt_pk_bf16_f32 v70, v28, v29
  v_cvt_pk_bf16_f32 v71, v30, v31
  buffer_store_dwordx4 v[68:71], v2, s[4:7], s29 offen offset:2048 sc1
  s_add_u32 s29, s29, 786432
  s_waitcnt lgkmcnt(4)
  v_mfma_f32_16x16x32_bf16 v[16:19], v[96:99], v[32:35], 0
  ds_read_b128 v[56:59], v3 offset:6144
  v_mfma_f32_16x16x32_bf16 v[24:27], v[176:179], v[32:35], 0
  ds_read_b128 v[60:63], v3 offset:7168
  v_mfma_f32_16x16x32_bf16 v[20:23], v[96:99], v[36:39], 0
  v_mfma_f32_16x16x32_bf16 v[28:31], v[176:179], v[36:39], 0
  s_waitcnt lgkmcnt(4)
  v_mfma_f32_16x16x32_bf16 v[16:19], v[100:103], v[40:43], v[16:19]
  ds_read_b128 v[32:35], v3 offset:8192
  v_mfma_f32_16x16x32_bf16 v[24:27], v[180:183], v[40:43], v[24:27]
  ds_read_b128 v[36:39], v3 offset:9216
  v_mfma_f32_16x16x32_bf16 v[20:23], v[100:103], v[44:47], v[20:23]
  v_mfma_f32_16x16x32_bf16 v[28:31], v[180:183], v[44:47], v[28:31]
  s_waitcnt lgkmcnt(4)
  v_mfma_f32_16x16x32_bf16 v[16:19], v[104:107], v[48:51], v[16:19]
  ds_read_b128 v[40:43], v3 offset:10240
  v_mfma_f32_16x16x32_bf16 v[24:27], v[184:187], v[48:51], v[24:27]
  ds_read_b128 v[44:47], v3 offset:11264
  v_mfma_f32_16x16x32_bf16 v[20:23], v[104:107], v[52:55], v[20:23]
  v_mfma_f32_16x16x32_bf16 v[28:31], v[184:187], v[52:55], v[28:31]
  s_waitcnt lgkmcnt(4)
  v_mfma_f32_16x16x32_bf16 v[16:19], v[108:111], v[56:59], v[16:19]
  ds_read_b128 v[48:51], v3 offset:12288
  v_mfma_f32_16x16x32_bf16 v[24:27], v[188:191], v[56:59], v[24:27]
  ds_read_b128 v[52:55], v3 offset:13312
  v_mfma_f32_16x16x32_bf16 v[20:23], v[108:111], v[60:63], v[20:23]
  v_mfma_f32_16x16x32_bf16 v[28:31], v[188:191], v[60:63], v[28:31]
  s_waitcnt lgkmcnt(4)
  v_mfma_f32_16x16x32_bf16 v[16:19], v[112:115], v[32:35], v[16:19]
  ds_read_b128 v[56:59], v3 offset:14336
  v_mfma_f32_16x16x32_bf16 v[24:27], v[192:195], v[32:35], v[24:27]
  ds_read_b128 v[60:63], v3 offset:15360
  v_mfma_f32_16x16x32_bf16 v[20:23], v[112:115], v[36:39], v[20:23]
  v_mfma_f32_16x16x32_bf16 v[28:31], v[192:195], v[36:39], v[28:31]
  s_waitcnt lgkmcnt(4)
  v_mfma_f32_16x16x32_bf16 v[16:19], v[116:119], v[40:43], v[16:19]
  ds_read_b128 v[32:35], v3 offset:16384
  v_mfma_f32_16x16x32_bf16 v[24:27], v[196:199], v[40:43], v[24:27]
  ds_read_b128 v[36:39], v3 offset:17408
  v_mfma_f32_16x16x32_bf16 v[20:23], v[116:119], v[44:47], v[20:23]
  v_mfma_f32_16x16x32_bf16 v[28:31], v[196:199], v[44:47], v[28:31]
  s_waitcnt lgkmcnt(4)
  v_mfma_f32_16x16x32_bf16 v[16:19], v[120:123], v[48:51], v[16:19]
  ds_read_b128 v[40:43], v3 offset:18432
  v_mfma_f32_16x16x32_bf16 v[24:27], v[200:203], v[48:51], v[24:27]
  ds_read_b128 v[44:47], v3 offset:19456
  v_mfma_f32_16x16x32_bf16 v[20:23], v[120:123], v[52:55], v[20:23]
  v_mfma_f32_16x16x32_bf16 v[28:31], v[200:203], v[52:55], v[28:31]
  s_waitcnt lgkmcnt(4)
  v_mfma_f32_16x16x32_bf16 v[16:19], v[124:127], v[56:59], v[16:19]
  ds_read_b128 v[48:51], v3 offset:20480
  v_mfma_f32_16x16x32_bf16 v[24:27], v[204:207], v[56:59], v[24:27]
  ds_read_b128 v[52:55], v3 offset:21504
  v_mfma_f32_16x16x32_bf16 v[20:23], v[124:127], v[60:63], v[20:23]
  v_mfma_f32_16x16x32_bf16 v[28:31], v[204:207], v[60:63], v[28:31]
  s_waitcnt vmcnt(0)
  s_barrier
  v_mov_b32 v6, 1
  buffer_store_dword v6, v4, s[4:7], 0 offen sc1
  s_cmp_lt_u32 s20, 4
  s_cbranch_scc0 Lao_27
  s_add_u32 m0, s31, s35
  s_add_u32 s38, s28, 4096
  s_add_u32 s39, s28, 8192
  buffer_load_dwordx4 v2, s[4:7], s28 offen offset:0 sc1 lds
  buffer_load_dwordx4 v2, s[4:7], s28 offen offset:1024 sc1 lds
  buffer_load_dwordx4 v2, s[4:7], s28 offen offset:2048 sc1 lds
  buffer_load_dwordx4 v2, s[4:7], s28 offen offset:3072 sc1 lds
  s_add_u32 m0, m0, 4096
  s_nop 0
  buffer_load_dwordx4 v2, s[4:7], s38 offen offset:0 sc1 lds
  buffer_load_dwordx4 v2, s[4:7], s38 offen offset:1024 sc1 lds
  buffer_load_dwordx4 v2, s[4:7], s38 offen offset:2048 sc1 lds
  buffer_load_dwordx4 v2, s[4:7], s38 offen offset:3072 sc1 lds
  s_add_u32 m0, m0, 4096
  s_nop 0
  buffer_load_dwordx4 v2, s[4:7], s39 offen offset:0 sc1 lds
  buffer_load_dwordx4 v2, s[4:7], s39 offen offset:1024 sc1 lds
  s_add_u32 s28, s28, 40960
Lao_27:
  s_waitcnt lgkmcnt(4)
  v_mfma_f32_16x16x32_bf16 v[16:19], v[128:131], v[32:35], v[16:19]
  ds_read_b128 v[56:59], v3 offset:22528
  v_mfma_f32_16x16x32_bf16 v[24:27], v[208:211], v[32:35], v[24:27]
  ds_read_b128 v[60:63], v3 offset:23552
  v_mfma_f32_16x16x32_bf16 v[20:23], v[128:131], v[36:39], v[20:23]
  v_mfma_f32_16x16x32_bf16 v[28:31], v[208:211], v[36:39], v[28:31]
  s_waitcnt lgkmcnt(4)
  v_mfma_f32_16x16x32_bf16 v[16:19], v[132:135], v[40:43], v[16:19]
  ds_read_b128 v[32:35], v3 offset:24576
  v_mfma_f32_16x16x32_bf16 v[24:27], v[212:215], v[40:43], v[24:27]
  ds_read_b128 v[36:39], v3 offset:25600
  v_mfma_f32_16x16x32_bf16 v[20:23], v[132:135], v[44:47], v[20:23]
  v_mfma_f32_16x16x32_bf16 v[28:31], v[212:215], v[44:47], v[28:31]
  s_waitcnt lgkmcnt(4)
  v_mfma_f32_16x16x32_bf16 v[16:19], v[136:139], v[48:51], v[16:19]
  ds_read_b128 v[40:43], v3 offset:26624
  v_mfma_f32_16x16x32_bf16 v[24:27], v[216:219], v[48:51], v[24:27]
  ds_read_b128 v[44:47], v3 offset:27648
  v_mfma_f32_16x16x32_bf16 v[20:23], v[136:139], v[52:55], v[20:23]
  v_mfma_f32_16x16x32_bf16 v[28:31], v[216:219], v[52:55], v[28:31]
  s_waitcnt lgkmcnt(4)
  v_mfma_f32_16x16x32_bf16 v[16:19], v[140:143], v[56:59], v[16:19]
  ds_read_b128 v[48:51], v3 offset:28672
  v_mfma_f32_16x16x32_bf16 v[24:27], v[220:223], v[56:59], v[24:27]
  ds_read_b128 v[52:55], v3 offset:29696
  v_mfma_f32_16x16x32_bf16 v[20:23], v[140:143], v[60:63], v[20:23]
  v_mfma_f32_16x16x32_bf16 v[28:31], v[220:223], v[60:63], v[28:31]
  s_waitcnt lgkmcnt(4)
  v_mfma_f32_16x16x32_bf16 v[16:19], v[144:147], v[32:35], v[16:19]
  ds_read_b128 v[56:59], v3 offset:30720
  v_mfma_f32_16x16x32_bf16 v[24:27], v[224:227], v[32:35], v[24:27]
  ds_read_b128 v[60:63], v3 offset:31744
  v_mfma_f32_16x16x32_bf16 v[20:23], v[144:147], v[36:39], v[20:23]
  v_mfma_f32_16x16x32_bf16 v[28:31], v[224:227], v[36:39], v[28:31]
  s_waitcnt lgkmcnt(4)
  v_mfma_f32_16x16x32_bf16 v[16:19], v[148:151], v[40:43], v[16:19]
  ds_read_b128 v[32:35], v3 offset:32768
  v_mfma_f32_16x16x32_bf16 v[24:27], v[228:231], v[40:43], v[24:27]
  ds_read_b128 v[36:39], v3 offset:33792
  v_mfma_f32_16x16x32_bf16 v[20:23], v[148:151], v[44:47], v[20:23]
  v_mfma_f32_16x16x32_bf16 v[28:31], v[228:231], v[44:47], v[28:31]
  s_waitcnt lgkmcnt(4)
  v_mfma_f32_16x16x32_bf16 v[16:19], v[152:155], v[48:51], v[16:19]
  ds_read_b128 v[40:43], v3 offset:34816
  v_mfma_f32_16x16x32_bf16 v[24:27], v[232:235], v[48:51], v[24:27]
  ds_read_b128 v[44:47], v3 offset:35840
  v_mfma_f32_16x16x32_bf16 v[20:23], v[152:155], v[52:55], v[20:23]
  v_mfma_f32_16x16x32_bf16 v[28:31], v[232:235], v[52:55], v[28:31]
  s_waitcnt lgkmcnt(4)
  v_mfma_f32_16x16x32_bf16 v[16:19], v[156:159], v[56:59], v[16:19]
  ds_read_b128 v[48:51], v3 offset:36864
  v_mfma_f32_16x16x32_bf16 v[24:27], v[236:239], v[56:59], v[24:27]
  ds_read_b128 v[52:55], v3 offset:37888
  v_mfma_f32_16x16x32_bf16 v[20:23], v[156:159], v[60:63], v[20:23]
  v_mfma_f32_16x16x32_bf16 v[28:31], v[236:239], v[60:63], v[28:31]
  s_waitcnt lgkmcnt(4)
  v_mfma_f32_16x16x32_bf16 v[16:19], v[160:163], v[32:35], v[16:19]
  ds_read_b128 v[56:59], v3 offset:38912
  v_mfma_f32_16x16x32_bf16 v[24:27], v[240:243], v[32:35], v[24:27]
  ds_read_b128 v[60:63], v3 offset:39936
  v_mfma_f32_16x16x32_bf16 v[20:23], v[160:163], v[36:39], v[20:23]
  v_mfma_f32_16x16x32_bf16 v[28:31], v[240:243], v[36:39], v[28:31]
  s_waitcnt lgkmcnt(4)
  v_mfma_f32_16x16x32_bf16 v[16:19], v[164:167], v[40:43], v[16:19]
  v_mfma_f32_16x16x32_bf16 v[24:27], v[244:247], v[40:43], v[24:27]
  v_mfma_f32_16x16x32_bf16 v[20:23], v[164:167], v[44:47], v[20:23]
  v_mfma_f32_16x16x32_bf16 v[28:31], v[244:247], v[44:47], v[28:31]
  s_waitcnt lgkmcnt(2)
  v_mfma_f32_16x16x32_bf16 v[16:19], v[168:171], v[48:51], v[16:19]
  v_mfma_f32_16x16x32_bf16 v[24:27], v[248:251], v[48:51], v[24:27]
  v_mfma_f32_16x16x32_bf16 v[20:23], v[168:171], v[52:55], v[20:23]
  v_mfma_f32_16x16x32_bf16 v[28:31], v[248:251], v[52:55], v[28:31]
  s_waitcnt lgkmcnt(0)
  v_mfma_f32_16x16x32_bf16 v[16:19], v[172:175], v[56:59], v[16:19]
  v_mfma_f32_16x16x32_bf16 v[24:27], v[252:255], v[56:59], v[24:27]
  v_mfma_f32_16x16x32_bf16 v[20:23], v[172:175], v[60:63], v[20:23]
  v_mfma_f32_16x16x32_bf16 v[28:31], v[252:255], v[60:63], v[28:31]
  s_mov_b32 s38, s30
  s_mov_b32 s30, s31
  s_mov_b32 s31, s32
  s_mov_b32 s32, s38
  s_add_u32 s22, s22, 1
  v_cvt_pk_bf16_f32 v64, v16, v17
  v_cvt_pk_bf16_f32 v65, v18, v19
  v_cvt_pk_bf16_f32 v66, v24, v25
  v_cvt_pk_bf16_f32 v67, v26, v27
  buffer_store_dwordx4 v[64:67], v2, s[4:7], s29 offen offset:0 sc1
  v_cvt_pk_bf16_f32 v68, v20, v21
  v_cvt_pk_bf16_f32 v69, v22, v23
  v_cvt_pk_bf16_f32 v70, v28, v29
  v_cvt_pk_bf16_f32 v71, v30, v31
  buffer_store_dwordx4 v[68:71], v2, s[4:7], s29 offen offset:2048 sc1
  s_add_u32 s29, s29, 786432
  s_waitcnt vmcnt(0)
  s_cmp_lt_u32 s20, 4
  s_cbranch_scc0 Lpb0_23
  s_setprio 1
  s_waitcnt vmcnt(0)
Lpa_21:
  v_add_u32 v3, s30, v2
  s_barrier
  ds_read_b128 v[32:35], v3 offset:0
  ds_read_b128 v[36:39], v3 offset:1024
  ds_read_b128 v[40:43], v3 offset:2048
  ds_read_b128 v[44:47], v3 offset:3072
  ds_read_b128 v[48:51], v3 offset:4096
  ds_read_b128 v[52:55], v3 offset:5120
  s_sub_u32 s40, s22, 1
  s_max_i32 s40, s40, 2
  v_mov_b32 v6, s40
  buffer_store_dword v6, v4, s[4:7], 0 offen sc1
  s_cmp_eq_u32 s22, 63
  s_cbranch_scc1 Lpnd_26
  s_add_u32 m0, s31, s35
  s_add_u32 s38, s28, 4096
  s_add_u32 s39, s28, 8192
  buffer_load_dwordx4 v2, s[4:7], s28 offen offset:0 sc1 lds
  buffer_load_dwordx4 v2, s[4:7], s28 offen offset:1024 sc1 lds
  buffer_load_dwordx4 v2, s[4:7], s28 offen offset:2048 sc1 lds
  buffer_load_dwordx4 v2, s[4:7], s28 offen offset:3072 sc1 lds
  s_add_u32 m0, m0, 4096
  s_nop 0
  buffer_load_dwordx4 v2, s[4:7], s38 offen offset:0 sc1 lds
  buffer_load_dwordx4 v2, s[4:7], s38 offen offset:1024 sc1 lds
  buffer_load_dwordx4 v2, s[4:7], s38 offen offset:2048 sc1 lds
  buffer_load_dwordx4 v2, s[4:7], s38 offen offset:3072 sc1 lds
  s_add_u32 m0, m0, 4096
  s_nop 0
  buffer_load_dwordx4 v2, s[4:7], s39 offen offset:0 sc1 lds
  buffer_load_dwordx4 v2, s[4:7], s39 offen offset:1024 sc1 lds
  s_add_u32 s28, s28, 40960
Lpnd_26:
  s_waitcnt lgkmcnt(4)
  v_mfma_f32_16x16x32_bf16 v[16:19], v[96:99], v[32:35], 0
  ds_read_b128 v[56:59], v3 offset:6144
  v_mfma_f32_16x16x32_bf16 v[24:27], v[176:179], v[32:35], 0
  ds_read_b128 v[60:63], v3 offset:7168
  v_mfma_f32_16x16x32_bf16 v[20:23], v[96:99], v[36:39], 0
  v_mfma_f32_16x16x32_bf16 v[28:31], v[176:179], v[36:39], 0
  s_waitcnt lgkmcnt(4)
  v_mfma_f32_16x16x32_bf16 v[16:19], v[100:103], v[40:43], v[16:19]
  ds_read_b128 v[32:35], v3 offset:8192
  v_mfma_f32_16x16x32_bf16 v[24:27], v[180:183], v[40:43], v[24:27]
  ds_read_b128 v[36:39], v3 offset:9216
  v_mfma_f32_16x16x32_bf16 v[20:23], v[100:103], v[44:47], v[20:23]
  v_mfma_f32_16x16x32_bf16 v[28:31], v[180:183], v[44:47], v[28:31]
  s_waitcnt lgkmcnt(4)
  v_mfma_f32_16x16x32_bf16 v[16:19], v[104:107], v[48:51], v[16:19]
  ds_read_b128 v[40:43], v3 offset:10240
  v_mfma_f32_16x16x32_bf16 v[24:27], v[184:187], v[48:51], v[24:27]
  ds_read_b128 v[44:47], v3 offset:11264
  v_mfma_f32_16x16x32_bf16 v[20:23], v[104:107], v[52:55], v[20:23]
  v_mfma_f32_16x16x32_bf16 v[28:31], v[184:187], v[52:55], v[28:31]
  s_waitcnt lgkmcnt(4)
  v_mfma_f32_16x16x32_bf16 v[16:19], v[108:111], v[56:59], v[16:19]
  ds_read_b128 v[48:51], v3 offset:12288
  v_mfma_f32_16x16x32_bf16 v[24:27], v[188:191], v[56:59], v[24:27]
  ds_read_b128 v[52:55], v3 offset:13312
  v_mfma_f32_16x16x32_bf16 v[20:23], v[108:111], v[60:63], v[20:23]
  v_mfma_f32_16x16x32_bf16 v[28:31], v[188:191], v[60:63], v[28:31]
  s_waitcnt lgkmcnt(4)
  v_mfma_f32_16x16x32_bf16 v[16:19], v[112:115], v[32:35], v[16:19]
  ds_read_b128 v[56:59], v3 offset:14336
  v_mfma_f32_16x16x32_bf16 v[24:27], v[192:195], v[32:35], v[24:27]
  ds_read_b128 v[60:63], v3 offset:15360
  v_mfma_f32_16x16x32_bf16 v[20:23], v[112:115], v[36:39], v[20:23]
  v_mfma_f32_16x16x32_bf16 v[28:31], v[192:195], v[36:39], v[28:31]
  s_waitcnt lgkmcnt(4)
  v_mfma_f32_16x16x32_bf16 v[16:19], v[116:119], v[40:43], v[16:19]
  ds_read_b128 v[32:35], v3 offset:16384
  v_mfma_f32_16x16x32_bf16 v[24:27], v[196:199], v[40:43], v[24:27]
  ds_read_b128 v[36:39], v3 offset:17408
  v_mfma_f32_16x16x32_bf16 v[20:23], v[116:119], v[44:47], v[20:23]
  v_mfma_f32_16x16x32_bf16 v[28:31], v[196:199], v[44:47], v[28:31]
  s_waitcnt lgkmcnt(4)
  v_mfma_f32_16x16x32_bf16 v[16:19], v[120:123], v[48:51], v[16:19]
  ds_read_b128 v[40:43], v3 offset:18432
  v_mfma_f32_16x16x32_bf16 v[24:27], v[200:203], v[48:51], v[24:27]
  ds_read_b128 v[44:47], v3 offset:19456
  v_mfma_f32_16x16x32_bf16 v[20:23], v[120:123], v[52:55], v[20:23]
  v_mfma_f32_16x16x32_bf16 v[28:31], v[200:203], v[52:55], v[28:31]
  s_waitcnt lgkmcnt(4)
  v_mfma_f32_16x16x32_bf16 v[16:19], v[124:127], v[56:59], v[16:19]
  ds_read_b128 v[48:51], v3 offset:20480
  v_mfma_f32_16x16x32_bf16 v[24:27], v[204:207], v[56:59], v[24:27]
  ds_read_b128 v[52:55], v3 offset:21504
  v_mfma_f32_16x16x32_bf16 v[20:23], v[124:127], v[60:63], v[20:23]
  v_mfma_f32_16x16x32_bf16 v[28:31], v[204:207], v[60:63], v[28:31]
  s_waitcnt lgkmcnt(4)
  v_mfma_f32_16x16x32_bf16 v[16:19], v[128:131], v[32:35], v[16:19]
  ds_read_b128 v[56:59], v3 offset:22528
  v_mfma_f32_16x16x32_bf16 v[24:27], v[208:211], v[32:35], v[24:27]
  ds_read_b128 v[60:63], v3 offset:23552
  v_mfma_f32_16x16x32_bf16 v[20:23], v[128:131], v[36:39], v[20:23]
  v_mfma_f32_16x16x32_bf16 v[28:31], v[208:211], v[36:39], v[28:31]
  s_waitcnt lgkmcnt(4)
  v_mfma_f32_16x16x32_bf16 v[16:19], v[132:135], v[40:43], v[16:19]
  ds_read_b128 v[32:35], v3 offset:24576
  v_mfma_f32_16x16x32_bf16 v[24:27], v[212:215], v[40:43], v[24:27]
  ds_read_b128 v[36:39], v3 offset:25600
  v_mfma_f32_16x16x32_bf16 v[20:23], v[132:135], v[44:47], v[20:23]
  v_mfma_f32_16x16x32_bf16 v[28:31], v[212:215], v[44:47], v[28:31]
  s_waitcnt lgkmcnt(4)
  v_mfma_f32_16x16x32_bf16 v[16:19], v[136:139], v[48:51], v[16:19]
  ds_read_b128 v[40:43], v3 offset:26624
  v_mfma_f32_16x16x32_bf16 v[24:27], v[216:219], v[48:51], v[24:27]
  ds_read_b128 v[44:47], v3 offset:27648
  v_mfma_f32_16x16x32_bf16 v[20:23], v[136:139], v[52:55], v[20:23]
  v_mfma_f32_16x16x32_bf16 v[28:31], v[216:219], v[52:55], v[28:31]
  s_waitcnt lgkmcnt(4)
  v_mfma_f32_16x16x32_bf16 v[16:19], v[140:143], v[56:59], v[16:19]
  ds_read_b128 v[48:51], v3 offset:28672
  v_mfma_f32_16x16x32_bf16 v[24:27], v[220:223], v[56:59], v[24:27]
  ds_read_b128 v[52:55], v3 offset:29696
  v_mfma_f32_16x16x32_bf16 v[20:23], v[140:143], v[60:63], v[20:23]
  v_mfma_f32_16x16x32_bf16 v[28:31], v[220:223], v[60:63], v[28:31]
  s_waitcnt lgkmcnt(4)
  v_mfma_f32_16x16x32_bf16 v[16:19], v[144:147], v[32:35], v[16:19]
  ds_read_b128 v[56:59], v3 offset:30720
  v_mfma_f32_16x16x32_bf16 v[24:27], v[224:227], v[32:35], v[24:27]
  ds_read_b128 v[60:63], v3 offset:31744
  v_mfma_f32_16x16x32_bf16 v[20:23], v[144:147], v[36:39], v[20:23]
  v_mfma_f32_16x16x32_bf16 v[28:31], v[224:227], v[36:39], v[28:31]
  s_waitcnt lgkmcnt(4)
  v_mfma_f32_16x16x32_bf16 v[16:19], v[148:151], v[40:43], v[16:19]
  ds_read_b128 v[32:35], v3 offset:32768
  v_mfma_f32_16x16x32_bf16 v[24:27], v[228:231], v[40:43], v[24:27]
  ds_read_b128 v[36:39], v3 offset:33792
  v_mfma_f32_16x16x32_bf16 v[20:23], v[148:151], v[44:47], v[20:23]
  v_mfma_f32_16x16x32_bf16 v[28:31], v[228:231], v[44:47], v[28:31]
  s_waitcnt lgkmcnt(4)
  v_mfma_f32_16x16x32_bf16 v[16:19], v[152:155], v[48:51], v[16:19]
  ds_read_b128 v[40:43], v3 offset:34816
  v_mfma_f32_16x16x32_bf16 v[24:27], v[232:235], v[48:51], v[24:27]
  ds_read_b128 v[44:47], v3 offset:35840
  v_mfma_f32_16x16x32_bf16 v[20:23], v[152:155], v[52:55], v[20:23]
  v_mfma_f32_16x16x32_bf16 v[28:31], v[232:235], v[52:55], v[28:31]
  s_waitcnt lgkmcnt(4)
  v_mfma_f32_16x16x32_bf16 v[16:19], v[156:159], v[56:59], v[16:19]
  ds_read_b128 v[48:51], v3 offset:36864
  v_mfma_f32_16x16x32_bf16 v[24:27], v[236:239], v[56:59], v[24:27]
  ds_read_b128 v[52:55], v3 offset:37888
  v_mfma_f32_16x16x32_bf16 v[20:23], v[156:159], v[60:63], v[20:23]
  v_mfma_f32_16x16x32_bf16 v[28:31], v[236:239], v[60:63], v[28:31]
  s_waitcnt lgkmcnt(4)
  v_mfma_f32_16x16x32_bf16 v[16:19], v[160:163], v[32:35], v[16:19]
  ds_read_b128 v[56:59], v3 offset:38912
  v_mfma_f32_16x16x32_bf16 v[24:27], v[240:243], v[32:35], v[24:27]
  ds_read_b128 v[60:63], v3 offset:39936
  v_mfma_f32_16x16x32_bf16 v[20:23], v[160:163], v[36:39], v[20:23]
  v_mfma_f32_16x16x32_bf16 v[28:31], v[240:243], v[36:39], v[28:31]
  s_waitcnt lgkmcnt(4)
  v_mfma_f32_16x16x32_bf16 v[16:19], v[164:167], v[40:43], v[16:19]
  v_mfma_f32_16x16x32_bf16 v[24:27], v[244:247], v[40:43], v[24:27]
  v_mfma_f32_16x16x32_bf16 v[20:23], v[164:167], v[44:47], v[20:23]
  v_mfma_f32_16x16x32_bf16 v[28:31], v[244:247], v[44:47], v[28:31]
  s_waitcnt lgkmcnt(2)
  v_mfma_f32_16x16x32_bf16 v[16:19], v[168:171], v[48:51], v[16:19]
  v_mfma_f32_16x16x32_bf16 v[24:27], v[248:251], v[48:51], v[24:27]
  v_mfma_f32_16x16x32_bf16 v[20:23], v[168:171], v[52:55], v[20:23]
  v_mfma_f32_16x16x32_bf16 v[28:31], v[248:251], v[52:55], v[28:31]
  s_waitcnt lgkmcnt(0)
  v_mfma_f32_16x16x32_bf16 v[16:19], v[172:175], v[56:59], v[16:19]
  v_mfma_f32_16x16x32_bf16 v[24:27], v[252:255], v[56:59], v[24:27]
  v_mfma_f32_16x16x32_bf16 v[20:23], v[172:175], v[60:63], v[20:23]
  v_mfma_f32_16x16x32_bf16 v[28:31], v[252:255], v[60:63], v[28:31]
  s_mov_b32 s38, s30
  s_mov_b32 s30, s31
  s_mov_b32 s31, s32
  s_mov_b32 s32, s38
  s_add_u32 s22, s22, 1
  s_waitcnt vmcnt(0)
  v_cvt_pk_bf16_f32 v64, v16, v17
  v_cvt_pk_bf16_f32 v65, v18, v19
  v_cvt_pk_bf16_f32 v66, v24, v25
  v_cvt_pk_bf16_f32 v67, v26, v27
  buffer_store_dwordx4 v[64:67], v2, s[4:7], s29 offen offset:0 sc1
  v_cvt_pk_bf16_f32 v68, v20, v21
  v_cvt_pk_bf16_f32 v69, v22, v23
  v_cvt_pk_bf16_f32 v70, v28, v29
  v_cvt_pk_bf16_f32 v71, v30, v31
  buffer_store_dwordx4 v[68:71], v2, s[4:7], s29 offen offset:2048 sc1
  s_add_u32 s29, s29, 786432
  s_cmp_lt_u32 s22, 64
  s_cbranch_scc1 Lpa_21
  s_barrier
  v_mov_b32 v6, 63
  buffer_store_dword v6, v4, s[4:7], 0 offen sc1
  s_waitcnt vmcnt(0)
  s_barrier
  v_mov_b32 v6, 64
  buffer_store_dword v6, v4, s[4:7], 0 offen sc1
  s_branch Lw_help
Lpb0_23:
  s_barrier
  v_add_u32 v3, s30, v2
  ds_read_b128 v[32:35], v3 offset:0
  ds_read_b128 v[36:39], v3 offset:1024
  ds_read_b128 v[40:43], v3 offset:2048
  ds_read_b128 v[44:47], v3 offset:3072
  ds_read_b128 v[48:51], v3 offset:4096
  ds_read_b128 v[52:55], v3 offset:5120
  s_branch Lpb1_24
Lpb_22:
  s_setprio 2
  s_barrier
  s_waitcnt lgkmcnt(4)
  v_mfma_f32_16x16x32_bf16 v[16:19], v[136:139], v[48:51], v[16:19]
  ds_read_b128 v[40:43], v3 offset:26624
  v_mfma_f32_16x16x32_bf16 v[24:27], v[216:219], v[48:51], v[24:27]
  ds_read_b128 v[44:47], v3 offset:27648
  v_mfma_f32_16x16x32_bf16 v[20:23], v[136:139], v[52:55], v[20:23]
  v_mfma_f32_16x16x32_bf16 v[28:31], v[216:219], v[52:55], v[28:31]
  s_waitcnt lgkmcnt(4)
  v_mfma_f32_16x16x32_bf16 v[16:19], v[140:143], v[56:59], v[16:19]
  ds_read_b128 v[48:51], v3 offset:28672
  v_mfma_f32_16x16x32_bf16 v[24:27], v[220:223], v[56:59], v[24:27]
  ds_read_b128 v[52:55], v3 offset:29696
  v_mfma_f32_16x16x32_bf16 v[20:23], v[140:143], v[60:63], v[20:23]
  v_mfma_f32_16x16x32_bf16 v[28:31], v[220:223], v[60:63], v[28:31]
  s_waitcnt lgkmcnt(4)
  v_mfma_f32_16x16x32_bf16 v[16:19], v[144:147], v[32:35], v[16:19]
  ds_read_b128 v[56:59], v3 offset:30720
  v_mfma_f32_16x16x32_bf16 v[24:27], v[224:227], v[32:35], v[24:27]
  ds_read_b128 v[60:63], v3 offset:31744
  v_mfma_f32_16x16x32_bf16 v[20:23], v[144:147], v[36:39], v[20:23]
  v_mfma_f32_16x16x32_bf16 v[28:31], v[224:227], v[36:39], v[28:31]
  s_waitcnt lgkmcnt(4)
  v_mfma_f32_16x16x32_bf16 v[16:19], v[148:151], v[40:43], v[16:19]
  ds_read_b128 v[32:35], v3 offset:32768
  v_mfma_f32_16x16x32_bf16 v[24:27], v[228:231], v[40:43], v[24:27]
  ds_read_b128 v[36:39], v3 offset:33792
  v_mfma_f32_16x16x32_bf16 v[20:23], v[148:151], v[44:47], v[20:23]
  v_mfma_f32_16x16x32_bf16 v[28:31], v[228:231], v[44:47], v[28:31]
  s_waitcnt lgkmcnt(4)
  v_mfma_f32_16x16x32_bf16 v[16:19], v[152:155], v[48:51], v[16:19]
  ds_read_b128 v[40:43], v3 offset:34816
  v_mfma_f32_16x16x32_bf16 v[24:27], v[232:235], v[48:51], v[24:27]
  ds_read_b128 v[44:47], v3 offset:35840
  v_mfma_f32_16x16x32_bf16 v[20:23], v[152:155], v[52:55], v[20:23]
  v_mfma_f32_16x16x32_bf16 v[28:31], v[232:235], v[52:55], v[28:31]
  s_waitcnt lgkmcnt(4)
  v_mfma_f32_16x16x32_bf16 v[16:19], v[156:159], v[56:59], v[16:19]
  ds_read_b128 v[48:51], v3 offset:36864
  v_mfma_f32_16x16x32_bf16 v[24:27], v[236:239], v[56:59], v[24:27]
  ds_read_b128 v[52:55], v3 offset:37888
  v_mfma_f32_16x16x32_bf16 v[20:23], v[156:159], v[60:63], v[20:23]
  v_mfma_f32_16x16x32_bf16 v[28:31], v[236:239], v[60:63], v[28:31]
  s_waitcnt lgkmcnt(4)
  v_mfma_f32_16x16x32_bf16 v[16:19], v[160:163], v[32:35], v[16:19]
  ds_read_b128 v[56:59], v3 offset:38912
  v_mfma_f32_16x16x32_bf16 v[24:27], v[240:243], v[32:35], v[24:27]
  ds_read_b128 v[60:63], v3 offset:39936
  v_mfma_f32_16x16x32_bf16 v[20:23], v[160:163], v[36:39], v[20:23]
  v_mfma_f32_16x16x32_bf16 v[28:31], v[240:243], v[36:39], v[28:31]
  s_waitcnt lgkmcnt(4)
  v_mfma_f32_16x16x32_bf16 v[16:19], v[164:167], v[40:43], v[16:19]
  v_mfma_f32_16x16x32_bf16 v[24:27], v[244:247], v[40:43], v[24:27]
  v_mfma_f32_16x16x32_bf16 v[20:23], v[164:167], v[44:47], v[20:23]
  v_mfma_f32_16x16x32_bf16 v[28:31], v[244:247], v[44:47], v[28:31]
  s_waitcnt lgkmcnt(2)
  v_mfma_f32_16x16x32_bf16 v[16:19], v[168:171], v[48:51], v[16:19]
  v_mfma_f32_16x16x32_bf16 v[24:27], v[248:251], v[48:51], v[24:27]
  v_mfma_f32_16x16x32_bf16 v[20:23], v[168:171], v[52:55], v[20:23]
  v_mfma_f32_16x16x32_bf16 v[28:31], v[248:251], v[52:55], v[28:31]
  s_waitcnt lgkmcnt(0)
  v_mfma_f32_16x16x32_bf16 v[16:19], v[172:175], v[56:59], v[16:19]
  v_mfma_f32_16x16x32_bf16 v[24:27], v[252:255], v[56:59], v[24:27]
  v_mfma_f32_16x16x32_bf16 v[20:23], v[172:175], v[60:63], v[20:23]
  v_mfma_f32_16x16x32_bf16 v[28:31], v[252:255], v[60:63], v[28:31]
  s_mov_b32 s38, s30
  s_mov_b32 s30, s31
  s_mov_b32 s31, s32
  s_mov_b32 s32, s38
  s_add_u32 s22, s22, 1
  s_setprio 0
  s_cmp_eq_u32 s22, 64
  s_cbranch_scc1 Lpbe_25
  v_add_u32 v3, s30, v2
  ds_read_b128 v[32:35], v3 offset:0
  ds_read_b128 v[36:39], v3 offset:1024
  ds_read_b128 v[40:43], v3 offset:2048
  ds_read_b128 v[44:47], v3 offset:3072
  ds_read_b128 v[48:51], v3 offset:4096
  ds_read_b128 v[52:55], v3 offset:5120
  v_cvt_pk_bf16_f32 v64, v16, v17
  v_cvt_pk_bf16_f32 v65, v18, v19
  v_cvt_pk_bf16_f32 v66, v24, v25
  v_cvt_pk_bf16_f32 v67, v26, v27
  buffer_store_dwordx4 v[64:67], v2, s[4:7], s29 offen offset:0 sc1
  v_cvt_pk_bf16_f32 v68, v20, v21
  v_cvt_pk_bf16_f32 v69, v22, v23
  v_cvt_pk_bf16_f32 v70, v28, v29
  v_cvt_pk_bf16_f32 v71, v30, v31
  buffer_store_dwordx4 v[68:71], v2, s[4:7], s29 offen offset:2048 sc1
  s_add_u32 s29, s29, 786432
Lpb1_24:
  s_waitcnt lgkmcnt(4)
  v_mfma_f32_16x16x32_bf16 v[16:19], v[96:99], v[32:35], 0
  ds_read_b128 v[56:59], v3 offset:6144
  v_mfma_f32_16x16x32_bf16 v[24:27], v[176:179], v[32:35], 0
  ds_read_b128 v[60:63], v3 offset:7168
  v_mfma_f32_16x16x32_bf16 v[20:23], v[96:99], v[36:39], 0
  v_mfma_f32_16x16x32_bf16 v[28:31], v[176:179], v[36:39], 0
  s_waitcnt lgkmcnt(4)
  v_mfma_f32_16x16x32_bf16 v[16:19], v[100:103], v[40:43], v[16:19]
  ds_read_b128 v[32:35], v3 offset:8192
  v_mfma_f32_16x16x32_bf16 v[24:27], v[180:183], v[40:43], v[24:27]
  ds_read_b128 v[36:39], v3 offset:9216
  v_mfma_f32_16x16x32_bf16 v[20:23], v[100:103], v[44:47], v[20:23]
  v_mfma_f32_16x16x32_bf16 v[28:31], v[180:183], v[44:47], v[28:31]
  s_waitcnt lgkmcnt(4)
  v_mfma_f32_16x16x32_bf16 v[16:19], v[104:107], v[48:51], v[16:19]
  ds_read_b128 v[40:43], v3 offset:10240
  v_mfma_f32_16x16x32_bf16 v[24:27], v[184:187], v[48:51], v[24:27]
  ds_read_b128 v[44:47], v3 offset:11264
  v_mfma_f32_16x16x32_bf16 v[20:23], v[104:107], v[52:55], v[20:23]
  v_mfma_f32_16x16x32_bf16 v[28:31], v[184:187], v[52:55], v[28:31]
  s_waitcnt lgkmcnt(4)
  v_mfma_f32_16x16x32_bf16 v[16:19], v[108:111], v[56:59], v[16:19]
  ds_read_b128 v[48:51], v3 offset:12288
  v_mfma_f32_16x16x32_bf16 v[24:27], v[188:191], v[56:59], v[24:27]
  ds_read_b128 v[52:55], v3 offset:13312
  v_mfma_f32_16x16x32_bf16 v[20:23], v[108:111], v[60:63], v[20:23]
  v_mfma_f32_16x16x32_bf16 v[28:31], v[188:191], v[60:63], v[28:31]
  s_waitcnt lgkmcnt(4)
  v_mfma_f32_16x16x32_bf16 v[16:19], v[112:115], v[32:35], v[16:19]
  ds_read_b128 v[56:59], v3 offset:14336
  v_mfma_f32_16x16x32_bf16 v[24:27], v[192:195], v[32:35], v[24:27]
  ds_read_b128 v[60:63], v3 offset:15360
  v_mfma_f32_16x16x32_bf16 v[20:23], v[112:115], v[36:39], v[20:23]
  v_mfma_f32_16x16x32_bf16 v[28:31], v[192:195], v[36:39], v[28:31]
  s_waitcnt lgkmcnt(4)
  v_mfma_f32_16x16x32_bf16 v[16:19], v[116:119], v[40:43], v[16:19]
  ds_read_b128 v[32:35], v3 offset:16384
  v_mfma_f32_16x16x32_bf16 v[24:27], v[196:199], v[40:43], v[24:27]
  ds_read_b128 v[36:39], v3 offset:17408
  v_mfma_f32_16x16x32_bf16 v[20:23], v[116:119], v[44:47], v[20:23]
  v_mfma_f32_16x16x32_bf16 v[28:31], v[196:199], v[44:47], v[28:31]
  s_waitcnt lgkmcnt(4)
  v_mfma_f32_16x16x32_bf16 v[16:19], v[120:123], v[48:51], v[16:19]
  ds_read_b128 v[40:43], v3 offset:18432
  v_mfma_f32_16x16x32_bf16 v[24:27], v[200:203], v[48:51], v[24:27]
  ds_read_b128 v[44:47], v3 offset:19456
  v_mfma_f32_16x16x32_bf16 v[20:23], v[120:123], v[52:55], v[20:23]
  v_mfma_f32_16x16x32_bf16 v[28:31], v[200:203], v[52:55], v[28:31]
  s_waitcnt lgkmcnt(4)
  v_mfma_f32_16x16x32_bf16 v[16:19], v[124:127], v[56:59], v[16:19]
  ds_read_b128 v[48:51], v3 offset:20480
  v_mfma_f32_16x16x32_bf16 v[24:27], v[204:207], v[56:59], v[24:27]
  ds_read_b128 v[52:55], v3 offset:21504
  v_mfma_f32_16x16x32_bf16 v[20:23], v[124:127], v[60:63], v[20:23]
  v_mfma_f32_16x16x32_bf16 v[28:31], v[204:207], v[60:63], v[28:31]
  s_waitcnt lgkmcnt(4)
  v_mfma_f32_16x16x32_bf16 v[16:19], v[128:131], v[32:35], v[16:19]
  ds_read_b128 v[56:59], v3 offset:22528
  v_mfma_f32_16x16x32_bf16 v[24:27], v[208:211], v[32:35], v[24:27]
  ds_read_b128 v[60:63], v3 offset:23552
  v_mfma_f32_16x16x32_bf16 v[20:23], v[128:131], v[36:39], v[20:23]
  v_mfma_f32_16x16x32_bf16 v[28:31], v[208:211], v[36:39], v[28:31]
  s_waitcnt lgkmcnt(4)
  v_mfma_f32_16x16x32_bf16 v[16:19], v[132:135], v[40:43], v[16:19]
  ds_read_b128 v[32:35], v3 offset:24576
  v_mfma_f32_16x16x32_bf16 v[24:27], v[212:215], v[40:43], v[24:27]
  ds_read_b128 v[36:39], v3 offset:25600
  v_mfma_f32_16x16x32_bf16 v[20:23], v[132:135], v[44:47], v[20:23]
  v_mfma_f32_16x16x32_bf16 v[28:31], v[212:215], v[44:47], v[28:31]
  s_waitcnt vmcnt(0)
  s_branch Lpb_22
Lpbe_25:
  v_cvt_pk_bf16_f32 v64, v16, v17
  v_cvt_pk_bf16_f32 v65, v18, v19
  v_cvt_pk_bf16_f32 v66, v24, v25
  v_cvt_pk_bf16_f32 v67, v26, v27
  buffer_store_dwordx4 v[64:67], v2, s[4:7], s29 offen offset:0 sc1
  v_cvt_pk_bf16_f32 v68, v20, v21
  v_cvt_pk_bf16_f32 v69, v22, v23
  v_cvt_pk_bf16_f32 v70, v28, v29
  v_cvt_pk_bf16_f32 v71, v30, v31
  buffer_store_dwordx4 v[68:71], v2, s[4:7], s29 offen offset:2048 sc1
  s_add_u32 s29, s29, 786432
  s_waitcnt vmcnt(0)
  s_barrier
  s_branch Lw_help
Lw_v:
  s_lshl_b32 s38, s38, 11
  s_add_u32 s29, s29, s38
  s_add_u32 s29, s29, 4096
  s_mov_b32 s25, 122880
  s_mov_b32 s26, 135168
  s_mov_b32 s27, 147456
  s_mov_b32 s22, 0
  s_waitcnt vmcnt(10)
  v_add_u32 v3, s30, v2
  s_barrier
  ds_read_b128 v[32:35], v3 offset:0
  ds_read_b128 v[36:39], v3 offset:1024
  ds_read_b128 v[40:43], v3 offset:2048
  ds_read_b128 v[44:47], v3 offset:3072
  ds_read_b128 v[48:51], v3 offset:4096
  ds_read_b128 v[52:55], v3 offset:5120
  s_waitcnt lgkmcnt(4)
  v_mfma_f32_16x16x32_bf16 v[16:19], v[32:35], v[96:99], 0
  ds_read_b128 v[56:59], v3 offset:6144
  v_mfma_f32_16x16x32_bf16 v[24:27], v[32:35], v[176:179], 0
  ds_read_b128 v[60:63], v3 offset:7168
  v_mfma_f32_16x16x32_bf16 v[20:23], v[36:39], v[96:99], 0
  v_mfma_f32_16x16x32_bf16 v[28:31], v[36:39], v[176:179], 0
  s_waitcnt lgkmcnt(4)
  v_mfma_f32_16x16x32_bf16 v[16:19], v[40:43], v[100:103], v[16:19]
  ds_read_b128 v[32:35], v3 offset:8192
  v_mfma_f32_16x16x32_bf16 v[24:27], v[40:43], v[180:183], v[24:27]
  ds_read_b128 v[36:39], v3 offset:9216
  v_mfma_f32_16x16x32_bf16 v[20:23], v[44:47], v[100:103], v[20:23]
  v_mfma_f32_16x16x32_bf16 v[28:31], v[44:47], v[180:183], v[28:31]
  s_waitcnt lgkmcnt(4)
  v_mfma_f32_16x16x32_bf16 v[16:19], v[48:51], v[104:107], v[16:19]
  ds_read_b128 v[40:43], v3 offset:10240
  v_mfma_f32_16x16x32_bf16 v[24:27], v[48:51], v[184:187], v[24:27]
  ds_read_b128 v[44:47], v3 offset:11264
  v_mfma_f32_16x16x32_bf16 v[20:23], v[52:55], v[104:107], v[20:23]
  v_mfma_f32_16x16x32_bf16 v[28:31], v[52:55], v[184:187], v[28:31]
  s_waitcnt lgkmcnt(4)
  v_mfma_f32_16x16x32_bf16 v[16:19], v[56:59], v[108:111], v[16:19]
  ds_read_b128 v[48:51], v3 offset:12288
  v_mfma_f32_16x16x32_bf16 v[24:27], v[56:59], v[188:191], v[24:27]
  ds_read_b128 v[52:55], v3 offset:13312
  v_mfma_f32_16x16x32_bf16 v[20:23], v[60:63], v[108:111], v[20:23]
  v_mfma_f32_16x16x32_bf16 v[28:31], v[60:63], v[188:191], v[28:31]
  s_waitcnt lgkmcnt(4)
  v_mfma_f32_16x16x32_bf16 v[16:19], v[32:35], v[112:115], v[16:19]
  ds_read_b128 v[56:59], v3 offset:14336
  v_mfma_f32_16x16x32_bf16 v[24:27], v[32:35], v[192:195], v[24:27]
  ds_read_b128 v[60:63], v3 offset:15360
  v_mfma_f32_16x16x32_bf16 v[20:23], v[36:39], v[112:115], v[20:23]
  v_mfma_f32_16x16x32_bf16 v[28:31], v[36:39], v[192:195], v[28:31]
  s_waitcnt lgkmcnt(4)
  v_mfma_f32_16x16x32_bf16 v[16:19], v[40:43], v[116:119], v[16:19]
  ds_read_b128 v[32:35], v3 offset:16384
  v_mfma_f32_16x16x32_bf16 v[24:27], v[40:43], v[196:199], v[24:27]
  ds_read_b128 v[36:39], v3 offset:17408
  v_mfma_f32_16x16x32_bf16 v[20:23], v[44:47], v[116:119], v[20:23]
  v_mfma_f32_16x16x32_bf16 v[28:31], v[44:47], v[196:199], v[28:31]
  s_waitcnt lgkmcnt(4)
  v_mfma_f32_16x16x32_bf16 v[16:19], v[48:51], v[120:123], v[16:19]
  ds_read_b128 v[40:43], v3 offset:18432
  v_mfma_f32_16x16x32_bf16 v[24:27], v[48:51], v[200:203], v[24:27]
  ds_read_b128 v[44:47], v3 offset:19456
  v_mfma_f32_16x16x32_bf16 v[20:23], v[52:55], v[120:123], v[20:23]
  v_mfma_f32_16x16x32_bf16 v[28:31], v[52:55], v[200:203], v[28:31]
  s_waitcnt lgkmcnt(4)
  v_mfma_f32_16x16x32_bf16 v[16:19], v[56:59], v[124:127], v[16:19]
  ds_read_b128 v[48:51], v3 offset:20480
  v_mfma_f32_16x16x32_bf16 v[24:27], v[56:59], v[204:207], v[24:27]
  ds_read_b128 v[52:55], v3 offset:21504
  v_mfma_f32_16x16x32_bf16 v[20:23], v[60:63], v[124:127], v[20:23]
  v_mfma_f32_16x16x32_bf16 v[28:31], v[60:63], v[204:207], v[28:31]
  s_waitcnt lgkmcnt(4)
  v_mfma_f32_16x16x32_bf16 v[16:19], v[32:35], v[128:131], v[16:19]
  ds_read_b128 v[56:59], v3 offset:22528
  v_mfma_f32_16x16x32_bf16 v[24:27], v[32:35], v[208:211], v[24:27]
  ds_read_b128 v[60:63], v3 offset:23552
  v_mfma_f32_16x16x32_bf16 v[20:23], v[36:39], v[128:131], v[20:23]
  v_mfma_f32_16x16x32_bf16 v[28:31], v[36:39], v[208:211], v[28:31]
  s_waitcnt lgkmcnt(4)
  v_mfma_f32_16x16x32_bf16 v[16:19], v[40:43], v[132:135], v[16:19]
  ds_read_b128 v[32:35], v3 offset:24576
  v_mfma_f32_16x16x32_bf16 v[24:27], v[40:43], v[212:215], v[24:27]
  ds_read_b128 v[36:39], v3 offset:25600
  v_mfma_f32_16x16x32_bf16 v[20:23], v[44:47], v[132:135], v[20:23]
  v_mfma_f32_16x16x32_bf16 v[28:31], v[44:47], v[212:215], v[28:31]
  s_waitcnt lgkmcnt(4)
  v_mfma_f32_16x16x32_bf16 v[16:19], v[48:51], v[136:139], v[16:19]
  ds_read_b128 v[40:43], v3 offset:26624
  v_mfma_f32_16x16x32_bf16 v[24:27], v[48:51], v[216:219], v[24:27]
  ds_read_b128 v[44:47], v3 offset:27648
  v_mfma_f32_16x16x32_bf16 v[20:23], v[52:55], v[136:139], v[20:23]
  v_mfma_f32_16x16x32_bf16 v[28:31], v[52:55], v[216:219], v[28:31]
  s_waitcnt lgkmcnt(4)
  v_mfma_f32_16x16x32_bf16 v[16:19], v[56:59], v[140:143], v[16:19]
  ds_read_b128 v[48:51], v3 offset:28672
  v_mfma_f32_16x16x32_bf16 v[24:27], v[56:59], v[220:223], v[24:27]
  ds_read_b128 v[52:55], v3 offset:29696
  v_mfma_f32_16x16x32_bf16 v[20:23], v[60:63], v[140:143], v[20:23]
  v_mfma_f32_16x16x32_bf16 v[28:31], v[60:63], v[220:223], v[28:31]
  s_waitcnt lgkmcnt(4)
  v_mfma_f32_16x16x32_bf16 v[16:19], v[32:35], v[144:147], v[16:19]
  ds_read_b128 v[56:59], v3 offset:30720
  v_mfma_f32_16x16x32_bf16 v[24:27], v[32:35], v[224:227], v[24:27]
  ds_read_b128 v[60:63], v3 offset:31744
  v_mfma_f32_16x16x32_bf16 v[20:23], v[36:39], v[144:147], v[20:23]
  v_mfma_f32_16x16x32_bf16 v[28:31], v[36:39], v[224:227], v[28:31]
  s_waitcnt lgkmcnt(4)
  v_mfma_f32_16x16x32_bf16 v[16:19], v[40:43], v[148:151], v[16:19]
  ds_read_b128 v[32:35], v3 offset:32768
  v_mfma_f32_16x16x32_bf16 v[24:27], v[40:43], v[228:231], v[24:27]
  ds_read_b128 v[36:39], v3 offset:33792
  v_mfma_f32_16x16x32_bf16 v[20:23], v[44:47], v[148:151], v[20:23]
  v_mfma_f32_16x16x32_bf16 v[28:31], v[44:47], v[228:231], v[28:31]
  s_waitcnt lgkmcnt(4)
  v_mfma_f32_16x16x32_bf16 v[16:19], v[48:51], v[152:155], v[16:19]
  ds_read_b128 v[40:43], v3 offset:34816
  v_mfma_f32_16x16x32_bf16 v[24:27], v[48:51], v[232:235], v[24:27]
  ds_read_b128 v[44:47], v3 offset:35840
  v_mfma_f32_16x16x32_bf16 v[20:23], v[52:55], v[152:155], v[20:23]
  v_mfma_f32_16x16x32_bf16 v[28:31], v[52:55], v[232:235], v[28:31]
  s_waitcnt lgkmcnt(4)
  v_mfma_f32_16x16x32_bf16 v[16:19], v[56:59], v[156:159], v[16:19]
  ds_read_b128 v[48:51], v3 offset:36864
  v_mfma_f32_16x16x32_bf16 v[24:27], v[56:59], v[236:239], v[24:27]
  ds_read_b128 v[52:55], v3 offset:37888
  v_mfma_f32_16x16x32_bf16 v[20:23], v[60:63], v[156:159], v[20:23]
  v_mfma_f32_16x16x32_bf16 v[28:31], v[60:63], v[236:239], v[28:31]
  s_waitcnt lgkmcnt(4)
  v_mfma_f32_16x16x32_bf16 v[16:19], v[32:35], v[160:163], v[16:19]
  ds_read_b128 v[56:59], v3 offset:38912
  v_mfma_f32_16x16x32_bf16 v[24:27], v[32:35], v[240:243], v[24:27]
  ds_read_b128 v[60:63], v3 offset:39936
  v_mfma_f32_16x16x32_bf16 v[20:23], v[36:39], v[160:163], v[20:23]
  v_mfma_f32_16x16x32_bf16 v[28:31], v[36:39], v[240:243], v[28:31]
  s_waitcnt lgkmcnt(4)
  v_mfma_f32_16x16x32_bf16 v[16:19], v[40:43], v[164:167], v[16:19]
  v_mfma_f32_16x16x32_bf16 v[24:27], v[40:43], v[244:247], v[24:27]
  v_mfma_f32_16x16x32_bf16 v[20:23], v[44:47], v[164:167], v[20:23]
  v_mfma_f32_16x16x32_bf16 v[28:31], v[44:47], v[244:247], v[28:31]
  s_waitcnt lgkmcnt(2)
  v_mfma_f32_16x16x32_bf16 v[16:19], v[48:51], v[168:171], v[16:19]
  v_mfma_f32_16x16x32_bf16 v[24:27], v[48:51], v[248:251], v[24:27]
  v_mfma_f32_16x16x32_bf16 v[20:23], v[52:55], v[168:171], v[20:23]
  v_mfma_f32_16x16x32_bf16 v[28:31], v[52:55], v[248:251], v[28:31]
  s_waitcnt lgkmcnt(0)
  v_mfma_f32_16x16x32_bf16 v[16:19], v[56:59], v[172:175], v[16:19]
  v_mfma_f32_16x16x32_bf16 v[24:27], v[56:59], v[252:255], v[24:27]
  v_mfma_f32_16x16x32_bf16 v[20:23], v[60:63], v[172:175], v[20:23]
  v_mfma_f32_16x16x32_bf16 v[28:31], v[60:63], v[252:255], v[28:31]
  s_mov_b32 s38, s30
  s_mov_b32 s30, s31
  s_mov_b32 s31, s32
  s_mov_b32 s32, s38
  s_add_u32 s22, s22, 1
  s_waitcnt vmcnt(0)
  v_add_u32 v3, s30, v2
  s_barrier
  ds_read_b128 v[32:35], v3 offset:0
  ds_read_b128 v[36:39], v3 offset:1024
  ds_read_b128 v[40:43], v3 offset:2048
  ds_read_b128 v[44:47], v3 offset:3072
  ds_read_b128 v[48:51], v3 offset:4096
  ds_read_b128 v[52:55], v3 offset:5120
  v_cvt_pk_bf16_f32 v64, v16, v17
  v_cvt_pk_bf16_f32 v65, v18, v19
  v_cvt_pk_bf16_f32 v66, v20, v21
  v_cvt_pk_bf16_f32 v67, v22, v23
  buffer_store_dwordx4 v[64:67], v2, s[4:7], s29 offen offset:0 sc1
  v_cvt_pk_bf16_f32 v68, v24, v25
  v_cvt_pk_bf16_f32 v69, v26, v27
  v_cvt_pk_bf16_f32 v70, v28, v29
  v_cvt_pk_bf16_f32 v71, v30, v31
  buffer_store_dwordx4 v[68:71], v2, s[4:7], s29 offen offset:1024 sc1
  s_add_u32 s29, s29, 786432
  s_waitcnt lgkmcnt(4)
  v_mfma_f32_16x16x32_bf16 v[16:19], v[32:35], v[96:99], 0
  ds_read_b128 v[56:59], v3 offset:6144
  v_mfma_f32_16x16x32_bf16 v[24:27], v[32:35], v[176:179], 0
  ds_read_b128 v[60:63], v3 offset:7168
  v_mfma_f32_16x16x32_bf16 v[20:23], v[36:39], v[96:99], 0
  v_mfma_f32_16x16x32_bf16 v[28:31], v[36:39], v[176:179], 0
  s_waitcnt lgkmcnt(4)
  v_mfma_f32_16x16x32_bf16 v[16:19], v[40:43], v[100:103], v[16:19]
  ds_read_b128 v[32:35], v3 offset:8192
  v_mfma_f32_16x16x32_bf16 v[24:27], v[40:43], v[180:183], v[24:27]
  ds_read_b128 v[36:39], v3 offset:9216
  v_mfma_f32_16x16x32_bf16 v[20:23], v[44:47], v[100:103], v[20:23]
  v_mfma_f32_16x16x32_bf16 v[28:31], v[44:47], v[180:183], v[28:31]
  s_waitcnt lgkmcnt(4)
  v_mfma_f32_16x16x32_bf16 v[16:19], v[48:51], v[104:107], v[16:19]
  ds_read_b128 v[40:43], v3 offset:10240
  v_mfma_f32_16x16x32_bf16 v[24:27], v[48:51], v[184:187], v[24:27]
  ds_read_b128 v[44:47], v3 offset:11264
  v_mfma_f32_16x16x32_bf16 v[20:23], v[52:55], v[104:107], v[20:23]
  v_mfma_f32_16x16x32_bf16 v[28:31], v[52:55], v[184:187], v[28:31]
  s_waitcnt lgkmcnt(4)
  v_mfma_f32_16x16x32_bf16 v[16:19], v[56:59], v[108:111], v[16:19]
  ds_read_b128 v[48:51], v3 offset:12288
  v_mfma_f32_16x16x32_bf16 v[24:27], v[56:59], v[188:191], v[24:27]
  ds_read_b128 v[52:55], v3 offset:13312
  v_mfma_f32_16x16x32_bf16 v[20:23], v[60:63], v[108:111], v[20:23]
  v_mfma_f32_16x16x32_bf16 v[28:31], v[60:63], v[188:191], v[28:31]
  s_waitcnt lgkmcnt(4)
  v_mfma_f32_16x16x32_bf16 v[16:19], v[32:35], v[112:115], v[16:19]
  ds_read_b128 v[56:59], v3 offset:14336
  v_mfma_f32_16x16x32_bf16 v[24:27], v[32:35], v[192:195], v[24:27]
  ds_read_b128 v[60:63], v3 offset:15360
  v_mfma_f32_16x16x32_bf16 v[20:23], v[36:39], v[112:115], v[20:23]
  v_mfma_f32_16x16x32_bf16 v[28:31], v[36:39], v[192:195], v[28:31]
  s_waitcnt lgkmcnt(4)
  v_mfma_f32_16x16x32_bf16 v[16:19], v[40:43], v[116:119], v[16:19]
  ds_read_b128 v[32:35], v3 offset:16384
  v_mfma_f32_16x16x32_bf16 v[24:27], v[40:43], v[196:199], v[24:27]
  ds_read_b128 v[36:39], v3 offset:17408
  v_mfma_f32_16x16x32_bf16 v[20:23], v[44:47], v[116:119], v[20:23]
  v_mfma_f32_16x16x32_bf16 v[28:31], v[44:47], v[196:199], v[28:31]
  s_waitcnt lgkmcnt(4)
  v_mfma_f32_16x16x32_bf16 v[16:19], v[48:51], v[120:123], v[16:19]
  ds_read_b128 v[40:43], v3 offset:18432
  v_mfma_f32_16x16x32_bf16 v[24:27], v[48:51], v[200:203], v[24:27]
  ds_read_b128 v[44:47], v3 offset:19456
  v_mfma_f32_16x16x32_bf16 v[20:23], v[52:55], v[120:123], v[20:23]
  v_mfma_f32_16x16x32_bf16 v[28:31], v[52:55], v[200:203], v[28:31]
  s_waitcnt lgkmcnt(4)
  v_mfma_f32_16x16x32_bf16 v[16:19], v[56:59], v[124:127], v[16:19]
  ds_read_b128 v[48:51], v3 offset:20480
  v_mfma_f32_16x16x32_bf16 v[24:27], v[56:59], v[204:207], v[24:27]
  ds_read_b128 v[52:55], v3 offset:21504
  v_mfma_f32_16x16x32_bf16 v[20:23], v[60:63], v[124:127], v[20:23]
  v_mfma_f32_16x16x32_bf16 v[28:31], v[60:63], v[204:207], v[28:31]
  s_waitcnt vmcnt(0)
  s_barrier
  v_mov_b32 v6, 1
  buffer_store_dword v6, v4, s[4:7], 0 offen sc1
  s_cmp_lt_u32 s20, 4
  s_cbranch_scc0 Lao_34
  s_add_u32 m0, s31, s35
  s_add_u32 s38, s28, 4096
  s_add_u32 s39, s28, 8192
  buffer_load_dwordx4 v2, s[4:7], s28 offen offset:0 sc1 lds
  buffer_load_dwordx4 v2, s[4:7], s28 offen offset:1024 sc1 lds
  buffer_load_dwordx4 v2, s[4:7], s28 offen offset:2048 sc1 lds
  buffer_load_dwordx4 v2, s[4:7], s28 offen offset:3072 sc1 lds
  s_add_u32 m0, m0, 4096
  s_nop 0
  buffer_load_dwordx4 v2, s[4:7], s38 offen offset:0 sc1 lds
  buffer_load_dwordx4 v2, s[4:7], s38 offen offset:1024 sc1 lds
  buffer_load_dwordx4 v2, s[4:7], s38 offen offset:2048 sc1 lds
  buffer_load_dwordx4 v2, s[4:7], s38 offen offset:3072 sc1 lds
  s_add_u32 m0, m0, 4096
  s_nop 0
  buffer_load_dwordx4 v2, s[4:7], s39 offen offset:0 sc1 lds
  buffer_load_dwordx4 v2, s[4:7], s39 offen offset:1024 sc1 lds
  s_add_u32 s28, s28, 40960
Lao_34:
  s_waitcnt lgkmcnt(4)
  v_mfma_f32_16x16x32_bf16 v[16:19], v[32:35], v[128:131], v[16:19]
  ds_read_b128 v[56:59], v3 offset:22528
  v_mfma_f32_16x16x32_bf16 v[24:27], v[32:35], v[208:211], v[24:27]
  ds_read_b128 v[60:63], v3 offset:23552
  v_mfma_f32_16x16x32_bf16 v[20:23], v[36:39], v[128:131], v[20:23]
  v_mfma_f32_16x16x32_bf16 v[28:31], v[36:39], v[208:211], v[28:31]
  s_waitcnt lgkmcnt(4)
  v_mfma_f32_16x16x32_bf16 v[16:19], v[40:43], v[132:135], v[16:19]
  ds_read_b128 v[32:35], v3 offset:24576
  v_mfma_f32_16x16x32_bf16 v[24:27], v[40:43], v[212:215], v[24:27]
  ds_read_b128 v[36:39], v3 offset:25600
  v_mfma_f32_16x16x32_bf16 v[20:23], v[44:47], v[132:135], v[20:23]
  v_mfma_f32_16x16x32_bf16 v[28:31], v[44:47], v[212:215], v[28:31]
  s_waitcnt lgkmcnt(4)
  v_mfma_f32_16x16x32_bf16 v[16:19], v[48:51], v[136:139], v[16:19]
  ds_read_b128 v[40:43], v3 offset:26624
  v_mfma_f32_16x16x32_bf16 v[24:27], v[48:51], v[216:219], v[24:27]
  ds_read_b128 v[44:47], v3 offset:27648
  v_mfma_f32_16x16x32_bf16 v[20:23], v[52:55], v[136:139], v[20:23]
  v_mfma_f32_16x16x32_bf16 v[28:31], v[52:55], v[216:219], v[28:31]
  s_waitcnt lgkmcnt(4)
  v_mfma_f32_16x16x32_bf16 v[16:19], v[56:59], v[140:143], v[16:19]
  ds_read_b128 v[48:51], v3 offset:28672
  v_mfma_f32_16x16x32_bf16 v[24:27], v[56:59], v[220:223], v[24:27]
  ds_read_b128 v[52:55], v3 offset:29696
  v_mfma_f32_16x16x32_bf16 v[20:23], v[60:63], v[140:143], v[20:23]
  v_mfma_f32_16x16x32_bf16 v[28:31], v[60:63], v[220:223], v[28:31]
  s_waitcnt lgkmcnt(4)
  v_mfma_f32_16x16x32_bf16 v[16:19], v[32:35], v[144:147], v[16:19]
  ds_read_b128 v[56:59], v3 offset:30720
  v_mfma_f32_16x16x32_bf16 v[24:27], v[32:35], v[224:227], v[24:27]
  ds_read_b128 v[60:63], v3 offset:31744
  v_mfma_f32_16x16x32_bf16 v[20:23], v[36:39], v[144:147], v[20:23]
  v_mfma_f32_16x16x32_bf16 v[28:31], v[36:39], v[224:227], v[28:31]
  s_waitcnt lgkmcnt(4)
  v_mfma_f32_16x16x32_bf16 v[16:19], v[40:43], v[148:151], v[16:19]
  ds_read_b128 v[32:35], v3 offset:32768
  v_mfma_f32_16x16x32_bf16 v[24:27], v[40:43], v[228:231], v[24:27]
  ds_read_b128 v[36:39], v3 offset:33792
  v_mfma_f32_16x16x32_bf16 v[20:23], v[44:47], v[148:151], v[20:23]
  v_mfma_f32_16x16x32_bf16 v[28:31], v[44:47], v[228:231], v[28:31]
  s_waitcnt lgkmcnt(4)
  v_mfma_f32_16x16x32_bf16 v[16:19], v[48:51], v[152:155], v[16:19]
  ds_read_b128 v[40:43], v3 offset:34816
  v_mfma_f32_16x16x32_bf16 v[24:27], v[48:51], v[232:235], v[24:27]
  ds_read_b128 v[44:47], v3 offset:35840
  v_mfma_f32_16x16x32_bf16 v[20:23], v[52:55], v[152:155], v[20:23]
  v_mfma_f32_16x16x32_bf16 v[28:31], v[52:55], v[232:235], v[28:31]
  s_waitcnt lgkmcnt(4)
  v_mfma_f32_16x16x32_bf16 v[16:19], v[56:59], v[156:159], v[16:19]
  ds_read_b128 v[48:51], v3 offset:36864
  v_mfma_f32_16x16x32_bf16 v[24:27], v[56:59], v[236:239], v[24:27]
  ds_read_b128 v[52:55], v3 offset:37888
  v_mfma_f32_16x16x32_bf16 v[20:23], v[60:63], v[156:159], v[20:23]
  v_mfma_f32_16x16x32_bf16 v[28:31], v[60:63], v[236:239], v[28:31]
  s_waitcnt lgkmcnt(4)
  v_mfma_f32_16x16x32_bf16 v[16:19], v[32:35], v[160:163], v[16:19]
  ds_read_b128 v[56:59], v3 offset:38912
  v_mfma_f32_16x16x32_bf16 v[24:27], v[32:35], v[240:243], v[24:27]
  ds_read_b128 v[60:63], v3 offset:39936
  v_mfma_f32_16x16x32_bf16 v[20:23], v[36:39], v[160:163], v[20:23]
  v_mfma_f32_16x16x32_bf16 v[28:31], v[36:39], v[240:243], v[28:31]
  s_waitcnt lgkmcnt(4)
  v_mfma_f32_16x16x32_bf16 v[16:19], v[40:43], v[164:167], v[16:19]
  v_mfma_f32_16x16x32_bf16 v[24:27], v[40:43], v[244:247], v[24:27]
  v_mfma_f32_16x16x32_bf16 v[20:23], v[44:47], v[164:167], v[20:23]
  v_mfma_f32_16x16x32_bf16 v[28:31], v[44:47], v[244:247], v[28:31]
  s_waitcnt lgkmcnt(2)
  v_mfma_f32_16x16x32_bf16 v[16:19], v[48:51], v[168:171], v[16:19]
  v_mfma_f32_16x16x32_bf16 v[24:27], v[48:51], v[248:251], v[24:27]
  v_mfma_f32_16x16x32_bf16 v[20:23], v[52:55], v[168:171], v[20:23]
  v_mfma_f32_16x16x32_bf16 v[28:31], v[52:55], v[248:251], v[28:31]
  s_waitcnt lgkmcnt(0)
  v_mfma_f32_16x16x32_bf16 v[16:19], v[56:59], v[172:175], v[16:19]
  v_mfma_f32_16x16x32_bf16 v[24:27], v[56:59], v[252:255], v[24:27]
  v_mfma_f32_16x16x32_bf16 v[20:23], v[60:63], v[172:175], v[20:23]
  v_mfma_f32_16x16x32_bf16 v[28:31], v[60:63], v[252:255], v[28:31]
  s_mov_b32 s38, s30
  s_mov_b32 s30, s31
  s_mov_b32 s31, s32
  s_mov_b32 s32, s38
  s_add_u32 s22, s22, 1
  v_cvt_pk_bf16_f32 v64, v16, v17
  v_cvt_pk_bf16_f32 v65, v18, v19
  v_cvt_pk_bf16_f32 v66, v20, v21
  v_cvt_pk_bf16_f32 v67, v22, v23
  buffer_store_dwordx4 v[64:67], v2, s[4:7], s29 offen offset:0 sc1
  v_cvt_pk_bf16_f32 v68, v24, v25
  v_cvt_pk_bf16_f32 v69, v26, v27
  v_cvt_pk_bf16_f32 v70, v28, v29
  v_cvt_pk_bf16_f32 v71, v30, v31
  buffer_store_dwordx4 v[68:71], v2, s[4:7], s29 offen offset:1024 sc1
  s_add_u32 s29, s29, 786432
  s_waitcnt vmcnt(0)
  s_cmp_lt_u32 s20, 4
  s_cbranch_scc0 Lpb0_30
  s_setprio 1
  s_waitcnt vmcnt(0)
Lpa_28:
  v_add_u32 v3, s30, v2
  s_barrier
  ds_read_b128 v[32:35], v3 offset:0
  ds_read_b128 v[36:39], v3 offset:1024
  ds_read_b128 v[40:43], v3 offset:2048
  ds_read_b128 v[44:47], v3 offset:3072
  ds_read_b128 v[48:51], v3 offset:4096
  ds_read_b128 v[52:55], v3 offset:5120
  s_sub_u32 s40, s22, 1
  s_max_i32 s40, s40, 2
  v_mov_b32 v6, s40
  buffer_store_dword v6, v4, s[4:7], 0 offen sc1
  s_cmp_eq_u32 s22, 63
  s_cbranch_scc1 Lpnd_33
  s_add_u32 m0, s31, s35
  s_add_u32 s38, s28, 4096
  s_add_u32 s39, s28, 8192
  buffer_load_dwordx4 v2, s[4:7], s28 offen offset:0 sc1 lds
  buffer_load_dwordx4 v2, s[4:7], s28 offen offset:1024 sc1 lds
  buffer_load_dwordx4 v2, s[4:7], s28 offen offset:2048 sc1 lds
  buffer_load_dwordx4 v2, s[4:7], s28 offen offset:3072 sc1 lds
  s_add_u32 m0, m0, 4096
  s_nop 0
  buffer_load_dwordx4 v2, s[4:7], s38 offen offset:0 sc1 lds
  buffer_load_dwordx4 v2, s[4:7], s38 offen offset:1024 sc1 lds
  buffer_load_dwordx4 v2, s[4:7], s38 offen offset:2048 sc1 lds
  buffer_load_dwordx4 v2, s[4:7], s38 offen offset:3072 sc1 lds
  s_add_u32 m0, m0, 4096
  s_nop 0
  buffer_load_dwordx4 v2, s[4:7], s39 offen offset:0 sc1 lds
  buffer_load_dwordx4 v2, s[4:7], s39 offen offset:1024 sc1 lds
  s_add_u32 s28, s28, 40960
Lpnd_33:
  s_waitcnt lgkmcnt(4)
  v_mfma_f32_16x16x32_bf16 v[16:19], v[32:35], v[96:99], 0
  ds_read_b128 v[56:59], v3 offset:6144
  v_mfma_f32_16x16x32_bf16 v[24:27], v[32:35], v[176:179], 0
  ds_read_b128 v[60:63], v3 offset:7168
  v_mfma_f32_16x16x32_bf16 v[20:23], v[36:39], v[96:99], 0
  v_mfma_f32_16x16x32_bf16 v[28:31], v[36:39], v[176:179], 0
  s_waitcnt lgkmcnt(4)
  v_mfma_f32_16x16x32_bf16 v[16:19], v[40:43], v[100:103], v[16:19]
  ds_read_b128 v[32:35], v3 offset:8192
  v_mfma_f32_16x16x32_bf16 v[24:27], v[40:43], v[180:183], v[24:27]
  ds_read_b128 v[36:39], v3 offset:9216
  v_mfma_f32_16x16x32_bf16 v[20:23], v[44:47], v[100:103], v[20:23]
  v_mfma_f32_16x16x32_bf16 v[28:31], v[44:47], v[180:183], v[28:31]
  s_waitcnt lgkmcnt(4)
  v_mfma_f32_16x16x32_bf16 v[16:19], v[48:51], v[104:107], v[16:19]
  ds_read_b128 v[40:43], v3 offset:10240
  v_mfma_f32_16x16x32_bf16 v[24:27], v[48:51], v[184:187], v[24:27]
  ds_read_b128 v[44:47], v3 offset:11264
  v_mfma_f32_16x16x32_bf16 v[20:23], v[52:55], v[104:107], v[20:23]
  v_mfma_f32_16x16x32_bf16 v[28:31], v[52:55], v[184:187], v[28:31]
  s_waitcnt lgkmcnt(4)
  v_mfma_f32_16x16x32_bf16 v[16:19], v[56:59], v[108:111], v[16:19]
  ds_read_b128 v[48:51], v3 offset:12288
  v_mfma_f32_16x16x32_bf16 v[24:27], v[56:59], v[188:191], v[24:27]
  ds_read_b128 v[52:55], v3 offset:13312
  v_mfma_f32_16x16x32_bf16 v[20:23], v[60:63], v[108:111], v[20:23]
  v_mfma_f32_16x16x32_bf16 v[28:31], v[60:63], v[188:191], v[28:31]
  s_waitcnt lgkmcnt(4)
  v_mfma_f32_16x16x32_bf16 v[16:19], v[32:35], v[112:115], v[16:19]
  ds_read_b128 v[56:59], v3 offset:14336
  v_mfma_f32_16x16x32_bf16 v[24:27], v[32:35], v[192:195], v[24:27]
  ds_read_b128 v[60:63], v3 offset:15360
  v_mfma_f32_16x16x32_bf16 v[20:23], v[36:39], v[112:115], v[20:23]
  v_mfma_f32_16x16x32_bf16 v[28:31], v[36:39], v[192:195], v[28:31]
  s_waitcnt lgkmcnt(4)
  v_mfma_f32_16x16x32_bf16 v[16:19], v[40:43], v[116:119], v[16:19]
  ds_read_b128 v[32:35], v3 offset:16384
  v_mfma_f32_16x16x32_bf16 v[24:27], v[40:43], v[196:199], v[24:27]
  ds_read_b128 v[36:39], v3 offset:17408
  v_mfma_f32_16x16x32_bf16 v[20:23], v[44:47], v[116:119], v[20:23]
  v_mfma_f32_16x16x32_bf16 v[28:31], v[44:47], v[196:199], v[28:31]
  s_waitcnt lgkmcnt(4)
  v_mfma_f32_16x16x32_bf16 v[16:19], v[48:51], v[120:123], v[16:19]
  ds_read_b128 v[40:43], v3 offset:18432
  v_mfma_f32_16x16x32_bf16 v[24:27], v[48:51], v[200:203], v[24:27]
  ds_read_b128 v[44:47], v3 offset:19456
  v_mfma_f32_16x16x32_bf16 v[20:23], v[52:55], v[120:123], v[20:23]
  v_mfma_f32_16x16x32_bf16 v[28:31], v[52:55], v[200:203], v[28:31]
  s_waitcnt lgkmcnt(4)
  v_mfma_f32_16x16x32_bf16 v[16:19], v[56:59], v[124:127], v[16:19]
  ds_read_b128 v[48:51], v3 offset:20480
  v_mfma_f32_16x16x32_bf16 v[24:27], v[56:59], v[204:207], v[24:27]
  ds_read_b128 v[52:55], v3 offset:21504
  v_mfma_f32_16x16x32_bf16 v[20:23], v[60:63], v[124:127], v[20:23]
  v_mfma_f32_16x16x32_bf16 v[28:31], v[60:63], v[204:207], v[28:31]
  s_waitcnt lgkmcnt(4)
  v_mfma_f32_16x16x32_bf16 v[16:19], v[32:35], v[128:131], v[16:19]
  ds_read_b128 v[56:59], v3 offset:22528
  v_mfma_f32_16x16x32_bf16 v[24:27], v[32:35], v[208:211], v[24:27]
  ds_read_b128 v[60:63], v3 offset:23552
  v_mfma_f32_16x16x32_bf16 v[20:23], v[36:39], v[128:131], v[20:23]
  v_mfma_f32_16x16x32_bf16 v[28:31], v[36:39], v[208:211], v[28:31]
  s_waitcnt lgkmcnt(4)
  v_mfma_f32_16x16x32_bf16 v[16:19], v[40:43], v[132:135], v[16:19]
  ds_read_b128 v[32:35], v3 offset:24576
  v_mfma_f32_16x16x32_bf16 v[24:27], v[40:43], v[212:215], v[24:27]
  ds_read_b128 v[36:39], v3 offset:25600
  v_mfma_f32_16x16x32_bf16 v[20:23], v[44:47], v[132:135], v[20:23]
  v_mfma_f32_16x16x32_bf16 v[28:31], v[44:47], v[212:215], v[28:31]
  s_waitcnt lgkmcnt(4)
  v_mfma_f32_16x16x32_bf16 v[16:19], v[48:51], v[136:139], v[16:19]
  ds_read_b128 v[40:43], v3 offset:26624
  v_mfma_f32_16x16x32_bf16 v[24:27], v[48:51], v[216:219], v[24:27]
  ds_read_b128 v[44:47], v3 offset:27648
  v_mfma_f32_16x16x32_bf16 v[20:23], v[52:55], v[136:139], v[20:23]
  v_mfma_f32_16x16x32_bf16 v[28:31], v[52:55], v[216:219], v[28:31]
  s_waitcnt lgkmcnt(4)
  v_mfma_f32_16x16x32_bf16 v[16:19], v[56:59], v[140:143], v[16:19]
  ds_read_b128 v[48:51], v3 offset:28672
  v_mfma_f32_16x16x32_bf16 v[24:27], v[56:59], v[220:223], v[24:27]
  ds_read_b128 v[52:55], v3 offset:29696
  v_mfma_f32_16x16x32_bf16 v[20:23], v[60:63], v[140:143], v[20:23]
  v_mfma_f32_16x16x32_bf16 v[28:31], v[60:63], v[220:223], v[28:31]
  s_waitcnt lgkmcnt(4)
  v_mfma_f32_16x16x32_bf16 v[16:19], v[32:35], v[144:147], v[16:19]
  ds_read_b128 v[56:59], v3 offset:30720
  v_mfma_f32_16x16x32_bf16 v[24:27], v[32:35], v[224:227], v[24:27]
  ds_read_b128 v[60:63], v3 offset:31744
  v_mfma_f32_16x16x32_bf16 v[20:23], v[36:39], v[144:147], v[20:23]
  v_mfma_f32_16x16x32_bf16 v[28:31], v[36:39], v[224:227], v[28:31]
  s_waitcnt lgkmcnt(4)
  v_mfma_f32_16x16x32_bf16 v[16:19], v[40:43], v[148:151], v[16:19]
  ds_read_b128 v[32:35], v3 offset:32768
  v_mfma_f32_16x16x32_bf16 v[24:27], v[40:43], v[228:231], v[24:27]
  ds_read_b128 v[36:39], v3 offset:33792
  v_mfma_f32_16x16x32_bf16 v[20:23], v[44:47], v[148:151], v[20:23]
  v_mfma_f32_16x16x32_bf16 v[28:31], v[44:47], v[228:231], v[28:31]
  s_waitcnt lgkmcnt(4)
  v_mfma_f32_16x16x32_bf16 v[16:19], v[48:51], v[152:155], v[16:19]
  ds_read_b128 v[40:43], v3 offset:34816
  v_mfma_f32_16x16x32_bf16 v[24:27], v[48:51], v[232:235], v[24:27]
  ds_read_b128 v[44:47], v3 offset:35840
  v_mfma_f32_16x16x32_bf16 v[20:23], v[52:55], v[152:155], v[20:23]
  v_mfma_f32_16x16x32_bf16 v[28:31], v[52:55], v[232:235], v[28:31]
  s_waitcnt lgkmcnt(4)
  v_mfma_f32_16x16x32_bf16 v[16:19], v[56:59], v[156:159], v[16:19]
  ds_read_b128 v[48:51], v3 offset:36864
  v_mfma_f32_16x16x32_bf16 v[24:27], v[56:59], v[236:239], v[24:27]
  ds_read_b128 v[52:55], v3 offset:37888
  v_mfma_f32_16x16x32_bf16 v[20:23], v[60:63], v[156:159], v[20:23]
  v_mfma_f32_16x16x32_bf16 v[28:31], v[60:63], v[236:239], v[28:31]
  s_waitcnt lgkmcnt(4)
  v_mfma_f32_16x16x32_bf16 v[16:19], v[32:35], v[160:163], v[16:19]
  ds_read_b128 v[56:59], v3 offset:38912
  v_mfma_f32_16x16x32_bf16 v[24:27], v[32:35], v[240:243], v[24:27]
  ds_read_b128 v[60:63], v3 offset:39936
  v_mfma_f32_16x16x32_bf16 v[20:23], v[36:39], v[160:163], v[20:23]
  v_mfma_f32_16x16x32_bf16 v[28:31], v[36:39], v[240:243], v[28:31]
  s_waitcnt lgkmcnt(4)
  v_mfma_f32_16x16x32_bf16 v[16:19], v[40:43], v[164:167], v[16:19]
  v_mfma_f32_16x16x32_bf16 v[24:27], v[40:43], v[244:247], v[24:27]
  v_mfma_f32_16x16x32_bf16 v[20:23], v[44:47], v[164:167], v[20:23]
  v_mfma_f32_16x16x32_bf16 v[28:31], v[44:47], v[244:247], v[28:31]
  s_waitcnt lgkmcnt(2)
  v_mfma_f32_16x16x32_bf16 v[16:19], v[48:51], v[168:171], v[16:19]
  v_mfma_f32_16x16x32_bf16 v[24:27], v[48:51], v[248:251], v[24:27]
  v_mfma_f32_16x16x32_bf16 v[20:23], v[52:55], v[168:171], v[20:23]
  v_mfma_f32_16x16x32_bf16 v[28:31], v[52:55], v[248:251], v[28:31]
  s_waitcnt lgkmcnt(0)
  v_mfma_f32_16x16x32_bf16 v[16:19], v[56:59], v[172:175], v[16:19]
  v_mfma_f32_16x16x32_bf16 v[24:27], v[56:59], v[252:255], v[24:27]
  v_mfma_f32_16x16x32_bf16 v[20:23], v[60:63], v[172:175], v[20:23]
  v_mfma_f32_16x16x32_bf16 v[28:31], v[60:63], v[252:255], v[28:31]
  s_mov_b32 s38, s30
  s_mov_b32 s30, s31
  s_mov_b32 s31, s32
  s_mov_b32 s32, s38
  s_add_u32 s22, s22, 1
  s_waitcnt vmcnt(0)
  v_cvt_pk_bf16_f32 v64, v16, v17
  v_cvt_pk_bf16_f32 v65, v18, v19
  v_cvt_pk_bf16_f32 v66, v20, v21
  v_cvt_pk_bf16_f32 v67, v22, v23
  buffer_store_dwordx4 v[64:67], v2, s[4:7], s29 offen offset:0 sc1
  v_cvt_pk_bf16_f32 v68, v24, v25
  v_cvt_pk_bf16_f32 v69, v26, v27
  v_cvt_pk_bf16_f32 v70, v28, v29
  v_cvt_pk_bf16_f32 v71, v30, v31
  buffer_store_dwordx4 v[68:71], v2, s[4:7], s29 offen offset:1024 sc1
  s_add_u32 s29, s29, 786432
  s_cmp_lt_u32 s22, 64
  s_cbranch_scc1 Lpa_28
  s_barrier
  v_mov_b32 v6, 63
  buffer_store_dword v6, v4, s[4:7], 0 offen sc1
  s_waitcnt vmcnt(0)
  s_barrier
  v_mov_b32 v6, 64
  buffer_store_dword v6, v4, s[4:7], 0 offen sc1
  s_branch Lw_help
Lpb0_30:
  s_barrier
  v_add_u32 v3, s30, v2
  ds_read_b128 v[32:35], v3 offset:0
  ds_read_b128 v[36:39], v3 offset:1024
  ds_read_b128 v[40:43], v3 offset:2048
  ds_read_b128 v[44:47], v3 offset:3072
  ds_read_b128 v[48:51], v3 offset:4096
  ds_read_b128 v[52:55], v3 offset:5120
  s_branch Lpb1_31
Lpb_29:
  s_setprio 2
  s_barrier
  s_waitcnt lgkmcnt(4)
  v_mfma_f32_16x16x32_bf16 v[16:19], v[48:51], v[136:139], v[16:19]
  ds_read_b128 v[40:43], v3 offset:26624
  v_mfma_f32_16x16x32_bf16 v[24:27], v[48:51], v[216:219], v[24:27]
  ds_read_b128 v[44:47], v3 offset:27648
  v_mfma_f32_16x16x32_bf16 v[20:23], v[52:55], v[136:139], v[20:23]
  v_mfma_f32_16x16x32_bf16 v[28:31], v[52:55], v[216:219], v[28:31]
  s_waitcnt lgkmcnt(4)
  v_mfma_f32_16x16x32_bf16 v[16:19], v[56:59], v[140:143], v[16:19]
  ds_read_b128 v[48:51], v3 offset:28672
  v_mfma_f32_16x16x32_bf16 v[24:27], v[56:59], v[220:223], v[24:27]
  ds_read_b128 v[52:55], v3 offset:29696
  v_mfma_f32_16x16x32_bf16 v[20:23], v[60:63], v[140:143], v[20:23]
  v_mfma_f32_16x16x32_bf16 v[28:31], v[60:63], v[220:223], v[28:31]
  s_waitcnt lgkmcnt(4)
  v_mfma_f32_16x16x32_bf16 v[16:19], v[32:35], v[144:147], v[16:19]
  ds_read_b128 v[56:59], v3 offset:30720
  v_mfma_f32_16x16x32_bf16 v[24:27], v[32:35], v[224:227], v[24:27]
  ds_read_b128 v[60:63], v3 offset:31744
  v_mfma_f32_16x16x32_bf16 v[20:23], v[36:39], v[144:147], v[20:23]
  v_mfma_f32_16x16x32_bf16 v[28:31], v[36:39], v[224:227], v[28:31]
  s_waitcnt lgkmcnt(4)
  v_mfma_f32_16x16x32_bf16 v[16:19], v[40:43], v[148:151], v[16:19]
  ds_read_b128 v[32:35], v3 offset:32768
  v_mfma_f32_16x16x32_bf16 v[24:27], v[40:43], v[228:231], v[24:27]
  ds_read_b128 v[36:39], v3 offset:33792
  v_mfma_f32_16x16x32_bf16 v[20:23], v[44:47], v[148:151], v[20:23]
  v_mfma_f32_16x16x32_bf16 v[28:31], v[44:47], v[228:231], v[28:31]
  s_waitcnt lgkmcnt(4)
  v_mfma_f32_16x16x32_bf16 v[16:19], v[48:51], v[152:155], v[16:19]
  ds_read_b128 v[40:43], v3 offset:34816
  v_mfma_f32_16x16x32_bf16 v[24:27], v[48:51], v[232:235], v[24:27]
  ds_read_b128 v[44:47], v3 offset:35840
  v_mfma_f32_16x16x32_bf16 v[20:23], v[52:55], v[152:155], v[20:23]
  v_mfma_f32_16x16x32_bf16 v[28:31], v[52:55], v[232:235], v[28:31]
  s_waitcnt lgkmcnt(4)
  v_mfma_f32_16x16x32_bf16 v[16:19], v[56:59], v[156:159], v[16:19]
  ds_read_b128 v[48:51], v3 offset:36864
  v_mfma_f32_16x16x32_bf16 v[24:27], v[56:59], v[236:239], v[24:27]
  ds_read_b128 v[52:55], v3 offset:37888
  v_mfma_f32_16x16x32_bf16 v[20:23], v[60:63], v[156:159], v[20:23]
  v_mfma_f32_16x16x32_bf16 v[28:31], v[60:63], v[236:239], v[28:31]
  s_waitcnt lgkmcnt(4)
  v_mfma_f32_16x16x32_bf16 v[16:19], v[32:35], v[160:163], v[16:19]
  ds_read_b128 v[56:59], v3 offset:38912
  v_mfma_f32_16x16x32_bf16 v[24:27], v[32:35], v[240:243], v[24:27]
  ds_read_b128 v[60:63], v3 offset:39936
  v_mfma_f32_16x16x32_bf16 v[20:23], v[36:39], v[160:163], v[20:23]
  v_mfma_f32_16x16x32_bf16 v[28:31], v[36:39], v[240:243], v[28:31]
  s_waitcnt lgkmcnt(4)
  v_mfma_f32_16x16x32_bf16 v[16:19], v[40:43], v[164:167], v[16:19]
  v_mfma_f32_16x16x32_bf16 v[24:27], v[40:43], v[244:247], v[24:27]
  v_mfma_f32_16x16x32_bf16 v[20:23], v[44:47], v[164:167], v[20:23]
  v_mfma_f32_16x16x32_bf16 v[28:31], v[44:47], v[244:247], v[28:31]
  s_waitcnt lgkmcnt(2)
  v_mfma_f32_16x16x32_bf16 v[16:19], v[48:51], v[168:171], v[16:19]
  v_mfma_f32_16x16x32_bf16 v[24:27], v[48:51], v[248:251], v[24:27]
  v_mfma_f32_16x16x32_bf16 v[20:23], v[52:55], v[168:171], v[20:23]
  v_mfma_f32_16x16x32_bf16 v[28:31], v[52:55], v[248:251], v[28:31]
  s_waitcnt lgkmcnt(0)
  v_mfma_f32_16x16x32_bf16 v[16:19], v[56:59], v[172:175], v[16:19]
  v_mfma_f32_16x16x32_bf16 v[24:27], v[56:59], v[252:255], v[24:27]
  v_mfma_f32_16x16x32_bf16 v[20:23], v[60:63], v[172:175], v[20:23]
  v_mfma_f32_16x16x32_bf16 v[28:31], v[60:63], v[252:255], v[28:31]
  s_mov_b32 s38, s30
  s_mov_b32 s30, s31
  s_mov_b32 s31, s32
  s_mov_b32 s32, s38
  s_add_u32 s22, s22, 1
  s_setprio 0
  s_cmp_eq_u32 s22, 64
  s_cbranch_scc1 Lpbe_32
  v_add_u32 v3, s30, v2
  ds_read_b128 v[32:35], v3 offset:0
  ds_read_b128 v[36:39], v3 offset:1024
  ds_read_b128 v[40:43], v3 offset:2048
  ds_read_b128 v[44:47], v3 offset:3072
  ds_read_b128 v[48:51], v3 offset:4096
  ds_read_b128 v[52:55], v3 offset:5120
  v_cvt_pk_bf16_f32 v64, v16, v17
  v_cvt_pk_bf16_f32 v65, v18, v19
  v_cvt_pk_bf16_f32 v66, v20, v21
  v_cvt_pk_bf16_f32 v67, v22, v23
  buffer_store_dwordx4 v[64:67], v2, s[4:7], s29 offen offset:0 sc1
  v_cvt_pk_bf16_f32 v68, v24, v25
  v_cvt_pk_bf16_f32 v69, v26, v27
  v_cvt_pk_bf16_f32 v70, v28, v29
  v_cvt_pk_bf16_f32 v71, v30, v31
  buffer_store_dwordx4 v[68:71], v2, s[4:7], s29 offen offset:1024 sc1
  s_add_u32 s29, s29, 786432
Lpb1_31:
  s_waitcnt lgkmcnt(4)
  v_mfma_f32_16x16x32_bf16 v[16:19], v[32:35], v[96:99], 0
  ds_read_b128 v[56:59], v3 offset:6144
  v_mfma_f32_16x16x32_bf16 v[24:27], v[32:35], v[176:179], 0
  ds_read_b128 v[60:63], v3 offset:7168
  v_mfma_f32_16x16x32_bf16 v[20:23], v[36:39], v[96:99], 0
  v_mfma_f32_16x16x32_bf16 v[28:31], v[36:39], v[176:179], 0
  s_waitcnt lgkmcnt(4)
  v_mfma_f32_16x16x32_bf16 v[16:19], v[40:43], v[100:103], v[16:19]
  ds_read_b128 v[32:35], v3 offset:8192
  v_mfma_f32_16x16x32_bf16 v[24:27], v[40:43], v[180:183], v[24:27]
  ds_read_b128 v[36:39], v3 offset:9216
  v_mfma_f32_16x16x32_bf16 v[20:23], v[44:47], v[100:103], v[20:23]
  v_mfma_f32_16x16x32_bf16 v[28:31], v[44:47], v[180:183], v[28:31]
  s_waitcnt lgkmcnt(4)
  v_mfma_f32_16x16x32_bf16 v[16:19], v[48:51], v[104:107], v[16:19]
  ds_read_b128 v[40:43], v3 offset:10240
  v_mfma_f32_16x16x32_bf16 v[24:27], v[48:51], v[184:187], v[24:27]
  ds_read_b128 v[44:47], v3 offset:11264
  v_mfma_f32_16x16x32_bf16 v[20:23], v[52:55], v[104:107], v[20:23]
  v_mfma_f32_16x16x32_bf16 v[28:31], v[52:55], v[184:187], v[28:31]
  s_waitcnt lgkmcnt(4)
  v_mfma_f32_16x16x32_bf16 v[16:19], v[56:59], v[108:111], v[16:19]
  ds_read_b128 v[48:51], v3 offset:12288
  v_mfma_f32_16x16x32_bf16 v[24:27], v[56:59], v[188:191], v[24:27]
  ds_read_b128 v[52:55], v3 offset:13312
  v_mfma_f32_16x16x32_bf16 v[20:23], v[60:63], v[108:111], v[20:23]
  v_mfma_f32_16x16x32_bf16 v[28:31], v[60:63], v[188:191], v[28:31]
  s_waitcnt lgkmcnt(4)
  v_mfma_f32_16x16x32_bf16 v[16:19], v[32:35], v[112:115], v[16:19]
  ds_read_b128 v[56:59], v3 offset:14336
  v_mfma_f32_16x16x32_bf16 v[24:27], v[32:35], v[192:195], v[24:27]
  ds_read_b128 v[60:63], v3 offset:15360
  v_mfma_f32_16x16x32_bf16 v[20:23], v[36:39], v[112:115], v[20:23]
  v_mfma_f32_16x16x32_bf16 v[28:31], v[36:39], v[192:195], v[28:31]
  s_waitcnt lgkmcnt(4)
  v_mfma_f32_16x16x32_bf16 v[16:19], v[40:43], v[116:119], v[16:19]
  ds_read_b128 v[32:35], v3 offset:16384
  v_mfma_f32_16x16x32_bf16 v[24:27], v[40:43], v[196:199], v[24:27]
  ds_read_b128 v[36:39], v3 offset:17408
  v_mfma_f32_16x16x32_bf16 v[20:23], v[44:47], v[116:119], v[20:23]
  v_mfma_f32_16x16x32_bf16 v[28:31], v[44:47], v[196:199], v[28:31]
  s_waitcnt lgkmcnt(4)
  v_mfma_f32_16x16x32_bf16 v[16:19], v[48:51], v[120:123], v[16:19]
  ds_read_b128 v[40:43], v3 offset:18432
  v_mfma_f32_16x16x32_bf16 v[24:27], v[48:51], v[200:203], v[24:27]
  ds_read_b128 v[44:47], v3 offset:19456
  v_mfma_f32_16x16x32_bf16 v[20:23], v[52:55], v[120:123], v[20:23]
  v_mfma_f32_16x16x32_bf16 v[28:31], v[52:55], v[200:203], v[28:31]
  s_waitcnt lgkmcnt(4)
  v_mfma_f32_16x16x32_bf16 v[16:19], v[56:59], v[124:127], v[16:19]
  ds_read_b128 v[48:51], v3 offset:20480
  v_mfma_f32_16x16x32_bf16 v[24:27], v[56:59], v[204:207], v[24:27]
  ds_read_b128 v[52:55], v3 offset:21504
  v_mfma_f32_16x16x32_bf16 v[20:23], v[60:63], v[124:127], v[20:23]
  v_mfma_f32_16x16x32_bf16 v[28:31], v[60:63], v[204:207], v[28:31]
  s_waitcnt lgkmcnt(4)
  v_mfma_f32_16x16x32_bf16 v[16:19], v[32:35], v[128:131], v[16:19]
  ds_read_b128 v[56:59], v3 offset:22528
  v_mfma_f32_16x16x32_bf16 v[24:27], v[32:35], v[208:211], v[24:27]
  ds_read_b128 v[60:63], v3 offset:23552
  v_mfma_f32_16x16x32_bf16 v[20:23], v[36:39], v[128:131], v[20:23]
  v_mfma_f32_16x16x32_bf16 v[28:31], v[36:39], v[208:211], v[28:31]
  s_waitcnt lgkmcnt(4)
  v_mfma_f32_16x16x32_bf16 v[16:19], v[40:43], v[132:135], v[16:19]
  ds_read_b128 v[32:35], v3 offset:24576
  v_mfma_f32_16x16x32_bf16 v[24:27], v[40:43], v[212:215], v[24:27]
  ds_read_b128 v[36:39], v3 offset:25600
  v_mfma_f32_16x16x32_bf16 v[20:23], v[44:47], v[132:135], v[20:23]
  v_mfma_f32_16x16x32_bf16 v[28:31], v[44:47], v[212:215], v[28:31]
  s_waitcnt vmcnt(0)
  s_branch Lpb_29
Lpbe_32:
  v_cvt_pk_bf16_f32 v64, v16, v17
  v_cvt_pk_bf16_f32 v65, v18, v19
  v_cvt_pk_bf16_f32 v66, v20, v21
  v_cvt_pk_bf16_f32 v67, v22, v23
  buffer_store_dwordx4 v[64:67], v2, s[4:7], s29 offen offset:0 sc1
  v_cvt_pk_bf16_f32 v68, v24, v25
  v_cvt_pk_bf16_f32 v69, v26, v27
  v_cvt_pk_bf16_f32 v70, v28, v29
  v_cvt_pk_bf16_f32 v71, v30, v31
  buffer_store_dwordx4 v[68:71], v2, s[4:7], s29 offen offset:1024 sc1
  s_add_u32 s29, s29, 786432
  s_waitcnt vmcnt(0)
  s_barrier
  s_branch Lw_help
Lw_qa:
  s_load_dwordx2 s[8:9], s[0:1], 16
  s_mov_b32 s10, 7864320
  s_mov_b32 s11, 0x20000
  s_sub_u32 s18, s17, 12
  s_lshl_b32 s19, s16, 3
  s_add_u32 s19, s19, s18
  s_mul_i32 s34, s19, 384
  s_cmp_lt_u32 s20, 4
  s_cbranch_scc1 Lw_noln
  s_lshl_b32 s40, s19, 2
  s_add_u32 s40, s40, s20
  s_sub_u32 s40, s40, 4
  s_load_dwordx2 s[84:85], s[0:1], 0
  s_mov_b32 s86, 2621440
  s_mov_b32 s87, 0x20000
  v_and_b32 v3, 15, v1
  v_mul_u32_u24 v3, 1280, v3
  v_lshrrev_b32 v4, 4, v1
  v_lshl_add_u32 v3, v4, 4, v3
  s_mul_i32 s38, s40, 20480
  s_waitcnt lgkmcnt(0)
  buffer_load_dwordx4 v[176:179], v3, s[84:87], s38 offen offset:0
  buffer_load_dwordx4 v[180:183], v3, s[84:87], s38 offen offset:64
  buffer_load_dwordx4 v[184:187], v3, s[84:87], s38 offen offset:128
  buffer_load_dwordx4 v[188:191], v3, s[84:87], s38 offen offset:192
  buffer_load_dwordx4 v[192:195], v3, s[84:87], s38 offen offset:256
  buffer_load_dwordx4 v[196:199], v3, s[84:87], s38 offen offset:320
  buffer_load_dwordx4 v[200:203], v3, s[84:87], s38 offen offset:384
  buffer_load_dwordx4 v[204:207], v3, s[84:87], s38 offen offset:448
  buffer_load_dwordx4 v[208:211], v3, s[84:87], s38 offen offset:512
  buffer_load_dwordx4 v[212:215], v3, s[84:87], s38 offen offset:576
  buffer_load_dwordx4 v[216:219], v3, s[84:87], s38 offen offset:640
  buffer_load_dwordx4 v[220:223], v3, s[84:87], s38 offen offset:704
  buffer_load_dwordx4 v[224:227], v3, s[84:87], s38 offen offset:768
  buffer_load_dwordx4 v[228:231], v3, s[84:87], s38 offen offset:832
  buffer_load_dwordx4 v[232:235], v3, s[84:87], s38 offen offset:896
  buffer_load_dwordx4 v[236:239], v3, s[84:87], s38 offen offset:960
  buffer_load_dwordx4 v[240:243], v3, s[84:87], s38 offen offset:1024
  buffer_load_dwordx4 v[244:247], v3, s[84:87], s38 offen offset:1088
  buffer_load_dwordx4 v[248:251], v3, s[84:87], s38 offen offset:1152
  buffer_load_dwordx4 v[252:255], v3, s[84:87], s38 offen offset:1216
  s_waitcnt vmcnt(19)
  v_lshlrev_b32 v16, 16, v176
  v_and_b32 v17, 0xffff0000, v176
  v_lshlrev_b32 v18, 16, v177
  v_and_b32 v19, 0xffff0000, v177
  v_pk_add_f32 v[4:5], v[16:17], v[18:19]
  v_lshlrev_b32 v20, 16, v178
  v_and_b32 v21, 0xffff0000, v178
  v_lshlrev_b32 v22, 16, v179
  v_and_b32 v23, 0xffff0000, v179
  v_pk_add_f32 v[6:7], v[20:21], v[22:23]
  s_waitcnt vmcnt(18)
  v_lshlrev_b32 v24, 16, v180
  v_and_b32 v25, 0xffff0000, v180
  v_pk_add_f32 v[4:5], v[4:5], v[24:25]
  v_lshlrev_b32 v26, 16, v181
  v_and_b32 v27, 0xffff0000, v181
  v_pk_add_f32 v[6:7], v[6:7], v[26:27]
  v_lshlrev_b32 v28, 16, v182
  v_and_b32 v29, 0xffff0000, v182
  v_pk_add_f32 v[4:5], v[4:5], v[28:29]
  v_lshlrev_b32 v30, 16, v183
  v_and_b32 v31, 0xffff0000, v183
  v_pk_add_f32 v[6:7], v[6:7], v[30:31]
  s_waitcnt vmcnt(17)
  v_lshlrev_b32 v32, 16, v184
  v_and_b32 v33, 0xffff0000, v184
  v_pk_add_f32 v[4:5], v[4:5], v[32:33]
  v_lshlrev_b32 v34, 16, v185
  v_and_b32 v35, 0xffff0000, v185
  v_pk_add_f32 v[6:7], v[6:7], v[34:35]
  v_lshlrev_b32 v36, 16, v186
  v_and_b32 v37, 0xffff0000, v186
  v_pk_add_f32 v[4:5], v[4:5], v[36:37]
  v_lshlrev_b32 v38, 16, v187
  v_and_b32 v39, 0xffff0000, v187
  v_pk_add_f32 v[6:7], v[6:7], v[38:39]
  s_waitcnt vmcnt(16)
  v_lshlrev_b32 v40, 16, v188
  v_and_b32 v41, 0xffff0000, v188
  v_pk_add_f32 v[4:5], v[4:5], v[40:41]
  v_lshlrev_b32 v42, 16, v189
  v_and_b32 v43, 0xffff0000, v189
  v_pk_add_f32 v[6:7], v[6:7], v[42:43]
  v_lshlrev_b32 v44, 16, v190
  v_and_b32 v45, 0xffff0000, v190
  v_pk_add_f32 v[4:5], v[4:5], v[44:45]
  v_lshlrev_b32 v46, 16, v191
  v_and_b32 v47, 0xffff0000, v191
  v_pk_add_f32 v[6:7], v[6:7], v[46:47]
  s_waitcnt vmcnt(15)
  v_lshlrev_b32 v48, 16, v192
  v_and_b32 v49, 0xffff0000, v192
  v_pk_add_f32 v[4:5], v[4:5], v[48:49]
  v_lshlrev_b32 v50, 16, v193
  v_and_b32 v51, 0xffff0000, v193
  v_pk_add_f32 v[6:7], v[6:7], v[50:51]
  v_lshlrev_b32 v52, 16, v194
  v_and_b32 v53, 0xffff0000, v194
  v_pk_add_f32 v[4:5], v[4:5], v[52:53]
  v_lshlrev_b32 v54, 16, v195
  v_and_b32 v55, 0xffff0000, v195
  v_pk_add_f32 v[6:7], v[6:7], v[54:55]
  s_waitcnt vmcnt(14)
  v_lshlrev_b32 v56, 16, v196
  v_and_b32 v57, 0xffff0000, v196
  v_pk_add_f32 v[4:5], v[4:5], v[56:57]
  v_lshlrev_b32 v58, 16, v197
  v_and_b32 v59, 0xffff0000, v197
  v_pk_add_f32 v[6:7], v[6:7], v[58:59]
  v_lshlrev_b32 v60, 16, v198
  v_and_b32 v61, 0xffff0000, v198
  v_pk_add_f32 v[4:5], v[4:5], v[60:61]
  v_lshlrev_b32 v62, 16, v199
  v_and_b32 v63, 0xffff0000, v199
  v_pk_add_f32 v[6:7], v[6:7], v[62:63]
  s_waitcnt vmcnt(13)
  v_lshlrev_b32 v64, 16, v200
  v_and_b32 v65, 0xffff0000, v200
  v_pk_add_f32 v[4:5], v[4:5], v[64:65]
  v_lshlrev_b32 v66, 16, v201
  v_and_b32 v67, 0xffff0000, v201
  v_pk_add_f32 v[6:7], v[6:7], v[66:67]
  v_lshlrev_b32 v68, 16, v202
  v_and_b32 v69, 0xffff0000, v202
  v_pk_add_f32 v[4:5], v[4:5], v[68:69]
  v_lshlrev_b32 v70, 16, v203
  v_and_b32 v71, 0xffff0000, v203
  v_pk_add_f32 v[6:7], v[6:7], v[70:71]
  s_waitcnt vmcnt(12)
  v_lshlrev_b32 v72, 16, v204
  v_and_b32 v73, 0xffff0000, v204
  v_pk_add_f32 v[4:5], v[4:5], v[72:73]
  v_lshlrev_b32 v74, 16, v205
  v_and_b32 v75, 0xffff0000, v205
  v_pk_add_f32 v[6:7], v[6:7], v[74:75]
  v_lshlrev_b32 v76, 16, v206
  v_and_b32 v77, 0xffff0000, v206
  v_pk_add_f32 v[4:5], v[4:5], v[76:77]
  v_lshlrev_b32 v78, 16, v207
  v_and_b32 v79, 0xffff0000, v207
  v_pk_add_f32 v[6:7], v[6:7], v[78:79]
  s_waitcnt vmcnt(11)
  v_lshlrev_b32 v80, 16, v208
  v_and_b32 v81, 0xffff0000, v208
  v_pk_add_f32 v[4:5], v[4:5], v[80:81]
  v_lshlrev_b32 v82, 16, v209
  v_and_b32 v83, 0xffff0000, v209
  v_pk_add_f32 v[6:7], v[6:7], v[82:83]
  v_lshlrev_b32 v84, 16, v210
  v_and_b32 v85, 0xffff0000, v210
  v_pk_add_f32 v[4:5], v[4:5], v[84:85]
  v_lshlrev_b32 v86, 16, v211
  v_and_b32 v87, 0xffff0000, v211
  v_pk_add_f32 v[6:7], v[6:7], v[86:87]
  s_waitcnt vmcnt(10)
  v_lshlrev_b32 v88, 16, v212
  v_and_b32 v89, 0xffff0000, v212
  v_pk_add_f32 v[4:5], v[4:5], v[88:89]
  v_lshlrev_b32 v90, 16, v213
  v_and_b32 v91, 0xffff0000, v213
  v_pk_add_f32 v[6:7], v[6:7], v[90:91]
  v_lshlrev_b32 v92, 16, v214
  v_and_b32 v93, 0xffff0000, v214
  v_pk_add_f32 v[4:5], v[4:5], v[92:93]
  v_lshlrev_b32 v94, 16, v215
  v_and_b32 v95, 0xffff0000, v215
  v_pk_add_f32 v[6:7], v[6:7], v[94:95]
  s_waitcnt vmcnt(9)
  v_lshlrev_b32 v96, 16, v216
  v_and_b32 v97, 0xffff0000, v216
  v_pk_add_f32 v[4:5], v[4:5], v[96:97]
  v_lshlrev_b32 v98, 16, v217
  v_and_b32 v99, 0xffff0000, v217
  v_pk_add_f32 v[6:7], v[6:7], v[98:99]
  v_lshlrev_b32 v100, 16, v218
  v_and_b32 v101, 0xffff0000, v218
  v_pk_add_f32 v[4:5], v[4:5], v[100:101]
  v_lshlrev_b32 v102, 16, v219
  v_and_b32 v103, 0xffff0000, v219
  v_pk_add_f32 v[6:7], v[6:7], v[102:103]
  s_waitcnt vmcnt(8)
  v_lshlrev_b32 v104, 16, v220
  v_and_b32 v105, 0xffff0000, v220
  v_pk_add_f32 v[4:5], v[4:5], v[104:105]
  v_lshlrev_b32 v106, 16, v221
  v_and_b32 v107, 0xffff0000, v221
  v_pk_add_f32 v[6:7], v[6:7], v[106:107]
  v_lshlrev_b32 v108, 16, v222
  v_and_b32 v109, 0xffff0000, v222
  v_pk_add_f32 v[4:5], v[4:5], v[108:109]
  v_lshlrev_b32 v110, 16, v223
  v_and_b32 v111, 0xffff0000, v223
  v_pk_add_f32 v[6:7], v[6:7], v[110:111]
  s_waitcnt vmcnt(7)
  v_lshlrev_b32 v112, 16, v224
  v_and_b32 v113, 0xffff0000, v224
  v_pk_add_f32 v[4:5], v[4:5], v[112:113]
  v_lshlrev_b32 v114, 16, v225
  v_and_b32 v115, 0xffff0000, v225
  v_pk_add_f32 v[6:7], v[6:7], v[114:115]
  v_lshlrev_b32 v116, 16, v226
  v_and_b32 v117, 0xffff0000, v226
  v_pk_add_f32 v[4:5], v[4:5], v[116:117]
  v_lshlrev_b32 v118, 16, v227
  v_and_b32 v119, 0xffff0000, v227
  v_pk_add_f32 v[6:7], v[6:7], v[118:119]
  s_waitcnt vmcnt(6)
  v_lshlrev_b32 v120, 16, v228
  v_and_b32 v121, 0xffff0000, v228
  v_pk_add_f32 v[4:5], v[4:5], v[120:121]
  v_lshlrev_b32 v122, 16, v229
  v_and_b32 v123, 0xffff0000, v229
  v_pk_add_f32 v[6:7], v[6:7], v[122:123]
  v_lshlrev_b32 v124, 16, v230
  v_and_b32 v125, 0xffff0000, v230
  v_pk_add_f32 v[4:5], v[4:5], v[124:125]
  v_lshlrev_b32 v126, 16, v231
  v_and_b32 v127, 0xffff0000, v231
  v_pk_add_f32 v[6:7], v[6:7], v[126:127]
  s_waitcnt vmcnt(5)
  v_lshlrev_b32 v128, 16, v232
  v_and_b32 v129, 0xffff0000, v232
  v_pk_add_f32 v[4:5], v[4:5], v[128:129]
  v_lshlrev_b32 v130, 16, v233
  v_and_b32 v131, 0xffff0000, v233
  v_pk_add_f32 v[6:7], v[6:7], v[130:131]
  v_lshlrev_b32 v132, 16, v234
  v_and_b32 v133, 0xffff0000, v234
  v_pk_add_f32 v[4:5], v[4:5], v[132:133]
  v_lshlrev_b32 v134, 16, v235
  v_and_b32 v135, 0xffff0000, v235
  v_pk_add_f32 v[6:7], v[6:7], v[134:135]
  s_waitcnt vmcnt(4)
  v_lshlrev_b32 v136, 16, v236
  v_and_b32 v137, 0xffff0000, v236
  v_pk_add_f32 v[4:5], v[4:5], v[136:137]
  v_lshlrev_b32 v138, 16, v237
  v_and_b32 v139, 0xffff0000, v237
  v_pk_add_f32 v[6:7], v[6:7], v[138:139]
  v_lshlrev_b32 v140, 16, v238
  v_and_b32 v141, 0xffff0000, v238
  v_pk_add_f32 v[4:5], v[4:5], v[140:141]
  v_lshlrev_b32 v142, 16, v239
  v_and_b32 v143, 0xffff0000, v239
  v_pk_add_f32 v[6:7], v[6:7], v[142:143]
  s_waitcnt vmcnt(3)
  v_lshlrev_b32 v144, 16, v240
  v_and_b32 v145, 0xffff0000, v240
  v_pk_add_f32 v[4:5], v[4:5], v[144:145]
  v_lshlrev_b32 v146, 16, v241
  v_and_b32 v147, 0xffff0000, v241
  v_pk_add_f32 v[6:7], v[6:7], v[146:147]
  v_lshlrev_b32 v148, 16, v242
  v_and_b32 v149, 0xffff0000, v242
  v_pk_add_f32 v[4:5], v[4:5], v[148:149]
  v_lshlrev_b32 v150, 16, v243
  v_and_b32 v151, 0xffff0000, v243
  v_pk_add_f32 v[6:7], v[6:7], v[150:151]
  s_waitcnt vmcnt(2)
  v_lshlrev_b32 v152, 16, v244
  v_and_b32 v153, 0xffff0000, v244
  v_pk_add_f32 v[4:5], v[4:5], v[152:153]
  v_lshlrev_b32 v154, 16, v245
  v_and_b32 v155, 0xffff0000, v245
  v_pk_add_f32 v[6:7], v[6:7], v[154:155]
  v_lshlrev_b32 v156, 16, v246
  v_and_b32 v157, 0xffff0000, v246
  v_pk_add_f32 v[4:5], v[4:5], v[156:157]
  v_lshlrev_b32 v158, 16, v247
  v_and_b32 v159, 0xffff0000, v247
  v_pk_add_f32 v[6:7], v[6:7], v[158:159]
  s_waitcnt vmcnt(1)
  v_lshlrev_b32 v160, 16, v248
  v_and_b32 v161, 0xffff0000, v248
  v_pk_add_f32 v[4:5], v[4:5], v[160:161]
  v_lshlrev_b32 v162, 16, v249
  v_and_b32 v163, 0xffff0000, v249
  v_pk_add_f32 v[6:7], v[6:7], v[162:163]
  v_lshlrev_b32 v164, 16, v250
  v_and_b32 v165, 0xffff0000, v250
  v_pk_add_f32 v[4:5], v[4:5], v[164:165]
  v_lshlrev_b32 v166, 16, v251
  v_and_b32 v167, 0xffff0000, v251
  v_pk_add_f32 v[6:7], v[6:7], v[166:167]
  s_waitcnt vmcnt(0)
  v_lshlrev_b32 v168, 16, v252
  v_and_b32 v169, 0xffff0000, v252
  v_pk_add_f32 v[4:5], v[4:5], v[168:169]
  v_lshlrev_b32 v170, 16, v253
  v_and_b32 v171, 0xffff0000, v253
  v_pk_add_f32 v[6:7], v[6:7], v[170:171]
  v_lshlrev_b32 v172, 16, v254
  v_and_b32 v173, 0xffff0000, v254
  v_pk_add_f32 v[4:5], v[4:5], v[172:173]
  v_lshlrev_b32 v174, 16, v255
  v_and_b32 v175, 0xffff0000, v255
  v_pk_add_f32 v[6:7], v[6:7], v[174:175]
  v_pk_add_f32 v[4:5], v[4:5], v[6:7]
  v_add_f32 v4, v4, v5
  v_mov_b32 v5, v4
  s_nop 1
  v_permlane16_swap_b32 v4, v5
  v_add_f32 v4, v4, v5
  v_mov_b32 v5, v4
  s_nop 1
  v_permlane32_swap_b32 v4, v5
  v_add_f32 v4, v4, v5
  v_mul_f32 v8, 0xbacccccd, v4
  v_mov_b32 v9, v8
  v_pk_add_f32 v[16:17], v[16:17], v[8:9]
  v_pk_mul_f32 v[4:5], v[16:17], v[16:17]
  v_pk_add_f32 v[18:19], v[18:19], v[8:9]
  v_pk_mul_f32 v[6:7], v[18:19], v[18:19]
  v_pk_add_f32 v[20:21], v[20:21], v[8:9]
  v_pk_fma_f32 v[4:5], v[20:21], v[20:21], v[4:5]
  v_pk_add_f32 v[22:23], v[22:23], v[8:9]
  v_pk_fma_f32 v[6:7], v[22:23], v[22:23], v[6:7]
  v_pk_add_f32 v[24:25], v[24:25], v[8:9]
  v_pk_fma_f32 v[4:5], v[24:25], v[24:25], v[4:5]
  v_pk_add_f32 v[26:27], v[26:27], v[8:9]
  v_pk_fma_f32 v[6:7], v[26:27], v[26:27], v[6:7]
  v_pk_add_f32 v[28:29], v[28:29], v[8:9]
  v_pk_fma_f32 v[4:5], v[28:29], v[28:29], v[4:5]
  v_pk_add_f32 v[30:31], v[30:31], v[8:9]
  v_pk_fma_f32 v[6:7], v[30:31], v[30:31], v[6:7]
  v_pk_add_f32 v[32:33], v[32:33], v[8:9]
  v_pk_fma_f32 v[4:5], v[32:33], v[32:33], v[4:5]
  v_pk_add_f32 v[34:35], v[34:35], v[8:9]
  v_pk_fma_f32 v[6:7], v[34:35], v[34:35], v[6:7]
  v_pk_add_f32 v[36:37], v[36:37], v[8:9]
  v_pk_fma_f32 v[4:5], v[36:37], v[36:37], v[4:5]
  v_pk_add_f32 v[38:39], v[38:39], v[8:9]
  v_pk_fma_f32 v[6:7], v[38:39], v[38:39], v[6:7]
  v_pk_add_f32 v[40:41], v[40:41], v[8:9]
  v_pk_fma_f32 v[4:5], v[40:41], v[40:41], v[4:5]
  v_pk_add_f32 v[42:43], v[42:43], v[8:9]
  v_pk_fma_f32 v[6:7], v[42:43], v[42:43], v[6:7]
  v_pk_add_f32 v[44:45], v[44:45], v[8:9]
  v_pk_fma_f32 v[4:5], v[44:45], v[44:45], v[4:5]
  v_pk_add_f32 v[46:47], v[46:47], v[8:9]
  v_pk_fma_f32 v[6:7], v[46:47], v[46:47], v[6:7]
  v_pk_add_f32 v[48:49], v[48:49], v[8:9]
  v_pk_fma_f32 v[4:5], v[48:49], v[48:49], v[4:5]
  v_pk_add_f32 v[50:51], v[50:51], v[8:9]
  v_pk_fma_f32 v[6:7], v[50:51], v[50:51], v[6:7]
  v_pk_add_f32 v[52:53], v[52:53], v[8:9]
  v_pk_fma_f32 v[4:5], v[52:53], v[52:53], v[4:5]
  v_pk_add_f32 v[54:55], v[54:55], v[8:9]
  v_pk_fma_f32 v[6:7], v[54:55], v[54:55], v[6:7]
  v_pk_add_f32 v[56:57], v[56:57], v[8:9]
  v_pk_fma_f32 v[4:5], v[56:57], v[56:57], v[4:5]
  v_pk_add_f32 v[58:59], v[58:59], v[8:9]
  v_pk_fma_f32 v[6:7], v[58:59], v[58:59], v[6:7]
  v_pk_add_f32 v[60:61], v[60:61], v[8:9]
  v_pk_fma_f32 v[4:5], v[60:61], v[60:61], v[4:5]
  v_pk_add_f32 v[62:63], v[62:63], v[8:9]
  v_pk_fma_f32 v[6:7], v[62:63], v[62:63], v[6:7]
  v_pk_add_f32 v[64:65], v[64:65], v[8:9]
  v_pk_fma_f32 v[4:5], v[64:65], v[64:65], v[4:5]
  v_pk_add_f32 v[66:67], v[66:67], v[8:9]
  v_pk_fma_f32 v[6:7], v[66:67], v[66:67], v[6:7]
  v_pk_add_f32 v[68:69], v[68:69], v[8:9]
  v_pk_fma_f32 v[4:5], v[68:69], v[68:69], v[4:5]
  v_pk_add_f32 v[70:71], v[70:71], v[8:9]
  v_pk_fma_f32 v[6:7], v[70:71], v[70:71], v[6:7]
  v_pk_add_f32 v[72:73], v[72:73], v[8:9]
  v_pk_fma_f32 v[4:5], v[72:73], v[72:73], v[4:5]
  v_pk_add_f32 v[74:75], v[74:75], v[8:9]
  v_pk_fma_f32 v[6:7], v[74:75], v[74:75], v[6:7]
  v_pk_add_f32 v[76:77], v[76:77], v[8:9]
  v_pk_fma_f32 v[4:5], v[76:77], v[76:77], v[4:5]
  v_pk_add_f32 v[78:79], v[78:79], v[8:9]
  v_pk_fma_f32 v[6:7], v[78:79], v[78:79], v[6:7]
  v_pk_add_f32 v[80:81], v[80:81], v[8:9]
  v_pk_fma_f32 v[4:5], v[80:81], v[80:81], v[4:5]
  v_pk_add_f32 v[82:83], v[82:83], v[8:9]
  v_pk_fma_f32 v[6:7], v[82:83], v[82:83], v[6:7]
  v_pk_add_f32 v[84:85], v[84:85], v[8:9]
  v_pk_fma_f32 v[4:5], v[84:85], v[84:85], v[4:5]
  v_pk_add_f32 v[86:87], v[86:87], v[8:9]
  v_pk_fma_f32 v[6:7], v[86:87], v[86:87], v[6:7]
  v_pk_add_f32 v[88:89], v[88:89], v[8:9]
  v_pk_fma_f32 v[4:5], v[88:89], v[88:89], v[4:5]
  v_pk_add_f32 v[90:91], v[90:91], v[8:9]
  v_pk_fma_f32 v[6:7], v[90:91], v[90:91], v[6:7]
  v_pk_add_f32 v[92:93], v[92:93], v[8:9]
  v_pk_fma_f32 v[4:5], v[92:93], v[92:93], v[4:5]
  v_pk_add_f32 v[94:95], v[94:95], v[8:9]
  v_pk_fma_f32 v[6:7], v[94:95], v[94:95], v[6:7]
  v_pk_add_f32 v[96:97], v[96:97], v[8:9]
  v_pk_fma_f32 v[4:5], v[96:97], v[96:97], v[4:5]
  v_pk_add_f32 v[98:99], v[98:99], v[8:9]
  v_pk_fma_f32 v[6:7], v[98:99], v[98:99], v[6:7]
  v_pk_add_f32 v[100:101], v[100:101], v[8:9]
  v_pk_fma_f32 v[4:5], v[100:101], v[100:101], v[4:5]
  v_pk_add_f32 v[102:103], v[102:103], v[8:9]
  v_pk_fma_f32 v[6:7], v[102:103], v[102:103], v[6:7]
  v_pk_add_f32 v[104:105], v[104:105], v[8:9]
  v_pk_fma_f32 v[4:5], v[104:105], v[104:105], v[4:5]
  v_pk_add_f32 v[106:107], v[106:107], v[8:9]
  v_pk_fma_f32 v[6:7], v[106:107], v[106:107], v[6:7]
  v_pk_add_f32 v[108:109], v[108:109], v[8:9]
  v_pk_fma_f32 v[4:5], v[108:109], v[108:109], v[4:5]
  v_pk_add_f32 v[110:111], v[110:111], v[8:9]
  v_pk_fma_f32 v[6:7], v[110:111], v[110:111], v[6:7]
  v_pk_add_f32 v[112:113], v[112:113], v[8:9]
  v_pk_fma_f32 v[4:5], v[112:113], v[112:113], v[4:5]
  v_pk_add_f32 v[114:115], v[114:115], v[8:9]
  v_pk_fma_f32 v[6:7], v[114:115], v[114:115], v[6:7]
  v_pk_add_f32 v[116:117], v[116:117], v[8:9]
  v_pk_fma_f32 v[4:5], v[116:117], v[116:117], v[4:5]
  v_pk_add_f32 v[118:119], v[118:119], v[8:9]
  v_pk_fma_f32 v[6:7], v[118:119], v[118:119], v[6:7]
  v_pk_add_f32 v[120:121], v[120:121], v[8:9]
  v_pk_fma_f32 v[4:5], v[120:121], v[120:121], v[4:5]
  v_pk_add_f32 v[122:123], v[122:123], v[8:9]
  v_pk_fma_f32 v[6:7], v[122:123], v[122:123], v[6:7]
  v_pk_add_f32 v[124:125], v[124:125], v[8:9]
  v_pk_fma_f32 v[4:5], v[124:125], v[124:125], v[4:5]
  v_pk_add_f32 v[126:127], v[126:127], v[8:9]
  v_pk_fma_f32 v[6:7], v[126:127], v[126:127], v[6:7]
  v_pk_add_f32 v[128:129], v[128:129], v[8:9]
  v_pk_fma_f32 v[4:5], v[128:129], v[128:129], v[4:5]
  v_pk_add_f32 v[130:131], v[130:131], v[8:9]
  v_pk_fma_f32 v[6:7], v[130:131], v[130:131], v[6:7]
  v_pk_add_f32 v[132:133], v[132:133], v[8:9]
  v_pk_fma_f32 v[4:5], v[132:133], v[132:133], v[4:5]
  v_pk_add_f32 v[134:135], v[134:135], v[8:9]
  v_pk_fma_f32 v[6:7], v[134:135], v[134:135], v[6:7]
  v_pk_add_f32 v[136:137], v[136:137], v[8:9]
  v_pk_fma_f32 v[4:5], v[136:137], v[136:137], v[4:5]
  v_pk_add_f32 v[138:139], v[138:139], v[8:9]
  v_pk_fma_f32 v[6:7], v[138:139], v[138:139], v[6:7]
  v_pk_add_f32 v[140:141], v[140:141], v[8:9]
  v_pk_fma_f32 v[4:5], v[140:141], v[140:141], v[4:5]
  v_pk_add_f32 v[142:143], v[142:143], v[8:9]
  v_pk_fma_f32 v[6:7], v[142:143], v[142:143], v[6:7]
  v_pk_add_f32 v[144:145], v[144:145], v[8:9]
  v_pk_fma_f32 v[4:5], v[144:145], v[144:145], v[4:5]
  v_pk_add_f32 v[146:147], v[146:147], v[8:9]
  v_pk_fma_f32 v[6:7], v[146:147], v[146:147], v[6:7]
  v_pk_add_f32 v[148:149], v[148:149], v[8:9]
  v_pk_fma_f32 v[4:5], v[148:149], v[148:149], v[4:5]
  v_pk_add_f32 v[150:151], v[150:151], v[8:9]
  v_pk_fma_f32 v[6:7], v[150:151], v[150:151], v[6:7]
  v_pk_add_f32 v[152:153], v[152:153], v[8:9]
  v_pk_fma_f32 v[4:5], v[152:153], v[152:153], v[4:5]
  v_pk_add_f32 v[154:155], v[154:155], v[8:9]
  v_pk_fma_f32 v[6:7], v[154:155], v[154:155], v[6:7]
  v_pk_add_f32 v[156:157], v[156:157], v[8:9]
  v_pk_fma_f32 v[4:5], v[156:157], v[156:157], v[4:5]
  v_pk_add_f32 v[158:159], v[158:159], v[8:9]
  v_pk_fma_f32 v[6:7], v[158:159], v[158:159], v[6:7]
  v_pk_add_f32 v[160:161], v[160:161], v[8:9]
  v_pk_fma_f32 v[4:5], v[160:161], v[160:161], v[4:5]
  v_pk_add_f32 v[162:163], v[162:163], v[8:9]
  v_pk_fma_f32 v[6:7], v[162:163], v[162:163], v[6:7]
  v_pk_add_f32 v[164:165], v[164:165], v[8:9]
  v_pk_fma_f32 v[4:5], v[164:165], v[164:165], v[4:5]
  v_pk_add_f32 v[166:167], v[166:167], v[8:9]
  v_pk_fma_f32 v[6:7], v[166:167], v[166:167], v[6:7]
  v_pk_add_f32 v[168:169], v[168:169], v[8:9]
  v_pk_fma_f32 v[4:5], v[168:169], v[168:169], v[4:5]
  v_pk_add_f32 v[170:171], v[170:171], v[8:9]
  v_pk_fma_f32 v[6:7], v[170:171], v[170:171], v[6:7]
  v_pk_add_f32 v[172:173], v[172:173], v[8:9]
  v_pk_fma_f32 v[4:5], v[172:173], v[172:173], v[4:5]
  v_pk_add_f32 v[174:175], v[174:175], v[8:9]
  v_pk_fma_f32 v[6:7], v[174:175], v[174:175], v[6:7]
  v_pk_add_f32 v[4:5], v[4:5], v[6:7]
  v_add_f32 v4, v4, v5
  v_mov_b32 v5, v4
  s_nop 1
  v_permlane16_swap_b32 v4, v5
  v_add_f32 v4, v4, v5
  v_mov_b32 v5, v4
  s_nop 1
  v_permlane32_swap_b32 v4, v5
  v_add_f32 v4, v4, v5
  v_mov_b32 v5, 0x3727c5ac
  v_fmac_f32 v5, 0x3acccccd, v4
  v_rsq_f32 v8, v5
  s_nop 0
  v_mov_b32 v9, v8
  s_lshr_b32 s38, s40, 1
  s_mul_i32 s38, s38, 40960
  s_and_b32 s39, s40, 1
  s_lshl_b32 s39, s39, 10
  s_add_u32 s38, s38, s39
  s_add_u32 s38, s38, 14680064
  v_pk_mul_f32 v[16:17], v[16:17], v[8:9]
  v_pk_mul_f32 v[18:19], v[18:19], v[8:9]
  v_pk_mul_f32 v[20:21], v[20:21], v[8:9]
  v_pk_mul_f32 v[22:23], v[22:23], v[8:9]
  v_cvt_pk_bf16_f32 v176, v16, v17
  v_cvt_pk_bf16_f32 v177, v18, v19
  v_cvt_pk_bf16_f32 v178, v20, v21
  v_cvt_pk_bf16_f32 v179, v22, v23
  buffer_store_dwordx4 v[176:179], v2, s[4:7], s38 offen offset:0 sc1
  v_pk_mul_f32 v[24:25], v[24:25], v[8:9]
  v_pk_mul_f32 v[26:27], v[26:27], v[8:9]
  v_pk_mul_f32 v[28:29], v[28:29], v[8:9]
  v_pk_mul_f32 v[30:31], v[30:31], v[8:9]
  v_cvt_pk_bf16_f32 v180, v24, v25
  v_cvt_pk_bf16_f32 v181, v26, v27
  v_cvt_pk_bf16_f32 v182, v28, v29
  v_cvt_pk_bf16_f32 v183, v30, v31
  buffer_store_dwordx4 v[180:183], v2, s[4:7], s38 offen offset:2048 sc1
  s_add_u32 s38, s38, 4096
  v_pk_mul_f32 v[32:33], v[32:33], v[8:9]
  v_pk_mul_f32 v[34:35], v[34:35], v[8:9]
  v_pk_mul_f32 v[36:37], v[36:37], v[8:9]
  v_pk_mul_f32 v[38:39], v[38:39], v[8:9]
  v_cvt_pk_bf16_f32 v184, v32, v33
  v_cvt_pk_bf16_f32 v185, v34, v35
  v_cvt_pk_bf16_f32 v186, v36, v37
  v_cvt_pk_bf16_f32 v187, v38, v39
  buffer_store_dwordx4 v[184:187], v2, s[4:7], s38 offen offset:0 sc1
  v_pk_mul_f32 v[40:41], v[40:41], v[8:9]
  v_pk_mul_f32 v[42:43], v[42:43], v[8:9]
  v_pk_mul_f32 v[44:45], v[44:45], v[8:9]
  v_pk_mul_f32 v[46:47], v[46:47], v[8:9]
  v_cvt_pk_bf16_f32 v188, v40, v41
  v_cvt_pk_bf16_f32 v189, v42, v43
  v_cvt_pk_bf16_f32 v190, v44, v45
  v_cvt_pk_bf16_f32 v191, v46, v47
  buffer_store_dwordx4 v[188:191], v2, s[4:7], s38 offen offset:2048 sc1
  s_add_u32 s38, s38, 4096
  v_pk_mul_f32 v[48:49], v[48:49], v[8:9]
  v_pk_mul_f32 v[50:51], v[50:51], v[8:9]
  v_pk_mul_f32 v[52:53], v[52:53], v[8:9]
  v_pk_mul_f32 v[54:55], v[54:55], v[8:9]
  v_cvt_pk_bf16_f32 v192, v48, v49
  v_cvt_pk_bf16_f32 v193, v50, v51
  v_cvt_pk_bf16_f32 v194, v52, v53
  v_cvt_pk_bf16_f32 v195, v54, v55
  buffer_store_dwordx4 v[192:195], v2, s[4:7], s38 offen offset:0 sc1
  v_pk_mul_f32 v[56:57], v[56:57], v[8:9]
  v_pk_mul_f32 v[58:59], v[58:59], v[8:9]
  v_pk_mul_f32 v[60:61], v[60:61], v[8:9]
  v_pk_mul_f32 v[62:63], v[62:63], v[8:9]
  v_cvt_pk_bf16_f32 v196, v56, v57
  v_cvt_pk_bf16_f32 v197, v58, v59
  v_cvt_pk_bf16_f32 v198, v60, v61
  v_cvt_pk_bf16_f32 v199, v62, v63
  buffer_store_dwordx4 v[196:199], v2, s[4:7], s38 offen offset:2048 sc1
  s_add_u32 s38, s38, 4096
  v_pk_mul_f32 v[64:65], v[64:65], v[8:9]
  v_pk_mul_f32 v[66:67], v[66:67], v[8:9]
  v_pk_mul_f32 v[68:69], v[68:69], v[8:9]
  v_pk_mul_f32 v[70:71], v[70:71], v[8:9]
  v_cvt_pk_bf16_f32 v200, v64, v65
  v_cvt_pk_bf16_f32 v201, v66, v67
  v_cvt_pk_bf16_f32 v202, v68, v69
  v_cvt_pk_bf16_f32 v203, v70, v71
  buffer_store_dwordx4 v[200:203], v2, s[4:7], s38 offen offset:0 sc1
  v_pk_mul_f32 v[72:73], v[72:73], v[8:9]
  v_pk_mul_f32 v[74:75], v[74:75], v[8:9]
  v_pk_mul_f32 v[76:77], v[76:77], v[8:9]
  v_pk_mul_f32 v[78:79], v[78:79], v[8:9]
  v_cvt_pk_bf16_f32 v204, v72, v73
  v_cvt_pk_bf16_f32 v205, v74, v75
  v_cvt_pk_bf16_f32 v206, v76, v77
  v_cvt_pk_bf16_f32 v207, v78, v79
  buffer_store_dwordx4 v[204:207], v2, s[4:7], s38 offen offset:2048 sc1
  s_add_u32 s38, s38, 4096
  v_pk_mul_f32 v[80:81], v[80:81], v[8:9]
  v_pk_mul_f32 v[82:83], v[82:83], v[8:9]
  v_pk_mul_f32 v[84:85], v[84:85], v[8:9]
  v_pk_mul_f32 v[86:87], v[86:87], v[8:9]
  v_cvt_pk_bf16_f32 v208, v80, v81
  v_cvt_pk_bf16_f32 v209, v82, v83
  v_cvt_pk_bf16_f32 v210, v84, v85
  v_cvt_pk_bf16_f32 v211, v86, v87
  buffer_store_dwordx4 v[208:211], v2, s[4:7], s38 offen offset:0 sc1
  v_pk_mul_f32 v[88:89], v[88:89], v[8:9]
  v_pk_mul_f32 v[90:91], v[90:91], v[8:9]
  v_pk_mul_f32 v[92:93], v[92:93], v[8:9]
  v_pk_mul_f32 v[94:95], v[94:95], v[8:9]
  v_cvt_pk_bf16_f32 v212, v88, v89
  v_cvt_pk_bf16_f32 v213, v90, v91
  v_cvt_pk_bf16_f32 v214, v92, v93
  v_cvt_pk_bf16_f32 v215, v94, v95
  buffer_store_dwordx4 v[212:215], v2, s[4:7], s38 offen offset:2048 sc1
  s_add_u32 s38, s38, 4096
  v_pk_mul_f32 v[96:97], v[96:97], v[8:9]
  v_pk_mul_f32 v[98:99], v[98:99], v[8:9]
  v_pk_mul_f32 v[100:101], v[100:101], v[8:9]
  v_pk_mul_f32 v[102:103], v[102:103], v[8:9]
  v_cvt_pk_bf16_f32 v216, v96, v97
  v_cvt_pk_bf16_f32 v217, v98, v99
  v_cvt_pk_bf16_f32 v218, v100, v101
  v_cvt_pk_bf16_f32 v219, v102, v103
  buffer_store_dwordx4 v[216:219], v2, s[4:7], s38 offen offset:0 sc1
  v_pk_mul_f32 v[104:105], v[104:105], v[8:9]
  v_pk_mul_f32 v[106:107], v[106:107], v[8:9]
  v_pk_mul_f32 v[108:109], v[108:109], v[8:9]
  v_pk_mul_f32 v[110:111], v[110:111], v[8:9]
  v_cvt_pk_bf16_f32 v220, v104, v105
  v_cvt_pk_bf16_f32 v221, v106, v107
  v_cvt_pk_bf16_f32 v222, v108, v109
  v_cvt_pk_bf16_f32 v223, v110, v111
  buffer_store_dwordx4 v[220:223], v2, s[4:7], s38 offen offset:2048 sc1
  s_add_u32 s38, s38, 4096
  v_pk_mul_f32 v[112:113], v[112:113], v[8:9]
  v_pk_mul_f32 v[114:115], v[114:115], v[8:9]
  v_pk_mul_f32 v[116:117], v[116:117], v[8:9]
  v_pk_mul_f32 v[118:119], v[118:119], v[8:9]
  v_cvt_pk_bf16_f32 v224, v112, v113
  v_cvt_pk_bf16_f32 v225, v114, v115
  v_cvt_pk_bf16_f32 v226, v116, v117
  v_cvt_pk_bf16_f32 v227, v118, v119
  buffer_store_dwordx4 v[224:227], v2, s[4:7], s38 offen offset:0 sc1
  v_pk_mul_f32 v[120:121], v[120:121], v[8:9]
  v_pk_mul_f32 v[122:123], v[122:123], v[8:9]
  v_pk_mul_f32 v[124:125], v[124:125], v[8:9]
  v_pk_mul_f32 v[126:127], v[126:127], v[8:9]
  v_cvt_pk_bf16_f32 v228, v120, v121
  v_cvt_pk_bf16_f32 v229, v122, v123
  v_cvt_pk_bf16_f32 v230, v124, v125
  v_cvt_pk_bf16_f32 v231, v126, v127
  buffer_store_dwordx4 v[228:231], v2, s[4:7], s38 offen offset:2048 sc1
  s_add_u32 s38, s38, 4096
  v_pk_mul_f32 v[128:129], v[128:129], v[8:9]
  v_pk_mul_f32 v[130:131], v[130:131], v[8:9]
  v_pk_mul_f32 v[132:133], v[132:133], v[8:9]
  v_pk_mul_f32 v[134:135], v[134:135], v[8:9]
  v_cvt_pk_bf16_f32 v232, v128, v129
  v_cvt_pk_bf16_f32 v233, v130, v131
  v_cvt_pk_bf16_f32 v234, v132, v133
  v_cvt_pk_bf16_f32 v235, v134, v135
  buffer_store_dwordx4 v[232:235], v2, s[4:7], s38 offen offset:0 sc1
  v_pk_mul_f32 v[136:137], v[136:137], v[8:9]
  v_pk_mul_f32 v[138:139], v[138:139], v[8:9]
  v_pk_mul_f32 v[140:141], v[140:141], v[8:9]
  v_pk_mul_f32 v[142:143], v[142:143], v[8:9]
  v_cvt_pk_bf16_f32 v236, v136, v137
  v_cvt_pk_bf16_f32 v237, v138, v139
  v_cvt_pk_bf16_f32 v238, v140, v141
  v_cvt_pk_bf16_f32 v239, v142, v143
  buffer_store_dwordx4 v[236:239], v2, s[4:7], s38 offen offset:2048 sc1
  s_add_u32 s38, s38, 4096
  v_pk_mul_f32 v[144:145], v[144:145], v[8:9]
  v_pk_mul_f32 v[146:147], v[146:147], v[8:9]
  v_pk_mul_f32 v[148:149], v[148:149], v[8:9]
  v_pk_mul_f32 v[150:151], v[150:151], v[8:9]
  v_cvt_pk_bf16_f32 v240, v144, v145
  v_cvt_pk_bf16_f32 v241, v146, v147
  v_cvt_pk_bf16_f32 v242, v148, v149
  v_cvt_pk_bf16_f32 v243, v150, v151
  buffer_store_dwordx4 v[240:243], v2, s[4:7], s38 offen offset:0 sc1
  v_pk_mul_f32 v[152:153], v[152:153], v[8:9]
  v_pk_mul_f32 v[154:155], v[154:155], v[8:9]
  v_pk_mul_f32 v[156:157], v[156:157], v[8:9]
  v_pk_mul_f32 v[158:159], v[158:159], v[8:9]
  v_cvt_pk_bf16_f32 v244, v152, v153
  v_cvt_pk_bf16_f32 v245, v154, v155
  v_cvt_pk_bf16_f32 v246, v156, v157
  v_cvt_pk_bf16_f32 v247, v158, v159
  buffer_store_dwordx4 v[244:247], v2, s[4:7], s38 offen offset:2048 sc1
  s_add_u32 s38, s38, 4096
  v_pk_mul_f32 v[160:161], v[160:161], v[8:9]
  v_pk_mul_f32 v[162:163], v[162:163], v[8:9]
  v_pk_mul_f32 v[164:165], v[164:165], v[8:9]
  v_pk_mul_f32 v[166:167], v[166:167], v[8:9]
  v_cvt_pk_bf16_f32 v248, v160, v161
  v_cvt_pk_bf16_f32 v249, v162, v163
  v_cvt_pk_bf16_f32 v250, v164, v165
  v_cvt_pk_bf16_f32 v251, v166, v167
  buffer_store_dwordx4 v[248:251], v2, s[4:7], s38 offen offset:0 sc1
  v_pk_mul_f32 v[168:169], v[168:169], v[8:9]
  v_pk_mul_f32 v[170:171], v[170:171], v[8:9]
  v_pk_mul_f32 v[172:173], v[172:173], v[8:9]
  v_pk_mul_f32 v[174:175], v[174:175], v[8:9]
  v_cvt_pk_bf16_f32 v252, v168, v169
  v_cvt_pk_bf16_f32 v253, v170, v171
  v_cvt_pk_bf16_f32 v254, v172, v173
  v_cvt_pk_bf16_f32 v255, v174, v175
  buffer_store_dwordx4 v[252:255], v2, s[4:7], s38 offen offset:2048 sc1
  s_add_u32 s38, s38, 4096
Lw_noln:
  s_waitcnt vmcnt(0) lgkmcnt(0)
  v_mov_b32 v11, 163832
  s_cmp_eq_u32 s20, 0
  s_cbranch_scc0 Lcx_37
  s_mov_b32 s39, 200000
Lcr_35:
  s_sleep 8
  buffer_load_dword v10, off, s[80:83], 0 sc1
  s_waitcnt vmcnt(0)
Lcq_36:
  s_sub_u32 s39, s39, 1
  s_cbranch_scc1 Lcd_38
  v_cmp_eq_u32 vcc, 0, v10
  s_cbranch_vccnz Lcr_35
Lcd_38:
  ds_write_b32 v11, v10
  s_waitcnt lgkmcnt(0)
Lcx_37:
  s_barrier
  ds_read_b32 v10, v11
  s_waitcnt lgkmcnt(0)
  v_readfirstlane_b32 s38, v10
  s_sub_u32 s38, s38, 1
  s_cmp_eq_u32 s38, s46
  s_cbranch_scc0 Lrestart
  s_cmp_eq_u32 s20, 0
  s_cbranch_scc0 Lw_noarr
  v_mov_b32 v12, 1
  v_mov_b32 v13, 128
  s_mov_b64 exec, 1
  buffer_atomic_add v12, v13, s[80:83], 0 offen
  s_mov_b64 exec, -1
  s_waitcnt vmcnt(0)
Lw_noarr:
  s_cmp_eq_u32 s20, 0
  s_cbranch_scc0 Lw0_39
Lp_40:
  buffer_load_ubyte v10, off, s[80:83], 0 offset:128 sc1
  s_waitcnt vmcnt(0)
  v_cmp_gt_u32 vcc, 36, v10
  s_cbranch_vccz Lpd_41
  s_sleep 16
  s_sub_u32 s24, s24, 1
  s_cbranch_scc0 Lp_40
  s_branch Lw_fail
Lpd_41:
  s_mul_i32 s38, s16, 1536
  s_add_u32 s38, s38, 1835008
  v_min_u32 v11, 11, v1
  v_lshlrev_b32 v11, 7, v11
Lp_42:
  buffer_load_dword v10, v11, s[4:7], s38 offen sc1
  s_waitcnt vmcnt(0)
  v_cmp_gt_u32 vcc, 1, v10
  s_cbranch_vccz Lpd_43
  s_sleep 8
  s_sub_u32 s24, s24, 1
  s_cbranch_scc0 Lp_42
  s_branch Lw_fail
Lpd_43:
Lw0_39:
  s_barrier
  v_lshrrev_b32 v4, 4, v1
  s_lshr_b32 s38, s20, 1
  s_and_b32 s38, s38, 1
  s_lshl_b32 s38, s38, 2
  v_or_b32 v5, s38, v4
  v_lshlrev_b32 v5, 1, v5
  v_and_b32 v6, 15, v1
  v_xor_b32 v5, v5, v6
  s_lshl_b32 s38, s20, 2
  v_add_u32 v4, s38, v4
  v_mul_u32_u24 v4, 12288, v4
  v_lshl_add_u32 v3, v5, 4, v4
  v_cmp_gt_u32 s[42:43], 8, v5
  s_lshl_b32 s35, s20, 10
  s_add_u32 s38, s34, 0
  s_add_u32 m0, s35, 0
  s_nop 0
  buffer_load_dwordx4 v3, s[8:11], s38 offen lds
  s_add_u32 s38, s38, 256
  s_add_u32 m0, s35, 8192
  s_mov_b64 exec, s[42:43]
  buffer_load_dwordx4 v3, s[8:11], s38 offen lds
  s_mov_b64 exec, -1
  s_add_u32 s38, s34, 393216
  s_add_u32 m0, s35, 16384
  s_nop 0
  buffer_load_dwordx4 v3, s[8:11], s38 offen lds
  s_add_u32 s38, s38, 256
  s_add_u32 m0, s35, 24576
  s_mov_b64 exec, s[42:43]
  buffer_load_dwordx4 v3, s[8:11], s38 offen lds
  s_mov_b64 exec, -1
  s_add_u32 s38, s34, 786432
  s_add_u32 m0, s35, 32768
  s_nop 0
  buffer_load_dwordx4 v3, s[8:11], s38 offen lds
  s_add_u32 s38, s38, 256
  s_add_u32 m0, s35, 40960
  s_mov_b64 exec, s[42:43]
  buffer_load_dwordx4 v3, s[8:11], s38 offen lds
  s_mov_b64 exec, -1
  s_add_u32 s38, s34, 1179648
  s_add_u32 m0, s35, 49152
  s_nop 0
  buffer_load_dwordx4 v3, s[8:11], s38 offen lds
  s_add_u32 s38, s38, 256
  s_add_u32 m0, s35, 57344
  s_mov_b64 exec, s[42:43]
  buffer_load_dwordx4 v3, s[8:11], s38 offen lds
  s_mov_b64 exec, -1
  s_add_u32 s38, s34, 1572864
  s_add_u32 m0, s35, 65536
  s_nop 0
  buffer_load_dwordx4 v3, s[8:11], s38 offen lds
  s_add_u32 s38, s38, 256
  s_add_u32 m0, s35, 73728
  s_mov_b64 exec, s[42:43]
  buffer_load_dwordx4 v3, s[8:11], s38 offen lds
  s_mov_b64 exec, -1
  s_add_u32 s38, s34, 1966080
  s_add_u32 m0, s35, 81920
  s_nop 0
  buffer_load_dwordx4 v3, s[8:11], s38 offen lds
  s_add_u32 s38, s38, 256
  s_add_u32 m0, s35, 90112
  s_mov_b64 exec, s[42:43]
  buffer_load_dwordx4 v3, s[8:11], s38 offen lds
  s_mov_b64 exec, -1
  s_add_u32 s38, s34, 2359296
  s_add_u32 m0, s35, 98304
  s_nop 0
  buffer_load_dwordx4 v3, s[8:11], s38 offen lds
  s_add_u32 s38, s38, 256
  s_add_u32 m0, s35, 106496
  s_mov_b64 exec, s[42:43]
  buffer_load_dwordx4 v3, s[8:11], s38 offen lds
  s_mov_b64 exec, -1
  s_add_u32 s38, s34, 2752512
  s_add_u32 m0, s35, 114688
  s_nop 0
  buffer_load_dwordx4 v3, s[8:11], s38 offen lds
  s_add_u32 s38, s38, 256
  s_add_u32 m0, s35, 122880
  s_mov_b64 exec, s[42:43]
  buffer_load_dwordx4 v3, s[8:11], s38 offen lds
  s_mov_b64 exec, -1
  v_bfe_u32 v6, v1, 4, 2
  v_lshlrev_b32 v6, 11, v6
  v_bfe_u32 v8, v1, 2, 2
  v_lshl_add_u32 v6, v8, 8, v6
  v_bfe_u32 v8, v1, 2, 3
  s_and_b32 s38, s20, 3
  s_lshl_b32 s38, s38, 1
  v_xor_b32 v8, s38, v8
  v_lshl_add_u32 v6, v8, 5, v6
  v_and_b32 v9, 3, v1
  v_lshl_add_u32 v6, v9, 3, v6
  s_lshr_b32 s38, s20, 2
  s_lshl_b32 s38, s38, 13
  v_add_u32 v6, s38, v6
  v_xor_b32 v7, 32, v6
  s_waitcnt vmcnt(8)
  s_barrier
  ds_read_b64_tr_b16 v[96:97], v6 offset:0
  ds_read_b64_tr_b16 v[98:99], v6 offset:1024
  ds_read_b64_tr_b16 v[176:177], v7 offset:0
  ds_read_b64_tr_b16 v[178:179], v7 offset:1024
  ds_read_b64_tr_b16 v[100:101], v6 offset:16384
  ds_read_b64_tr_b16 v[102:103], v6 offset:17408
  ds_read_b64_tr_b16 v[180:181], v7 offset:16384
  ds_read_b64_tr_b16 v[182:183], v7 offset:17408
  ds_read_b64_tr_b16 v[104:105], v6 offset:32768
  ds_read_b64_tr_b16 v[106:107], v6 offset:33792
  ds_read_b64_tr_b16 v[184:185], v7 offset:32768
  ds_read_b64_tr_b16 v[186:187], v7 offset:33792
  ds_read_b64_tr_b16 v[108:109], v6 offset:49152
  ds_read_b64_tr_b16 v[110:111], v6 offset:50176
  ds_read_b64_tr_b16 v[188:189], v7 offset:49152
  ds_read_b64_tr_b16 v[190:191], v7 offset:50176
  v_xor_b32 v6, 0x10000, v6
  v_xor_b32 v7, 0x10000, v7
  s_waitcnt lgkmcnt(0)
  s_barrier
  s_add_u32 s38, s34, 3145728
  s_add_u32 m0, s35, 0
  s_nop 0
  buffer_load_dwordx4 v3, s[8:11], s38 offen lds
  s_add_u32 s38, s38, 256
  s_add_u32 m0, s35, 8192
  s_mov_b64 exec, s[42:43]
  buffer_load_dwordx4 v3, s[8:11], s38 offen lds
  s_mov_b64 exec, -1
  s_add_u32 s38, s34, 3538944
  s_add_u32 m0, s35, 16384
  s_nop 0
  buffer_load_dwordx4 v3, s[8:11], s38 offen lds
  s_add_u32 s38, s38, 256
  s_add_u32 m0, s35, 24576
  s_mov_b64 exec, s[42:43]
  buffer_load_dwordx4 v3, s[8:11], s38 offen lds
  s_mov_b64 exec, -1
  s_add_u32 s38, s34, 3932160
  s_add_u32 m0, s35, 32768
  s_nop 0
  buffer_load_dwordx4 v3, s[8:11], s38 offen lds
  s_add_u32 s38, s38, 256
  s_add_u32 m0, s35, 40960
  s_mov_b64 exec, s[42:43]
  buffer_load_dwordx4 v3, s[8:11], s38 offen lds
  s_mov_b64 exec, -1
  s_add_u32 s38, s34, 4325376
  s_add_u32 m0, s35, 49152
  s_nop 0
  buffer_load_dwordx4 v3, s[8:11], s38 offen lds
  s_add_u32 s38, s38, 256
  s_add_u32 m0, s35, 57344
  s_mov_b64 exec, s[42:43]
  buffer_load_dwordx4 v3, s[8:11], s38 offen lds
  s_mov_b64 exec, -1
  s_waitcnt vmcnt(8)
  s_barrier
  ds_read_b64_tr_b16 v[112:113], v6 offset:0
  ds_read_b64_tr_b16 v[114:115], v6 offset:1024
  ds_read_b64_tr_b16 v[192:193], v7 offset:0
  ds_read_b64_tr_b16 v[194:195], v7 offset:1024
  ds_read_b64_tr_b16 v[116:117], v6 offset:16384
  ds_read_b64_tr_b16 v[118:119], v6 offset:17408
  ds_read_b64_tr_b16 v[196:197], v7 offset:16384
  ds_read_b64_tr_b16 v[198:199], v7 offset:17408
  ds_read_b64_tr_b16 v[120:121], v6 offset:32768
  ds_read_b64_tr_b16 v[122:123], v6 offset:33792
  ds_read_b64_tr_b16 v[200:201], v7 offset:32768
  ds_read_b64_tr_b16 v[202:203], v7 offset:33792
  ds_read_b64_tr_b16 v[124:125], v6 offset:49152
  ds_read_b64_tr_b16 v[126:127], v6 offset:50176
  ds_read_b64_tr_b16 v[204:205], v7 offset:49152
  ds_read_b64_tr_b16 v[206:207], v7 offset:50176
  v_xor_b32 v6, 0x10000, v6
  v_xor_b32 v7, 0x10000, v7
  s_waitcnt lgkmcnt(0)
  s_barrier
  s_add_u32 s38, s34, 4718592
  s_add_u32 m0, s35, 65536
  s_nop 0
  buffer_load_dwordx4 v3, s[8:11], s38 offen lds
  s_add_u32 s38, s38, 256
  s_add_u32 m0, s35, 73728
  s_mov_b64 exec, s[42:43]
  buffer_load_dwordx4 v3, s[8:11], s38 offen lds
  s_mov_b64 exec, -1
  s_add_u32 s38, s34, 5111808
  s_add_u32 m0, s35, 81920
  s_nop 0
  buffer_load_dwordx4 v3, s[8:11], s38 offen lds
  s_add_u32 s38, s38, 256
  s_add_u32 m0, s35, 90112
  s_mov_b64 exec, s[42:43]
  buffer_load_dwordx4 v3, s[8:11], s38 offen lds
  s_mov_b64 exec, -1
  s_add_u32 s38, s34, 5505024
  s_add_u32 m0, s35, 98304
  s_nop 0
  buffer_load_dwordx4 v3, s[8:11], s38 offen lds
  s_add_u32 s38, s38, 256
  s_add_u32 m0, s35, 106496
  s_mov_b64 exec, s[42:43]
  buffer_load_dwordx4 v3, s[8:11], s38 offen lds
  s_mov_b64 exec, -1
  s_add_u32 s38, s34, 5898240
  s_add_u32 m0, s35, 114688
  s_nop 0
  buffer_load_dwordx4 v3, s[8:11], s38 offen lds
  s_add_u32 s38, s38, 256
  s_add_u32 m0, s35, 122880
  s_mov_b64 exec, s[42:43]
  buffer_load_dwordx4 v3, s[8:11], s38 offen lds
  s_mov_b64 exec, -1
  s_waitcnt vmcnt(8)
  s_barrier
  ds_read_b64_tr_b16 v[128:129], v6 offset:0
  ds_read_b64_tr_b16 v[130:131], v6 offset:1024
  ds_read_b64_tr_b16 v[208:209], v7 offset:0
  ds_read_b64_tr_b16 v[210:211], v7 offset:1024
  ds_read_b64_tr_b16 v[132:133], v6 offset:16384
  ds_read_b64_tr_b16 v[134:135], v6 offset:17408
  ds_read_b64_tr_b16 v[212:213], v7 offset:16384
  ds_read_b64_tr_b16 v[214:215], v7 offset:17408
  ds_read_b64_tr_b16 v[136:137], v6 offset:32768
  ds_read_b64_tr_b16 v[138:139], v6 offset:33792
  ds_read_b64_tr_b16 v[216:217], v7 offset:32768
  ds_read_b64_tr_b16 v[218:219], v7 offset:33792
  ds_read_b64_tr_b16 v[140:141], v6 offset:49152
  ds_read_b64_tr_b16 v[142:143], v6 offset:50176
  ds_read_b64_tr_b16 v[220:221], v7 offset:49152
  ds_read_b64_tr_b16 v[222:223], v7 offset:50176
  v_xor_b32 v6, 0x10000, v6
  v_xor_b32 v7, 0x10000, v7
  s_waitcnt lgkmcnt(0)
  s_barrier
  s_add_u32 s38, s34, 6291456
  s_add_u32 m0, s35, 0
  s_nop 0
  buffer_load_dwordx4 v3, s[8:11], s38 offen lds
  s_add_u32 s38, s38, 256
  s_add_u32 m0, s35, 8192
  s_mov_b64 exec, s[42:43]
  buffer_load_dwordx4 v3, s[8:11], s38 offen lds
  s_mov_b64 exec, -1
  s_add_u32 s38, s34, 6684672
  s_add_u32 m0, s35, 16384
  s_nop 0
  buffer_load_dwordx4 v3, s[8:11], s38 offen lds
  s_add_u32 s38, s38, 256
  s_add_u32 m0, s35, 24576
  s_mov_b64 exec, s[42:43]
  buffer_load_dwordx4 v3, s[8:11], s38 offen lds
  s_mov_b64 exec, -1
  s_add_u32 s38, s34, 7077888
  s_add_u32 m0, s35, 32768
  s_nop 0
  buffer_load_dwordx4 v3, s[8:11], s38 offen lds
  s_add_u32 s38, s38, 256
  s_add_u32 m0, s35, 40960
  s_mov_b64 exec, s[42:43]
  buffer_load_dwordx4 v3, s[8:11], s38 offen lds
  s_mov_b64 exec, -1
  s_add_u32 s38, s34, 7471104
  s_add_u32 m0, s35, 49152
  s_nop 0
  buffer_load_dwordx4 v3, s[8:11], s38 offen lds
  s_add_u32 s38, s38, 256
  s_add_u32 m0, s35, 57344
  s_mov_b64 exec, s[42:43]
  buffer_load_dwordx4 v3, s[8:11], s38 offen lds
  s_mov_b64 exec, -1
  s_waitcnt vmcnt(8)
  s_barrier
  ds_read_b64_tr_b16 v[144:145], v6 offset:0
  ds_read_b64_tr_b16 v[146:147], v6 offset:1024
  ds_read_b64_tr_b16 v[224:225], v7 offset:0
  ds_read_b64_tr_b16 v[226:227], v7 offset:1024
  ds_read_b64_tr_b16 v[148:149], v6 offset:16384
  ds_read_b64_tr_b16 v[150:151], v6 offset:17408
  ds_read_b64_tr_b16 v[228:229], v7 offset:16384
  ds_read_b64_tr_b16 v[230:231], v7 offset:17408
  ds_read_b64_tr_b16 v[152:153], v6 offset:32768
  ds_read_b64_tr_b16 v[154:155], v6 offset:33792
  ds_read_b64_tr_b16 v[232:233], v7 offset:32768
  ds_read_b64_tr_b16 v[234:235], v7 offset:33792
  ds_read_b64_tr_b16 v[156:157], v6 offset:49152
  ds_read_b64_tr_b16 v[158:159], v6 offset:50176
  ds_read_b64_tr_b16 v[236:237], v7 offset:49152
  ds_read_b64_tr_b16 v[238:239], v7 offset:50176
  v_xor_b32 v6, 0x10000, v6
  v_xor_b32 v7, 0x10000, v7
  s_waitcnt lgkmcnt(0)
  s_waitcnt vmcnt(0)
  s_barrier
  ds_read_b64_tr_b16 v[160:161], v6 offset:0
  ds_read_b64_tr_b16 v[162:163], v6 offset:1024
  ds_read_b64_tr_b16 v[240:241], v7 offset:0
  ds_read_b64_tr_b16 v[242:243], v7 offset:1024
  ds_read_b64_tr_b16 v[164:165], v6 offset:16384
  ds_read_b64_tr_b16 v[166:167], v6 offset:17408
  ds_read_b64_tr_b16 v[244:245], v7 offset:16384
  ds_read_b64_tr_b16 v[246:247], v7 offset:17408
  ds_read_b64_tr_b16 v[168:169], v6 offset:32768
  ds_read_b64_tr_b16 v[170:171], v6 offset:33792
  ds_read_b64_tr_b16 v[248:249], v7 offset:32768
  ds_read_b64_tr_b16 v[250:251], v7 offset:33792
  ds_read_b64_tr_b16 v[172:173], v6 offset:49152
  ds_read_b64_tr_b16 v[174:175], v6 offset:50176
  ds_read_b64_tr_b16 v[252:253], v7 offset:49152
  ds_read_b64_tr_b16 v[254:255], v7 offset:50176
  v_xor_b32 v6, 0x10000, v6
  v_xor_b32 v7, 0x10000, v7
  s_waitcnt lgkmcnt(0)
  s_barrier
  s_cmp_ge_u32 s20, 6
  s_cbranch_scc1 Lw_att
  s_lshl_b32 s38, s20, 10
  v_add_u32 v5, s38, v2
  s_mov_b32 s25, 122880
  s_mov_b32 s26, 135168
  s_mov_b32 s27, 147456
  s_mov_b32 s22, 0
  s_mul_i32 s35, s20, 10240
  s_add_u32 s28, s35, 14680064
  s_mov_b32 s30, 0
  s_mov_b32 s31, 40960
  s_mov_b32 s32, 81920
  s_cmp_lt_u32 s20, 4
  s_cbranch_scc0 Lpb0_46
  s_add_u32 m0, s30, s35
  s_add_u32 s38, s28, 4096
  s_add_u32 s39, s28, 8192
  buffer_load_dwordx4 v2, s[4:7], s28 offen offset:0 sc1 lds
  buffer_load_dwordx4 v2, s[4:7], s28 offen offset:1024 sc1 lds
  buffer_load_dwordx4 v2, s[4:7], s28 offen offset:2048 sc1 lds
  buffer_load_dwordx4 v2, s[4:7], s28 offen offset:3072 sc1 lds
  s_add_u32 m0, m0, 4096
  s_nop 0
  buffer_load_dwordx4 v2, s[4:7], s38 offen offset:0 sc1 lds
  buffer_load_dwordx4 v2, s[4:7], s38 offen offset:1024 sc1 lds
  buffer_load_dwordx4 v2, s[4:7], s38 offen offset:2048 sc1 lds
  buffer_load_dwordx4 v2, s[4:7], s38 offen offset:3072 sc1 lds
  s_add_u32 m0, m0, 4096
  s_nop 0
  buffer_load_dwordx4 v2, s[4:7], s39 offen offset:0 sc1 lds
  buffer_load_dwordx4 v2, s[4:7], s39 offen offset:1024 sc1 lds
  s_add_u32 s28, s28, 40960
  s_setprio 1
  s_waitcnt vmcnt(0)
Lpa_44:
  v_add_u32 v3, s30, v2
  s_barrier
  ds_read_b128 v[32:35], v3 offset:0
  ds_read_b128 v[36:39], v3 offset:1024
  ds_read_b128 v[40:43], v3 offset:2048
  ds_read_b128 v[44:47], v3 offset:3072
  ds_read_b128 v[48:51], v3 offset:4096
  ds_read_b128 v[52:55], v3 offset:5120
  s_sub_u32 s40, s22, 1
  s_max_i32 s40, s40, 0
  s_cmp_eq_u32 s22, 63
  s_cbranch_scc1 Lpnd_49
  s_add_u32 m0, s31, s35
  s_add_u32 s38, s28, 4096
  s_add_u32 s39, s28, 8192
  buffer_load_dwordx4 v2, s[4:7], s28 offen offset:0 sc1 lds
  buffer_load_dwordx4 v2, s[4:7], s28 offen offset:1024 sc1 lds
  buffer_load_dwordx4 v2, s[4:7], s28 offen offset:2048 sc1 lds
  buffer_load_dwordx4 v2, s[4:7], s28 offen offset:3072 sc1 lds
  s_add_u32 m0, m0, 4096
  s_nop 0
  buffer_load_dwordx4 v2, s[4:7], s38 offen offset:0 sc1 lds
  buffer_load_dwordx4 v2, s[4:7], s38 offen offset:1024 sc1 lds
  buffer_load_dwordx4 v2, s[4:7], s38 offen offset:2048 sc1 lds
  buffer_load_dwordx4 v2, s[4:7], s38 offen offset:3072 sc1 lds
  s_add_u32 m0, m0, 4096
  s_nop 0
  buffer_load_dwordx4 v2, s[4:7], s39 offen offset:0 sc1 lds
  buffer_load_dwordx4 v2, s[4:7], s39 offen offset:1024 sc1 lds
  s_add_u32 s28, s28, 40960
Lpnd_49:
  s_waitcnt lgkmcnt(4)
  v_mfma_f32_16x16x32_bf16 v[16:19], v[96:99], v[32:35], 0
  ds_read_b128 v[56:59], v3 offset:6144
  v_mfma_f32_16x16x32_bf16 v[24:27], v[176:179], v[32:35], 0
  ds_read_b128 v[60:63], v3 offset:7168
  v_mfma_f32_16x16x32_bf16 v[20:23], v[96:99], v[36:39], 0
  v_mfma_f32_16x16x32_bf16 v[28:31], v[176:179], v[36:39], 0
  s_waitcnt lgkmcnt(4)
  v_mfma_f32_16x16x32_bf16 v[16:19], v[100:103], v[40:43], v[16:19]
  ds_read_b128 v[32:35], v3 offset:8192
  v_mfma_f32_16x16x32_bf16 v[24:27], v[180:183], v[40:43], v[24:27]
  ds_read_b128 v[36:39], v3 offset:9216
  v_mfma_f32_16x16x32_bf16 v[20:23], v[100:103], v[44:47], v[20:23]
  v_mfma_f32_16x16x32_bf16 v[28:31], v[180:183], v[44:47], v[28:31]
  s_waitcnt lgkmcnt(4)
  v_mfma_f32_16x16x32_bf16 v[16:19], v[104:107], v[48:51], v[16:19]
  ds_read_b128 v[40:43], v3 offset:10240
  v_mfma_f32_16x16x32_bf16 v[24:27], v[184:187], v[48:51], v[24:27]
  ds_read_b128 v[44:47], v3 offset:11264
  v_mfma_f32_16x16x32_bf16 v[20:23], v[104:107], v[52:55], v[20:23]
  v_mfma_f32_16x16x32_bf16 v[28:31], v[184:187], v[52:55], v[28:31]
  s_waitcnt lgkmcnt(4)
  v_mfma_f32_16x16x32_bf16 v[16:19], v[108:111], v[56:59], v[16:19]
  ds_read_b128 v[48:51], v3 offset:12288
  v_mfma_f32_16x16x32_bf16 v[24:27], v[188:191], v[56:59], v[24:27]
  ds_read_b128 v[52:55], v3 offset:13312
  v_mfma_f32_16x16x32_bf16 v[20:23], v[108:111], v[60:63], v[20:23]
  v_mfma_f32_16x16x32_bf16 v[28:31], v[188:191], v[60:63], v[28:31]
  s_waitcnt lgkmcnt(4)
  v_mfma_f32_16x16x32_bf16 v[16:19], v[112:115], v[32:35], v[16:19]
  ds_read_b128 v[56:59], v3 offset:14336
  v_mfma_f32_16x16x32_bf16 v[24:27], v[192:195], v[32:35], v[24:27]
  ds_read_b128 v[60:63], v3 offset:15360
  v_mfma_f32_16x16x32_bf16 v[20:23], v[112:115], v[36:39], v[20:23]
  v_mfma_f32_16x16x32_bf16 v[28:31], v[192:195], v[36:39], v[28:31]
  s_waitcnt lgkmcnt(4)
  v_mfma_f32_16x16x32_bf16 v[16:19], v[116:119], v[40:43], v[16:19]
  ds_read_b128 v[32:35], v3 offset:16384
  v_mfma_f32_16x16x32_bf16 v[24:27], v[196:199], v[40:43], v[24:27]
  ds_read_b128 v[36:39], v3 offset:17408
  v_mfma_f32_16x16x32_bf16 v[20:23], v[116:119], v[44:47], v[20:23]
  v_mfma_f32_16x16x32_bf16 v[28:31], v[196:199], v[44:47], v[28:31]
  s_waitcnt lgkmcnt(4)
  v_mfma_f32_16x16x32_bf16 v[16:19], v[120:123], v[48:51], v[16:19]
  ds_read_b128 v[40:43], v3 offset:18432
  v_mfma_f32_16x16x32_bf16 v[24:27], v[200:203], v[48:51], v[24:27]
  ds_read_b128 v[44:47], v3 offset:19456
  v_mfma_f32_16x16x32_bf16 v[20:23], v[120:123], v[52:55], v[20:23]
  v_mfma_f32_16x16x32_bf16 v[28:31], v[200:203], v[52:55], v[28:31]
  s_waitcnt lgkmcnt(4)
  v_mfma_f32_16x16x32_bf16 v[16:19], v[124:127], v[56:59], v[16:19]
  ds_read_b128 v[48:51], v3 offset:20480
  v_mfma_f32_16x16x32_bf16 v[24:27], v[204:207], v[56:59], v[24:27]
  ds_read_b128 v[52:55], v3 offset:21504
  v_mfma_f32_16x16x32_bf16 v[20:23], v[124:127], v[60:63], v[20:23]
  v_mfma_f32_16x16x32_bf16 v[28:31], v[204:207], v[60:63], v[28:31]
  s_waitcnt lgkmcnt(4)
  v_mfma_f32_16x16x32_bf16 v[16:19], v[128:131], v[32:35], v[16:19]
  ds_read_b128 v[56:59], v3 offset:22528
  v_mfma_f32_16x16x32_bf16 v[24:27], v[208:211], v[32:35], v[24:27]
  ds_read_b128 v[60:63], v3 offset:23552
  v_mfma_f32_16x16x32_bf16 v[20:23], v[128:131], v[36:39], v[20:23]
  v_mfma_f32_16x16x32_bf16 v[28:31], v[208:211], v[36:39], v[28:31]
  s_waitcnt lgkmcnt(4)
  v_mfma_f32_16x16x32_bf16 v[16:19], v[132:135], v[40:43], v[16:19]
  ds_read_b128 v[32:35], v3 offset:24576
  v_mfma_f32_16x16x32_bf16 v[24:27], v[212:215], v[40:43], v[24:27]
  ds_read_b128 v[36:39], v3 offset:25600
  v_mfma_f32_16x16x32_bf16 v[20:23], v[132:135], v[44:47], v[20:23]
  v_mfma_f32_16x16x32_bf16 v[28:31], v[212:215], v[44:47], v[28:31]
  s_waitcnt lgkmcnt(4)
  v_mfma_f32_16x16x32_bf16 v[16:19], v[136:139], v[48:51], v[16:19]
  ds_read_b128 v[40:43], v3 offset:26624
  v_mfma_f32_16x16x32_bf16 v[24:27], v[216:219], v[48:51], v[24:27]
  ds_read_b128 v[44:47], v3 offset:27648
  v_mfma_f32_16x16x32_bf16 v[20:23], v[136:139], v[52:55], v[20:23]
  v_mfma_f32_16x16x32_bf16 v[28:31], v[216:219], v[52:55], v[28:31]
  s_waitcnt lgkmcnt(4)
  v_mfma_f32_16x16x32_bf16 v[16:19], v[140:143], v[56:59], v[16:19]
  ds_read_b128 v[48:51], v3 offset:28672
  v_mfma_f32_16x16x32_bf16 v[24:27], v[220:223], v[56:59], v[24:27]
  ds_read_b128 v[52:55], v3 offset:29696
  v_mfma_f32_16x16x32_bf16 v[20:23], v[140:143], v[60:63], v[20:23]
  v_mfma_f32_16x16x32_bf16 v[28:31], v[220:223], v[60:63], v[28:31]
  s_waitcnt lgkmcnt(4)
  v_mfma_f32_16x16x32_bf16 v[16:19], v[144:147], v[32:35], v[16:19]
  ds_read_b128 v[56:59], v3 offset:30720
  v_mfma_f32_16x16x32_bf16 v[24:27], v[224:227], v[32:35], v[24:27]
  ds_read_b128 v[60:63], v3 offset:31744
  v_mfma_f32_16x16x32_bf16 v[20:23], v[144:147], v[36:39], v[20:23]
  v_mfma_f32_16x16x32_bf16 v[28:31], v[224:227], v[36:39], v[28:31]
  s_waitcnt lgkmcnt(4)
  v_mfma_f32_16x16x32_bf16 v[16:19], v[148:151], v[40:43], v[16:19]
  ds_read_b128 v[32:35], v3 offset:32768
  v_mfma_f32_16x16x32_bf16 v[24:27], v[228:231], v[40:43], v[24:27]
  ds_read_b128 v[36:39], v3 offset:33792
  v_mfma_f32_16x16x32_bf16 v[20:23], v[148:151], v[44:47], v[20:23]
  v_mfma_f32_16x16x32_bf16 v[28:31], v[228:231], v[44:47], v[28:31]
  s_waitcnt lgkmcnt(4)
  v_mfma_f32_16x16x32_bf16 v[16:19], v[152:155], v[48:51], v[16:19]
  ds_read_b128 v[40:43], v3 offset:34816
  v_mfma_f32_16x16x32_bf16 v[24:27], v[232:235], v[48:51], v[24:27]
  ds_read_b128 v[44:47], v3 offset:35840
  v_mfma_f32_16x16x32_bf16 v[20:23], v[152:155], v[52:55], v[20:23]
  v_mfma_f32_16x16x32_bf16 v[28:31], v[232:235], v[52:55], v[28:31]
  s_waitcnt lgkmcnt(4)
  v_mfma_f32_16x16x32_bf16 v[16:19], v[156:159], v[56:59], v[16:19]
  ds_read_b128 v[48:51], v3 offset:36864
  v_mfma_f32_16x16x32_bf16 v[24:27], v[236:239], v[56:59], v[24:27]
  ds_read_b128 v[52:55], v3 offset:37888
  v_mfma_f32_16x16x32_bf16 v[20:23], v[156:159], v[60:63], v[20:23]
  v_mfma_f32_16x16x32_bf16 v[28:31], v[236:239], v[60:63], v[28:31]
  s_waitcnt lgkmcnt(4)
  v_mfma_f32_16x16x32_bf16 v[16:19], v[160:163], v[32:35], v[16:19]
  ds_read_b128 v[56:59], v3 offset:38912
  v_mfma_f32_16x16x32_bf16 v[24:27], v[240:243], v[32:35], v[24:27]
  ds_read_b128 v[60:63], v3 offset:39936
  v_mfma_f32_16x16x32_bf16 v[20:23], v[160:163], v[36:39], v[20:23]
  v_mfma_f32_16x16x32_bf16 v[28:31], v[240:243], v[36:39], v[28:31]
  s_waitcnt lgkmcnt(4)
  v_mfma_f32_16x16x32_bf16 v[16:19], v[164:167], v[40:43], v[16:19]
  v_mfma_f32_16x16x32_bf16 v[24:27], v[244:247], v[40:43], v[24:27]
  v_mfma_f32_16x16x32_bf16 v[20:23], v[164:167], v[44:47], v[20:23]
  v_mfma_f32_16x16x32_bf16 v[28:31], v[244:247], v[44:47], v[28:31]
  s_waitcnt lgkmcnt(2)
  v_mfma_f32_16x16x32_bf16 v[16:19], v[168:171], v[48:51], v[16:19]
  v_mfma_f32_16x16x32_bf16 v[24:27], v[248:251], v[48:51], v[24:27]
  v_mfma_f32_16x16x32_bf16 v[20:23], v[168:171], v[52:55], v[20:23]
  v_mfma_f32_16x16x32_bf16 v[28:31], v[248:251], v[52:55], v[28:31]
  s_waitcnt lgkmcnt(0)
  v_mfma_f32_16x16x32_bf16 v[16:19], v[172:175], v[56:59], v[16:19]
  v_mfma_f32_16x16x32_bf16 v[24:27], v[252:255], v[56:59], v[24:27]
  v_mfma_f32_16x16x32_bf16 v[20:23], v[172:175], v[60:63], v[20:23]
  v_mfma_f32_16x16x32_bf16 v[28:31], v[252:255], v[60:63], v[28:31]
  s_mov_b32 s38, s30
  s_mov_b32 s30, s31
  s_mov_b32 s31, s32
  s_mov_b32 s32, s38
  s_add_u32 s22, s22, 1
  s_waitcnt vmcnt(0)
  v_add_u32 v6, s25, v5
  v_cvt_pk_bf16_f32 v64, v16, v17
  v_cvt_pk_bf16_f32 v65, v18, v19
  v_cvt_pk_bf16_f32 v66, v24, v25
  v_cvt_pk_bf16_f32 v67, v26, v27
  ds_write_b128 v6, v[64:67] offset:0
  v_cvt_pk_bf16_f32 v68, v20, v21
  v_cvt_pk_bf16_f32 v69, v22, v23
  v_cvt_pk_bf16_f32 v70, v28, v29
  v_cvt_pk_bf16_f32 v71, v30, v31
  ds_write_b128 v6, v[68:71] offset:6144
  s_mov_b32 s38, s25
  s_mov_b32 s25, s26
  s_mov_b32 s26, s27
  s_mov_b32 s27, s38
  s_waitcnt lgkmcnt(0)
  s_cmp_lt_u32 s22, 64
  s_cbranch_scc1 Lpa_44
  s_barrier
  s_waitcnt vmcnt(0)
  s_barrier
  s_branch Lw_end
Lpb0_46:
  s_barrier
  v_add_u32 v3, s30, v2
  ds_read_b128 v[32:35], v3 offset:0
  ds_read_b128 v[36:39], v3 offset:1024
  ds_read_b128 v[40:43], v3 offset:2048
  ds_read_b128 v[44:47], v3 offset:3072
  ds_read_b128 v[48:51], v3 offset:4096
  ds_read_b128 v[52:55], v3 offset:5120
  s_branch Lpb1_47
Lpb_45:
  s_setprio 2
  s_barrier
  s_waitcnt lgkmcnt(4)
  v_mfma_f32_16x16x32_bf16 v[16:19], v[136:139], v[48:51], v[16:19]
  ds_read_b128 v[40:43], v3 offset:26624
  v_mfma_f32_16x16x32_bf16 v[24:27], v[216:219], v[48:51], v[24:27]
  ds_read_b128 v[44:47], v3 offset:27648
  v_mfma_f32_16x16x32_bf16 v[20:23], v[136:139], v[52:55], v[20:23]
  v_mfma_f32_16x16x32_bf16 v[28:31], v[216:219], v[52:55], v[28:31]
  s_waitcnt lgkmcnt(4)
  v_mfma_f32_16x16x32_bf16 v[16:19], v[140:143], v[56:59], v[16:19]
  ds_read_b128 v[48:51], v3 offset:28672
  v_mfma_f32_16x16x32_bf16 v[24:27], v[220:223], v[56:59], v[24:27]
  ds_read_b128 v[52:55], v3 offset:29696
  v_mfma_f32_16x16x32_bf16 v[20:23], v[140:143], v[60:63], v[20:23]
  v_mfma_f32_16x16x32_bf16 v[28:31], v[220:223], v[60:63], v[28:31]
  s_waitcnt lgkmcnt(4)
  v_mfma_f32_16x16x32_bf16 v[16:19], v[144:147], v[32:35], v[16:19]
  ds_read_b128 v[56:59], v3 offset:30720
  v_mfma_f32_16x16x32_bf16 v[24:27], v[224:227], v[32:35], v[24:27]
  ds_read_b128 v[60:63], v3 offset:31744
  v_mfma_f32_16x16x32_bf16 v[20:23], v[144:147], v[36:39], v[20:23]
  v_mfma_f32_16x16x32_bf16 v[28:31], v[224:227], v[36:39], v[28:31]
  s_waitcnt lgkmcnt(4)
  v_mfma_f32_16x16x32_bf16 v[16:19], v[148:151], v[40:43], v[16:19]
  ds_read_b128 v[32:35], v3 offset:32768
  v_mfma_f32_16x16x32_bf16 v[24:27], v[228:231], v[40:43], v[24:27]
  ds_read_b128 v[36:39], v3 offset:33792
  v_mfma_f32_16x16x32_bf16 v[20:23], v[148:151], v[44:47], v[20:23]
  v_mfma_f32_16x16x32_bf16 v[28:31], v[228:231], v[44:47], v[28:31]
  s_waitcnt lgkmcnt(4)
  v_mfma_f32_16x16x32_bf16 v[16:19], v[152:155], v[48:51], v[16:19]
  ds_read_b128 v[40:43], v3 offset:34816
  v_mfma_f32_16x16x32_bf16 v[24:27], v[232:235], v[48:51], v[24:27]
  ds_read_b128 v[44:47], v3 offset:35840
  v_mfma_f32_16x16x32_bf16 v[20:23], v[152:155], v[52:55], v[20:23]
  v_mfma_f32_16x16x32_bf16 v[28:31], v[232:235], v[52:55], v[28:31]
  s_waitcnt lgkmcnt(4)
  v_mfma_f32_16x16x32_bf16 v[16:19], v[156:159], v[56:59], v[16:19]
  ds_read_b128 v[48:51], v3 offset:36864
  v_mfma_f32_16x16x32_bf16 v[24:27], v[236:239], v[56:59], v[24:27]
  ds_read_b128 v[52:55], v3 offset:37888
  v_mfma_f32_16x16x32_bf16 v[20:23], v[156:159], v[60:63], v[20:23]
  v_mfma_f32_16x16x32_bf16 v[28:31], v[236:239], v[60:63], v[28:31]
  s_waitcnt lgkmcnt(4)
  v_mfma_f32_16x16x32_bf16 v[16:19], v[160:163], v[32:35], v[16:19]
  ds_read_b128 v[56:59], v3 offset:38912
  v_mfma_f32_16x16x32_bf16 v[24:27], v[240:243], v[32:35], v[24:27]
  ds_read_b128 v[60:63], v3 offset:39936
  v_mfma_f32_16x16x32_bf16 v[20:23], v[160:163], v[36:39], v[20:23]
  v_mfma_f32_16x16x32_bf16 v[28:31], v[240:243], v[36:39], v[28:31]
  s_waitcnt lgkmcnt(4)
  v_mfma_f32_16x16x32_bf16 v[16:19], v[164:167], v[40:43], v[16:19]
  v_mfma_f32_16x16x32_bf16 v[24:27], v[244:247], v[40:43], v[24:27]
  v_mfma_f32_16x16x32_bf16 v[20:23], v[164:167], v[44:47], v[20:23]
  v_mfma_f32_16x16x32_bf16 v[28:31], v[244:247], v[44:47], v[28:31]
  s_waitcnt lgkmcnt(2)
  v_mfma_f32_16x16x32_bf16 v[16:19], v[168:171], v[48:51], v[16:19]
  v_mfma_f32_16x16x32_bf16 v[24:27], v[248:251], v[48:51], v[24:27]
  v_mfma_f32_16x16x32_bf16 v[20:23], v[168:171], v[52:55], v[20:23]
  v_mfma_f32_16x16x32_bf16 v[28:31], v[248:251], v[52:55], v[28:31]
  s_waitcnt lgkmcnt(0)
  v_mfma_f32_16x16x32_bf16 v[16:19], v[172:175], v[56:59], v[16:19]
  v_mfma_f32_16x16x32_bf16 v[24:27], v[252:255], v[56:59], v[24:27]
  v_mfma_f32_16x16x32_bf16 v[20:23], v[172:175], v[60:63], v[20:23]
  v_mfma_f32_16x16x32_bf16 v[28:31], v[252:255], v[60:63], v[28:31]
  s_mov_b32 s38, s30
  s_mov_b32 s30, s31
  s_mov_b32 s31, s32
  s_mov_b32 s32, s38
  s_add_u32 s22, s22, 1
  s_setprio 0
  s_cmp_eq_u32 s22, 64
  s_cbranch_scc1 Lpbe_48
  v_add_u32 v3, s30, v2
  ds_read_b128 v[32:35], v3 offset:0
  ds_read_b128 v[36:39], v3 offset:1024
  ds_read_b128 v[40:43], v3 offset:2048
  ds_read_b128 v[44:47], v3 offset:3072
  ds_read_b128 v[48:51], v3 offset:4096
  ds_read_b128 v[52:55], v3 offset:5120
  v_add_u32 v6, s25, v5
  v_cvt_pk_bf16_f32 v64, v16, v17
  v_cvt_pk_bf16_f32 v65, v18, v19
  v_cvt_pk_bf16_f32 v66, v24, v25
  v_cvt_pk_bf16_f32 v67, v26, v27
  ds_write_b128 v6, v[64:67] offset:0
  v_cvt_pk_bf16_f32 v68, v20, v21
  v_cvt_pk_bf16_f32 v69, v22, v23
  v_cvt_pk_bf16_f32 v70, v28, v29
  v_cvt_pk_bf16_f32 v71, v30, v31
  ds_write_b128 v6, v[68:71] offset:6144
  s_mov_b32 s38, s25
  s_mov_b32 s25, s26
  s_mov_b32 s26, s27
  s_mov_b32 s27, s38
  s_waitcnt lgkmcnt(0)
Lpb1_47:
  s_waitcnt lgkmcnt(4)
  v_mfma_f32_16x16x32_bf16 v[16:19], v[96:99], v[32:35], 0
  ds_read_b128 v[56:59], v3 offset:6144
  v_mfma_f32_16x16x32_bf16 v[24:27], v[176:179], v[32:35], 0
  ds_read_b128 v[60:63], v3 offset:7168
  v_mfma_f32_16x16x32_bf16 v[20:23], v[96:99], v[36:39], 0
  v_mfma_f32_16x16x32_bf16 v[28:31], v[176:179], v[36:39], 0
  s_waitcnt lgkmcnt(4)
  v_mfma_f32_16x16x32_bf16 v[16:19], v[100:103], v[40:43], v[16:19]
  ds_read_b128 v[32:35], v3 offset:8192
  v_mfma_f32_16x16x32_bf16 v[24:27], v[180:183], v[40:43], v[24:27]
  ds_read_b128 v[36:39], v3 offset:9216
  v_mfma_f32_16x16x32_bf16 v[20:23], v[100:103], v[44:47], v[20:23]
  v_mfma_f32_16x16x32_bf16 v[28:31], v[180:183], v[44:47], v[28:31]
  s_waitcnt lgkmcnt(4)
  v_mfma_f32_16x16x32_bf16 v[16:19], v[104:107], v[48:51], v[16:19]
  ds_read_b128 v[40:43], v3 offset:10240
  v_mfma_f32_16x16x32_bf16 v[24:27], v[184:187], v[48:51], v[24:27]
  ds_read_b128 v[44:47], v3 offset:11264
  v_mfma_f32_16x16x32_bf16 v[20:23], v[104:107], v[52:55], v[20:23]
  v_mfma_f32_16x16x32_bf16 v[28:31], v[184:187], v[52:55], v[28:31]
  s_waitcnt lgkmcnt(4)
  v_mfma_f32_16x16x32_bf16 v[16:19], v[108:111], v[56:59], v[16:19]
  ds_read_b128 v[48:51], v3 offset:12288
  v_mfma_f32_16x16x32_bf16 v[24:27], v[188:191], v[56:59], v[24:27]
  ds_read_b128 v[52:55], v3 offset:13312
  v_mfma_f32_16x16x32_bf16 v[20:23], v[108:111], v[60:63], v[20:23]
  v_mfma_f32_16x16x32_bf16 v[28:31], v[188:191], v[60:63], v[28:31]
  s_waitcnt lgkmcnt(4)
  v_mfma_f32_16x16x32_bf16 v[16:19], v[112:115], v[32:35], v[16:19]
  ds_read_b128 v[56:59], v3 offset:14336
  v_mfma_f32_16x16x32_bf16 v[24:27], v[192:195], v[32:35], v[24:27]
  ds_read_b128 v[60:63], v3 offset:15360
  v_mfma_f32_16x16x32_bf16 v[20:23], v[112:115], v[36:39], v[20:23]
  v_mfma_f32_16x16x32_bf16 v[28:31], v[192:195], v[36:39], v[28:31]
  s_waitcnt lgkmcnt(4)
  v_mfma_f32_16x16x32_bf16 v[16:19], v[116:119], v[40:43], v[16:19]
  ds_read_b128 v[32:35], v3 offset:16384
  v_mfma_f32_16x16x32_bf16 v[24:27], v[196:199], v[40:43], v[24:27]
  ds_read_b128 v[36:39], v3 offset:17408
  v_mfma_f32_16x16x32_bf16 v[20:23], v[116:119], v[44:47], v[20:23]
  v_mfma_f32_16x16x32_bf16 v[28:31], v[196:199], v[44:47], v[28:31]
  s_waitcnt lgkmcnt(4)
  v_mfma_f32_16x16x32_bf16 v[16:19], v[120:123], v[48:51], v[16:19]
  ds_read_b128 v[40:43], v3 offset:18432
  v_mfma_f32_16x16x32_bf16 v[24:27], v[200:203], v[48:51], v[24:27]
  ds_read_b128 v[44:47], v3 offset:19456
  v_mfma_f32_16x16x32_bf16 v[20:23], v[120:123], v[52:55], v[20:23]
  v_mfma_f32_16x16x32_bf16 v[28:31], v[200:203], v[52:55], v[28:31]
  s_waitcnt lgkmcnt(4)
  v_mfma_f32_16x16x32_bf16 v[16:19], v[124:127], v[56:59], v[16:19]
  ds_read_b128 v[48:51], v3 offset:20480
  v_mfma_f32_16x16x32_bf16 v[24:27], v[204:207], v[56:59], v[24:27]
  ds_read_b128 v[52:55], v3 offset:21504
  v_mfma_f32_16x16x32_bf16 v[20:23], v[124:127], v[60:63], v[20:23]
  v_mfma_f32_16x16x32_bf16 v[28:31], v[204:207], v[60:63], v[28:31]
  s_waitcnt lgkmcnt(4)
  v_mfma_f32_16x16x32_bf16 v[16:19], v[128:131], v[32:35], v[16:19]
  ds_read_b128 v[56:59], v3 offset:22528
  v_mfma_f32_16x16x32_bf16 v[24:27], v[208:211], v[32:35], v[24:27]
  ds_read_b128 v[60:63], v3 offset:23552
  v_mfma_f32_16x16x32_bf16 v[20:23], v[128:131], v[36:39], v[20:23]
  v_mfma_f32_16x16x32_bf16 v[28:31], v[208:211], v[36:39], v[28:31]
  s_waitcnt lgkmcnt(4)
  v_mfma_f32_16x16x32_bf16 v[16:19], v[132:135], v[40:43], v[16:19]
  ds_read_b128 v[32:35], v3 offset:24576
  v_mfma_f32_16x16x32_bf16 v[24:27], v[212:215], v[40:43], v[24:27]
  ds_read_b128 v[36:39], v3 offset:25600
  v_mfma_f32_16x16x32_bf16 v[20:23], v[132:135], v[44:47], v[20:23]
  v_mfma_f32_16x16x32_bf16 v[28:31], v[212:215], v[44:47], v[28:31]
  s_waitcnt vmcnt(0)
  s_branch Lpb_45
Lpbe_48:
  v_add_u32 v6, s25, v5
  v_cvt_pk_bf16_f32 v64, v16, v17
  v_cvt_pk_bf16_f32 v65, v18, v19
  v_cvt_pk_bf16_f32 v66, v24, v25
  v_cvt_pk_bf16_f32 v67, v26, v27
  ds_write_b128 v6, v[64:67] offset:0
  v_cvt_pk_bf16_f32 v68, v20, v21
  v_cvt_pk_bf16_f32 v69, v22, v23
  v_cvt_pk_bf16_f32 v70, v28, v29
  v_cvt_pk_bf16_f32 v71, v30, v31
  ds_write_b128 v6, v[68:71] offset:6144
  s_mov_b32 s38, s25
  s_mov_b32 s25, s26
  s_mov_b32 s26, s27
  s_mov_b32 s27, s38
  s_waitcnt lgkmcnt(0)
  s_waitcnt vmcnt(0)
  s_barrier
  s_branch Lw_end
Lw_att:
  s_sub_u32 s21, s20, 6
  s_mov_b32 s37, 0x3dd53b95
  s_mov_b64 s[42:43], 15
  s_setprio 3
  s_not_b64 s[44:45], s[42:43]
  s_mul_i32 s25, s19, 24576
  s_add_u32 s25, s25, 17825792
  s_mul_i32 s26, s19, 6144
  s_add_u32 s26, s26, 2097152
  s_mul_i32 s29, s16, 122880
  s_mul_i32 s38, s18, 12288
  s_add_u32 s29, s29, s38
  s_lshl_b32 s38, s21, 10
  s_add_u32 s29, s29, s38
  s_add_u32 s29, s29, 68157440
  s_mul_i32 s38, s19, 384
  s_add_u32 s38, s38, 1840640
  v_min_u32 v4, 6, v1
  v_lshl_add_u32 v4, v4, 7, s38
  s_mul_i32 s38, s18, 3
  s_add_u32 s39, s38, 2
  s_lshr_b32 s38, s38, 2
  s_lshr_b32 s39, s39, 2
  s_mul_i32 s40, s16, 12
  s_add_u32 s38, s38, s40
  s_add_u32 s39, s39, s40
  s_lshl_b32 s38, s38, 7
  s_lshl_b32 s39, s39, 7
  s_add_u32 s38, s38, 1835008
  s_add_u32 s39, s39, 1835008
  v_writelane_b32 v4, s38, 0
  v_writelane_b32 v4, s39, 1
  s_add_u32 s38, s38, 768
  s_add_u32 s39, s39, 768
  v_writelane_b32 v4, s38, 2
  v_writelane_b32 v4, s39, 3
  s_lshl_b32 s38, s19, 1
  s_add_u32 s38, s38, s21
  s_lshl_b32 s38, s38, 7
  s_add_u32 s38, s38, 1853440
  v_mov_b32 v5, 0x40000000
  v_writelane_b32 v5, s38, 0
  v_bfe_u32 v3, v1, 4, 2
  v_lshlrev_b32 v3, 7, v3
  v_bfe_u32 v8, v1, 2, 2
  v_lshl_add_u32 v3, v8, 5, v3
  v_bfe_u32 v8, v1, 0, 1
  v_lshl_add_u32 v3, v8, 4, v3
  s_mul_i32 s38, s21, 6144
  v_add_u32 v7, s38, v2
  s_mov_b32 s30, 122880
  s_mov_b32 s31, 135168
  s_mov_b32 s32, 147456
  s_lshl_b32 s38, s21, 4
  v_and_b32 v8, 15, v1
  v_add_u32 v8, s38, v8
  v_lshrrev_b32 v9, 4, v1
  v_lshlrev_b32 v9, 2, v9
  v_sub_u32 v8, v8, v9
  v_mov_b32 v9, 0xf149f2ca
  v_cmp_le_i32 vcc, 0, v8
  s_nop 1
  v_cndmask_b32 v16, v9, 0, vcc
  v_cmp_le_i32 vcc, 1, v8
  s_nop 1
  v_cndmask_b32 v17, v9, 0, vcc
  v_cmp_le_i32 vcc, 2, v8
  s_nop 1
  v_cndmask_b32 v18, v9, 0, vcc
  v_cmp_le_i32 vcc, 3, v8
  s_nop 1
  v_cndmask_b32 v19, v9, 0, vcc
  v_cmp_le_i32 vcc, 16, v8
  s_nop 1
  v_cndmask_b32 v20, v9, 0, vcc
  v_cmp_le_i32 vcc, 17, v8
  s_nop 1
  v_cndmask_b32 v21, v9, 0, vcc
  v_cmp_le_i32 vcc, 18, v8
  s_nop 1
  v_cndmask_b32 v22, v9, 0, vcc
  v_cmp_le_i32 vcc, 19, v8
  s_nop 1
  v_cndmask_b32 v23, v9, 0, vcc
  v_mov_b32 v128, 0
  v_mov_b32 v129, 0
  v_mov_b32 v130, 0
  v_mov_b32 v131, 0
  v_mov_b32 v132, 0
  v_mov_b32 v133, 0
  v_mov_b32 v134, 0
  v_mov_b32 v135, 0
  v_mov_b32 v136, 0
  v_mov_b32 v137, 0
  v_mov_b32 v138, 0
  v_mov_b32 v139, 0
  v_mov_b32 v140, 0
  v_mov_b32 v141, 0
  v_mov_b32 v142, 0
  v_mov_b32 v143, 0
  v_mov_b32 v144, 0
  v_mov_b32 v145, 0
  v_mov_b32 v146, 0
  v_mov_b32 v147, 0
  v_mov_b32 v148, 0
  v_mov_b32 v149, 0
  v_mov_b32 v150, 0
  v_mov_b32 v151, 0
  v_mov_b32 v41, 0
  v_mov_b32 v42, 0
  v_mov_b32 v12, v2
  v_mov_b32 v44, -1
  v_mov_b32 v45, -1
  v_mov_b32 v46, -1
  v_mov_b32 v47, -1
  s_add_u32 s38, s29, 28999680
  buffer_store_dwordx4 v[44:47], v2, s[4:7], s38 offen offset:0 sc1
  buffer_store_dwordx4 v[44:47], v2, s[4:7], s38 offen offset:2048 sc1
  s_add_u32 s38, s29, 29003776
  buffer_store_dwordx4 v[44:47], v2, s[4:7], s38 offen offset:0 sc1
  buffer_store_dwordx4 v[44:47], v2, s[4:7], s38 offen offset:2048 sc1
  s_add_u32 s38, s29, 29007872
  buffer_store_dwordx4 v[44:47], v2, s[4:7], s38 offen offset:0 sc1
  buffer_store_dwordx4 v[44:47], v2, s[4:7], s38 offen offset:2048 sc1
  s_add_u32 s38, s29, 29491200
  buffer_store_dwordx4 v[44:47], v2, s[4:7], s38 offen offset:0 sc1
  buffer_store_dwordx4 v[44:47], v2, s[4:7], s38 offen offset:2048 sc1
  s_add_u32 s38, s29, 29495296
  buffer_store_dwordx4 v[44:47], v2, s[4:7], s38 offen offset:0 sc1
  buffer_store_dwordx4 v[44:47], v2, s[4:7], s38 offen offset:2048 sc1
  s_add_u32 s38, s29, 29499392
  buffer_store_dwordx4 v[44:47], v2, s[4:7], s38 offen offset:0 sc1
  buffer_store_dwordx4 v[44:47], v2, s[4:7], s38 offen offset:2048 sc1
  s_add_u32 s38, s29, 29982720
  buffer_store_dwordx4 v[44:47], v2, s[4:7], s38 offen offset:0 sc1
  buffer_store_dwordx4 v[44:47], v2, s[4:7], s38 offen offset:2048 sc1
  s_add_u32 s38, s29, 29986816
  buffer_store_dwordx4 v[44:47], v2, s[4:7], s38 offen offset:0 sc1
  buffer_store_dwordx4 v[44:47], v2, s[4:7], s38 offen offset:2048 sc1
  s_add_u32 s38, s29, 29990912
  buffer_store_dwordx4 v[44:47], v2, s[4:7], s38 offen offset:0 sc1
  buffer_store_dwordx4 v[44:47], v2, s[4:7], s38 offen offset:2048 sc1
  s_add_u32 s38, s29, 30474240
  buffer_store_dwordx4 v[44:47], v2, s[4:7], s38 offen offset:0 sc1
  buffer_store_dwordx4 v[44:47], v2, s[4:7], s38 offen offset:2048 sc1
  s_add_u32 s38, s29, 30478336
  buffer_store_dwordx4 v[44:47], v2, s[4:7], s38 offen offset:0 sc1
  buffer_store_dwordx4 v[44:47], v2, s[4:7], s38 offen offset:2048 sc1
  s_add_u32 s38, s29, 30482432
  buffer_store_dwordx4 v[44:47], v2, s[4:7], s38 offen offset:0 sc1
  buffer_store_dwordx4 v[44:47], v2, s[4:7], s38 offen offset:2048 sc1
  s_add_u32 s38, s29, 30965760
  buffer_store_dwordx4 v[44:47], v2, s[4:7], s38 offen offset:0 sc1
  buffer_store_dwordx4 v[44:47], v2, s[4:7], s38 offen offset:2048 sc1
  s_add_u32 s38, s29, 30969856
  buffer_store_dwordx4 v[44:47], v2, s[4:7], s38 offen offset:0 sc1
  buffer_store_dwordx4 v[44:47], v2, s[4:7], s38 offen offset:2048 sc1
  s_add_u32 s38, s29, 30973952
  buffer_store_dwordx4 v[44:47], v2, s[4:7], s38 offen offset:0 sc1
  buffer_store_dwordx4 v[44:47], v2, s[4:7], s38 offen offset:2048 sc1
  s_mov_b32 s22, 1
  s_mov_b32 s27, 0
  s_barrier
  s_barrier
Lp_50:
  buffer_load_dword v8, v4, s[4:7], 0 offen sc1
  s_waitcnt vmcnt(0)
  v_cmp_gt_u32 vcc, s22, v8
  s_and_b64 vcc, vcc, s[42:43]
  s_cbranch_scc0 Lpd_51
  s_sleep 2
  s_sub_u32 s24, s24, 1
  s_cbranch_scc0 Lp_50
  s_branch Lw_fail
Lpd_51:
  s_add_u32 s38, s25, 8192
  s_add_u32 s39, s25, 16384
  buffer_load_dwordx4 v[104:107], v12, s[4:7], s25 offen offset:0 sc1
  buffer_load_dwordx4 v[108:111], v12, s[4:7], s25 offen offset:1024 sc1
  buffer_load_dwordx4 v[112:115], v12, s[4:7], s38 offen offset:0 sc1
  buffer_load_dwordx4 v[116:119], v12, s[4:7], s38 offen offset:1024 sc1
  buffer_load_dwordx4 v[120:123], v12, s[4:7], s39 offen offset:0 sc1
  buffer_load_dwordx4 v[124:127], v12, s[4:7], s39 offen offset:1024 sc1
  s_cmp_eq_u32 s21, 0
  s_cbranch_scc1 Lk1_52
  buffer_load_dwordx4 v[128:131], v12, s[4:7], s25 offen offset:2048 sc1
  buffer_load_dwordx4 v[132:135], v12, s[4:7], s25 offen offset:3072 sc1
  buffer_load_dwordx4 v[136:139], v12, s[4:7], s38 offen offset:2048 sc1
  buffer_load_dwordx4 v[140:143], v12, s[4:7], s38 offen offset:3072 sc1
  buffer_load_dwordx4 v[144:147], v12, s[4:7], s39 offen offset:2048 sc1
  buffer_load_dwordx4 v[148:151], v12, s[4:7], s39 offen offset:3072 sc1
Lk1_52:
  s_add_u32 s40, s25, 4096
  s_add_u32 s38, s25, 12288
  s_add_u32 s39, s25, 20480
  buffer_load_dwordx4 v[152:155], v12, s[4:7], s40 offen offset:0 sc1
  buffer_load_dwordx4 v[156:159], v12, s[4:7], s40 offen offset:1024 sc1
  buffer_load_dwordx4 v[160:163], v12, s[4:7], s40 offen offset:2048 sc1
  buffer_load_dwordx4 v[164:167], v12, s[4:7], s40 offen offset:3072 sc1
  buffer_load_dwordx4 v[168:171], v12, s[4:7], s38 offen offset:0 sc1
  buffer_load_dwordx4 v[172:175], v12, s[4:7], s38 offen offset:1024 sc1
  buffer_load_dwordx4 v[176:179], v12, s[4:7], s38 offen offset:2048 sc1
  buffer_load_dwordx4 v[180:183], v12, s[4:7], s38 offen offset:3072 sc1
  buffer_load_dwordx4 v[184:187], v12, s[4:7], s39 offen offset:0 sc1
  buffer_load_dwordx4 v[188:191], v12, s[4:7], s39 offen offset:1024 sc1
  buffer_load_dwordx4 v[192:195], v12, s[4:7], s39 offen offset:2048 sc1
  buffer_load_dwordx4 v[196:199], v12, s[4:7], s39 offen offset:3072 sc1
  s_add_u32 s25, s25, 786432
Lw_aloop:
  v_add_u32 v6, s30, v7
  s_barrier
  ds_read_b128 v[44:47], v6 offset:0
  ds_read_b128 v[48:51], v6 offset:1024
  ds_read_b128 v[52:55], v6 offset:2048
  ds_read_b128 v[56:59], v6 offset:3072
  ds_read_b128 v[60:63], v6 offset:4096
  ds_read_b128 v[64:67], v6 offset:5120
  s_mov_b32 s38, s30
  s_mov_b32 s30, s31
  s_mov_b32 s31, s32
  s_mov_b32 s32, s38
  s_cmp_eq_u32 s27, 2
  s_waitcnt vmcnt(27)
  s_cbranch_scc1 Lw_adf
  s_waitcnt vmcnt(12)
Lw_adf:
  s_waitcnt lgkmcnt(5)
  v_mfma_f32_16x16x32_bf16 v[24:27], v[104:107], v[44:47], v[16:19]
  v_mfma_f32_16x16x32_bf16 v[28:31], v[128:131], v[44:47], v[20:23]
  s_waitcnt lgkmcnt(4)
  v_mfma_f32_16x16x32_bf16 v[24:27], v[108:111], v[48:51], v[24:27]
  v_mfma_f32_16x16x32_bf16 v[28:31], v[132:135], v[48:51], v[28:31]
  s_waitcnt lgkmcnt(3)
  v_mfma_f32_16x16x32_bf16 v[24:27], v[112:115], v[52:55], v[24:27]
  v_mfma_f32_16x16x32_bf16 v[28:31], v[136:139], v[52:55], v[28:31]
  s_waitcnt lgkmcnt(2)
  v_mfma_f32_16x16x32_bf16 v[24:27], v[116:119], v[56:59], v[24:27]
  v_mfma_f32_16x16x32_bf16 v[28:31], v[140:143], v[56:59], v[28:31]
  s_waitcnt lgkmcnt(1)
  v_mfma_f32_16x16x32_bf16 v[24:27], v[120:123], v[60:63], v[24:27]
  v_mfma_f32_16x16x32_bf16 v[28:31], v[144:147], v[60:63], v[28:31]
  s_waitcnt lgkmcnt(0)
  v_mfma_f32_16x16x32_bf16 v[24:27], v[124:127], v[64:67], v[24:27]
  v_mfma_f32_16x16x32_bf16 v[28:31], v[148:151], v[64:67], v[28:31]
  s_cmp_eq_u32 s27, 1
  s_cbranch_scc1 Lw_ahave
  s_cmp_gt_u32 s22, 59
  s_cbranch_scc0 Lw_afl
  s_waitcnt vmcnt(0)
  s_branch Lw_atp
Lw_atag:
  s_add_u32 s38, s26, 4096
  buffer_load_dwordx4 v[68:71], v3, s[4:7], s26 offen offset:0 sc1
  buffer_load_dwordx4 v[72:75], v3, s[4:7], s26 offen offset:512 sc1
  buffer_load_dwordx4 v[76:79], v3, s[4:7], s26 offen offset:2048 sc1
  buffer_load_dwordx4 v[80:83], v3, s[4:7], s26 offen offset:2560 sc1
  buffer_load_dwordx4 v[84:87], v3, s[4:7], s38 offen offset:0 sc1
  buffer_load_dwordx4 v[88:91], v3, s[4:7], s38 offen offset:512 sc1
  buffer_load_dwordx4 v[92:95], v2, s[4:7], s26 offen offset:1024 sc1
  buffer_load_dwordx4 v[96:99], v2, s[4:7], s26 offen offset:3072 sc1
  buffer_load_dwordx4 v[100:103], v2, s[4:7], s38 offen offset:1024 sc1
  s_waitcnt vmcnt(0)
Lw_atp:
  v_max3_u32 v11, v68, v72, v76
  v_max3_u32 v11, v11, v80, v84
  v_max3_u32 v11, v11, v88, v92
  v_max3_u32 v11, v11, v96, v100
  v_cmp_eq_u32 vcc, -1, v11
  s_cbranch_vccz Lrd_53
  s_sub_u32 s24, s24, 1
  s_cbranch_scc0 Lw_atag
  s_branch Lw_fail
Lrd_53:
  s_add_u32 s26, s26, 196608
  s_branch Lw_ahave
Lw_afl:
Lp_54:
  buffer_load_dword v8, v4, s[4:7], 0 offen sc1
  s_waitcnt vmcnt(0)
  v_cmp_gt_u32 vcc, s22, v8
  s_and_b64 vcc, vcc, s[44:45]
  s_cbranch_scc0 Lpd_55
  s_sleep 2
  s_sub_u32 s24, s24, 1
  s_cbranch_scc0 Lp_54
  s_branch Lw_fail
Lpd_55:
  s_add_u32 s38, s26, 4096
  buffer_load_dwordx4 v[68:71], v3, s[4:7], s26 offen offset:0 sc1
  buffer_load_dwordx4 v[72:75], v3, s[4:7], s26 offen offset:512 sc1
  buffer_load_dwordx4 v[76:79], v3, s[4:7], s26 offen offset:2048 sc1
  buffer_load_dwordx4 v[80:83], v3, s[4:7], s26 offen offset:2560 sc1
  buffer_load_dwordx4 v[84:87], v3, s[4:7], s38 offen offset:0 sc1
  buffer_load_dwordx4 v[88:91], v3, s[4:7], s38 offen offset:512 sc1
  buffer_load_dwordx4 v[92:95], v2, s[4:7], s26 offen offset:1024 sc1
  buffer_load_dwordx4 v[96:99], v2, s[4:7], s26 offen offset:3072 sc1
  buffer_load_dwordx4 v[100:103], v2, s[4:7], s38 offen offset:1024 sc1
  s_add_u32 s26, s26, 196608
Lw_ahave:
  s_min_u32 s41, s22, 63
  v_cmp_ge_u32 vcc, s41, v8
  s_and_b64 vcc, vcc, s[42:43]
  s_cbranch_scc0 Lw_akr
Lp_56:
  buffer_load_dword v8, v4, s[4:7], 0 offen sc1
  s_waitcnt vmcnt(0)
  v_cmp_ge_u32 vcc, s41, v8
  s_and_b64 vcc, vcc, s[42:43]
  s_cbranch_scc0 Lpd_57
  s_sleep 2
  s_sub_u32 s24, s24, 1
  s_cbranch_scc0 Lp_56
  s_branch Lw_fail
Lpd_57:
Lw_akr:
  s_cmp_eq_u32 s22, 64
  s_cselect_b32 s38, 0x40000000, 0
  v_or_b32 v12, s38, v2
  buffer_load_dword v8, v4, s[4:7], 0 offen sc1
  v_max3_f32 v9, v24, v25, v26
  v_max3_f32 v10, v27, v28, v29
  v_max3_f32 v9, v9, v30, v31
  s_waitcnt vmcnt(9)
  v_mfma_f32_16x16x32_bf16 v[32:35], v[68:71], v[44:47], 0
  s_waitcnt vmcnt(8)
  v_mfma_f32_16x16x32_bf16 v[32:35], v[72:75], v[48:51], v[32:35]
  s_waitcnt vmcnt(7)
  v_mfma_f32_16x16x32_bf16 v[32:35], v[76:79], v[52:55], v[32:35]
  s_waitcnt vmcnt(6)
  v_mfma_f32_16x16x32_bf16 v[32:35], v[80:83], v[56:59], v[32:35]
  s_waitcnt vmcnt(5)
  v_mfma_f32_16x16x32_bf16 v[32:35], v[84:87], v[60:63], v[32:35]
  s_waitcnt vmcnt(4)
  v_mfma_f32_16x16x32_bf16 v[32:35], v[88:91], v[64:67], v[32:35]
  s_add_u32 s38, s25, 8192
  s_add_u32 s39, s25, 16384
  buffer_load_dwordx4 v[104:107], v12, s[4:7], s25 offen offset:0 sc1
  buffer_load_dwordx4 v[108:111], v12, s[4:7], s25 offen offset:1024 sc1
  buffer_load_dwordx4 v[112:115], v12, s[4:7], s38 offen offset:0 sc1
  buffer_load_dwordx4 v[116:119], v12, s[4:7], s38 offen offset:1024 sc1
  buffer_load_dwordx4 v[120:123], v12, s[4:7], s39 offen offset:0 sc1
  buffer_load_dwordx4 v[124:127], v12, s[4:7], s39 offen offset:1024 sc1
  s_cmp_eq_u32 s21, 0
  s_cbranch_scc1 Lk1_58
  buffer_load_dwordx4 v[128:131], v12, s[4:7], s25 offen offset:2048 sc1
  buffer_load_dwordx4 v[132:135], v12, s[4:7], s25 offen offset:3072 sc1
  buffer_load_dwordx4 v[136:139], v12, s[4:7], s38 offen offset:2048 sc1
  buffer_load_dwordx4 v[140:143], v12, s[4:7], s38 offen offset:3072 sc1
  buffer_load_dwordx4 v[144:147], v12, s[4:7], s39 offen offset:2048 sc1
  buffer_load_dwordx4 v[148:151], v12, s[4:7], s39 offen offset:3072 sc1
Lk1_58:
  v_max3_f32 v10, v10, v32, v33
  v_max_f32 v9, v9, v10
  v_mov_b32 v10, v9
  s_nop 1
  v_permlane16_swap_b32 v9, v10
  v_max_f32 v9, v9, v10
  v_mov_b32 v10, v9
  s_nop 1
  v_permlane32_swap_b32 v9, v10
  v_max_f32 v9, v9, v10
  v_mul_f32 v9, s37, v9
  v_fma_f32 v24, v24, s37, -v9
  v_fma_f32 v25, v25, s37, -v9
  v_fma_f32 v26, v26, s37, -v9
  v_fma_f32 v27, v27, s37, -v9
  v_fma_f32 v28, v28, s37, -v9
  v_fma_f32 v29, v29, s37, -v9
  v_fma_f32 v30, v30, s37, -v9
  v_fma_f32 v31, v31, s37, -v9
  v_fma_f32 v32, v32, s37, -v9
  v_fma_f32 v33, v33, s37, -v9
  v_exp_f32 v24, v24
  v_exp_f32 v25, v25
  v_exp_f32 v26, v26
  v_exp_f32 v27, v27
  v_exp_f32 v28, v28
  v_exp_f32 v29, v29
  v_exp_f32 v30, v30
  v_exp_f32 v31, v31
  v_exp_f32 v32, v32
  v_exp_f32 v33, v33
  v_cvt_pk_bf16_f32 v36, v24, v25
  v_cvt_pk_bf16_f32 v37, v26, v27
  v_cvt_pk_bf16_f32 v38, v28, v29
  v_cvt_pk_bf16_f32 v39, v30, v31
  v_cvt_pk_bf16_f32 v40, v32, v33
  v_mov_b32 v43, v40
  s_waitcnt vmcnt(13)
  s_cmp_eq_u32 s21, 0
  s_cbranch_scc0 Lkw_59
  s_waitcnt vmcnt(7)
Lkw_59:
  v_mfma_f32_16x16x32_bf16 v[200:203], v[152:155], v[36:39], 0
  v_add_f32 v24, v24, v26
  v_add_f32 v25, v25, v27
  v_mfma_f32_16x16x32_bf16 v[204:207], v[156:159], v[36:39], 0
  v_add_f32 v28, v28, v30
  v_add_f32 v29, v29, v31
  v_mfma_f32_16x16x32_bf16 v[208:211], v[160:163], v[36:39], 0
  v_add_f32 v24, v24, v32
  v_add_f32 v25, v25, v33
  v_mfma_f32_16x16x32_bf16 v[212:215], v[164:167], v[36:39], 0
  v_add_f32 v24, v24, v28
  v_add_f32 v25, v25, v29
  v_mfma_f32_16x16x32_bf16 v[216:219], v[168:171], v[36:39], 0
  v_add_f32 v10, v24, v25
  v_mfma_f32_16x16x32_bf16 v[220:223], v[172:175], v[36:39], 0
  v_mov_b32 v11, v10
  v_mfma_f32_16x16x32_bf16 v[224:227], v[176:179], v[36:39], 0
  s_nop 0
  v_permlane16_swap_b32 v10, v11
  v_mfma_f32_16x16x32_bf16 v[228:231], v[180:183], v[36:39], 0
  v_add_f32 v10, v10, v11
  v_mfma_f32_16x16x32_bf16 v[232:235], v[184:187], v[36:39], 0
  v_mov_b32 v11, v10
  v_mfma_f32_16x16x32_bf16 v[236:239], v[188:191], v[36:39], 0
  s_nop 0
  v_permlane32_swap_b32 v10, v11
  v_mfma_f32_16x16x32_bf16 v[240:243], v[192:195], v[36:39], 0
  v_add_f32 v10, v10, v11
  v_mfma_f32_16x16x32_bf16 v[244:247], v[196:199], v[36:39], 0
  v_rcp_f32 v10, v10
  s_cmp_eq_u32 s22, 64
  s_cbranch_scc1 Lw_anv
  s_add_u32 s40, s25, 4096
  s_add_u32 s38, s25, 12288
  s_add_u32 s39, s25, 20480
  buffer_load_dwordx4 v[152:155], v12, s[4:7], s40 offen offset:0 sc1
  buffer_load_dwordx4 v[156:159], v12, s[4:7], s40 offen offset:1024 sc1
  buffer_load_dwordx4 v[160:163], v12, s[4:7], s40 offen offset:2048 sc1
  buffer_load_dwordx4 v[164:167], v12, s[4:7], s40 offen offset:3072 sc1
  buffer_load_dwordx4 v[168:171], v12, s[4:7], s38 offen offset:0 sc1
  buffer_load_dwordx4 v[172:175], v12, s[4:7], s38 offen offset:1024 sc1
  buffer_load_dwordx4 v[176:179], v12, s[4:7], s38 offen offset:2048 sc1
  buffer_load_dwordx4 v[180:183], v12, s[4:7], s38 offen offset:3072 sc1
  buffer_load_dwordx4 v[184:187], v12, s[4:7], s39 offen offset:0 sc1
  buffer_load_dwordx4 v[188:191], v12, s[4:7], s39 offen offset:1024 sc1
  buffer_load_dwordx4 v[192:195], v12, s[4:7], s39 offen offset:2048 sc1
  buffer_load_dwordx4 v[196:199], v12, s[4:7], s39 offen offset:3072 sc1
  s_add_u32 s25, s25, 786432
Lw_anv:
  s_add_u32 s38, s29, 4096
  s_add_u32 s39, s29, 8192
  v_mfma_f32_16x16x16_bf16 v[200:203], v[92:93], v[40:41], v[200:203]
  v_mfma_f32_16x16x16_bf16 v[204:207], v[94:95], v[40:41], v[204:207]
  v_mfma_f32_16x16x16_bf16 v[208:211], v[92:93], v[42:43], v[208:211]
  v_mfma_f32_16x16x16_bf16 v[212:215], v[94:95], v[42:43], v[212:215]
  v_mfma_f32_16x16x16_bf16 v[216:219], v[96:97], v[40:41], v[216:219]
  v_mfma_f32_16x16x16_bf16 v[220:223], v[98:99], v[40:41], v[220:223]
  s_nop 2
  v_mul_f32 v200, v10, v200
  v_mul_f32 v201, v10, v201
  v_mul_f32 v202, v10, v202
  v_mfma_f32_16x16x16_bf16 v[224:227], v[96:97], v[42:43], v[224:227]
  v_mul_f32 v203, v10, v203
  v_mul_f32 v204, v10, v204
  v_mul_f32 v205, v10, v205
  v_mfma_f32_16x16x16_bf16 v[228:231], v[98:99], v[42:43], v[228:231]
  v_mul_f32 v206, v10, v206
  v_mul_f32 v207, v10, v207
  v_cvt_pk_bf16_f32 v44, v200, v201
  v_mfma_f32_16x16x16_bf16 v[232:235], v[100:101], v[40:41], v[232:235]
  v_cvt_pk_bf16_f32 v45, v202, v203
  v_cvt_pk_bf16_f32 v46, v204, v205
  v_cvt_pk_bf16_f32 v47, v206, v207
  v_mfma_f32_16x16x16_bf16 v[236:239], v[102:103], v[40:41], v[236:239]
  buffer_store_dwordx4 v[44:47], v2, s[4:7], s29 offen offset:0 sc1
  v_mul_f32 v208, v10, v208
  v_mul_f32 v209, v10, v209
  v_mfma_f32_16x16x16_bf16 v[240:243], v[100:101], v[42:43], v[240:243]
  v_mul_f32 v210, v10, v210
  v_mul_f32 v211, v10, v211
  v_mul_f32 v212, v10, v212
  v_mfma_f32_16x16x16_bf16 v[244:247], v[102:103], v[42:43], v[244:247]
  v_mul_f32 v213, v10, v213
  v_mul_f32 v214, v10, v214
  v_mul_f32 v215, v10, v215
  v_cvt_pk_bf16_f32 v48, v208, v209
  v_cvt_pk_bf16_f32 v49, v210, v211
  v_cvt_pk_bf16_f32 v50, v212, v213
  v_cvt_pk_bf16_f32 v51, v214, v215
  buffer_store_dwordx4 v[48:51], v2, s[4:7], s29 offen offset:2048 sc1
  v_mul_f32 v216, v10, v216
  v_mul_f32 v217, v10, v217
  v_mul_f32 v218, v10, v218
  v_mul_f32 v219, v10, v219
  v_mul_f32 v220, v10, v220
  v_mul_f32 v221, v10, v221
  v_mul_f32 v222, v10, v222
  v_mul_f32 v223, v10, v223
  v_cvt_pk_bf16_f32 v52, v216, v217
  v_cvt_pk_bf16_f32 v53, v218, v219
  v_cvt_pk_bf16_f32 v54, v220, v221
  v_cvt_pk_bf16_f32 v55, v222, v223
  buffer_store_dwordx4 v[52:55], v2, s[4:7], s38 offen offset:0 sc1
  v_mul_f32 v224, v10, v224
  v_mul_f32 v225, v10, v225
  v_mul_f32 v226, v10, v226
  v_mul_f32 v227, v10, v227
  v_mul_f32 v228, v10, v228
  v_mul_f32 v229, v10, v229
  v_mul_f32 v230, v10, v230
  v_mul_f32 v231, v10, v231
  v_cvt_pk_bf16_f32 v56, v224, v225
  v_cvt_pk_bf16_f32 v57, v226, v227
  v_cvt_pk_bf16_f32 v58, v228, v229
  v_cvt_pk_bf16_f32 v59, v230, v231
  buffer_store_dwordx4 v[56:59], v2, s[4:7], s38 offen offset:2048 sc1
  v_mul_f32 v232, v10, v232
  v_mul_f32 v233, v10, v233
  v_mul_f32 v234, v10, v234
  v_mul_f32 v235, v10, v235
  v_mul_f32 v236, v10, v236
  v_mul_f32 v237, v10, v237
  v_mul_f32 v238, v10, v238
  v_mul_f32 v239, v10, v239
  v_cvt_pk_bf16_f32 v60, v232, v233
  v_cvt_pk_bf16_f32 v61, v234, v235
  v_cvt_pk_bf16_f32 v62, v236, v237
  v_cvt_pk_bf16_f32 v63, v238, v239
  buffer_store_dwordx4 v[60:63], v2, s[4:7], s39 offen offset:0 sc1
  v_mul_f32 v240, v10, v240
  v_mul_f32 v241, v10, v241
  v_mul_f32 v242, v10, v242
  v_mul_f32 v243, v10, v243
  v_mul_f32 v244, v10, v244
  v_mul_f32 v245, v10, v245
  v_mul_f32 v246, v10, v246
  v_mul_f32 v247, v10, v247
  v_cvt_pk_bf16_f32 v64, v240, v241
  v_cvt_pk_bf16_f32 v65, v242, v243
  v_cvt_pk_bf16_f32 v66, v244, v245
  v_cvt_pk_bf16_f32 v67, v246, v247
  buffer_store_dwordx4 v[64:67], v2, s[4:7], s39 offen offset:2048 sc1
  s_add_u32 s29, s29, 491520
  v_mov_b32 v9, s22
  s_add_u32 s22, s22, 1
  s_cmp_eq_u32 s22, 65
  s_cbranch_scc1 Lw_aend
  s_cmp_gt_u32 s22, 59
  s_cbranch_scc0 Lw_antp
  s_mov_b32 s27, 2
  s_add_u32 s38, s26, 4096
  buffer_load_dwordx4 v[68:71], v3, s[4:7], s26 offen offset:0 sc1
  buffer_load_dwordx4 v[72:75], v3, s[4:7], s26 offen offset:512 sc1
  buffer_load_dwordx4 v[76:79], v3, s[4:7], s26 offen offset:2048 sc1
  buffer_load_dwordx4 v[80:83], v3, s[4:7], s26 offen offset:2560 sc1
  buffer_load_dwordx4 v[84:87], v3, s[4:7], s38 offen offset:0 sc1
  buffer_load_dwordx4 v[88:91], v3, s[4:7], s38 offen offset:512 sc1
  buffer_load_dwordx4 v[92:95], v2, s[4:7], s26 offen offset:1024 sc1
  buffer_load_dwordx4 v[96:99], v2, s[4:7], s26 offen offset:3072 sc1
  buffer_load_dwordx4 v[100:103], v2, s[4:7], s38 offen offset:1024 sc1
  s_branch Lw_akv
Lw_antp:
  s_waitcnt vmcnt(30)
  s_cmp_eq_u32 s21, 0
  s_cbranch_scc0 Lkw_60
  s_waitcnt vmcnt(24)
Lkw_60:
  v_cmp_gt_u32 vcc, s22, v8
  s_mov_b32 s27, 0
  s_cbranch_vccnz Lw_akv
  s_cmp_gt_u32 s22, 59
  s_cbranch_scc1 Lw_akv
  s_mov_b32 s27, 1
  s_add_u32 s38, s26, 4096
  buffer_load_dwordx4 v[68:71], v3, s[4:7], s26 offen offset:0 sc1
  buffer_load_dwordx4 v[72:75], v3, s[4:7], s26 offen offset:512 sc1
  buffer_load_dwordx4 v[76:79], v3, s[4:7], s26 offen offset:2048 sc1
  buffer_load_dwordx4 v[80:83], v3, s[4:7], s26 offen offset:2560 sc1
  buffer_load_dwordx4 v[84:87], v3, s[4:7], s38 offen offset:0 sc1
  buffer_load_dwordx4 v[88:91], v3, s[4:7], s38 offen offset:512 sc1
  buffer_load_dwordx4 v[92:95], v2, s[4:7], s26 offen offset:1024 sc1
  buffer_load_dwordx4 v[96:99], v2, s[4:7], s26 offen offset:3072 sc1
  buffer_load_dwordx4 v[100:103], v2, s[4:7], s38 offen offset:1024 sc1
  s_add_u32 s26, s26, 196608
Lw_akv:
  s_cmp_gt_u32 s22, 60
  s_cbranch_scc1 Lw_aloop
  s_cmp_eq_u32 s27, 0
  s_waitcnt vmcnt(9)
  s_cbranch_scc0 Lw_aev
  s_waitcnt vmcnt(0)
Lw_aev:
  buffer_store_dword v9, v5, s[4:7], 0 offen sc1
  s_branch Lw_aloop
Lw_aend:
  s_waitcnt vmcnt(0)
  buffer_store_dword v9, v5, s[4:7], 0 offen sc1
  s_branch Lw_end
Lw_glu:
  s_load_dwordx2 s[8:9], s[0:1], 64
  s_mov_b32 s10, 1966080
  s_mov_b32 s11, 0x20000
  s_load_dwordx2 s[12:13], s[0:1], 72
  s_mov_b32 s14, 1966080
  s_mov_b32 s15, 0x20000
  s_sub_u32 s18, s17, 20
  s_mul_i32 s34, s16, 768
  s_lshl_b32 s38, s18, 8
  s_add_u32 s34, s34, s38
  s_waitcnt lgkmcnt(0)
  s_cmp_eq_u32 s20, 0
  s_cbranch_scc0 Lw0_61
Lp_62:
  buffer_load_ubyte v10, off, s[80:83], 0 offset:128 sc1
  s_waitcnt vmcnt(0)
  v_cmp_gt_u32 vcc, 36, v10
  s_cbranch_vccz Lpd_63
  s_sleep 16
  s_sub_u32 s24, s24, 1
  s_cbranch_scc0 Lp_62
  s_branch Lw_fail
Lpd_63:
  s_mul_i32 s38, s16, 1536
  s_add_u32 s38, s38, 1835008
  v_min_u32 v11, 11, v1
  v_lshlrev_b32 v11, 7, v11
Lp_64:
  buffer_load_dword v10, v11, s[4:7], s38 offen sc1
  s_waitcnt vmcnt(0)
  v_cmp_gt_u32 vcc, 1, v10
  s_cbranch_vccz Lpd_65
  s_sleep 8
  s_sub_u32 s24, s24, 1
  s_cbranch_scc0 Lp_64
  s_branch Lw_fail
Lpd_65:
Lw0_61:
  s_barrier
  v_lshrrev_b32 v4, 4, v1
  s_lshr_b32 s38, s20, 1
  s_and_b32 s38, s38, 1
  s_lshl_b32 s38, s38, 2
  v_or_b32 v5, s38, v4
  v_lshlrev_b32 v5, 1, v5
  v_and_b32 v6, 15, v1
  v_xor_b32 v5, v5, v6
  s_lshl_b32 s38, s20, 2
  v_add_u32 v4, s38, v4
  v_mul_u32_u24 v4, 3072, v4
  v_lshl_add_u32 v3, v5, 4, v4
  v_cmp_gt_u32 s[42:43], 8, v5
  s_lshl_b32 s35, s20, 10
  s_add_u32 s38, s34, 0
  s_add_u32 m0, s35, 0
  s_nop 0
  buffer_load_dwordx4 v3, s[8:11], s38 offen lds
  s_add_u32 m0, s35, 8192
  s_nop 0
  buffer_load_dwordx4 v3, s[12:15], s38 offen lds
  s_add_u32 s38, s34, 98304
  s_add_u32 m0, s35, 16384
  s_nop 0
  buffer_load_dwordx4 v3, s[8:11], s38 offen lds
  s_add_u32 m0, s35, 24576
  s_nop 0
  buffer_load_dwordx4 v3, s[12:15], s38 offen lds
  s_add_u32 s38, s34, 196608
  s_add_u32 m0, s35, 32768
  s_nop 0
  buffer_load_dwordx4 v3, s[8:11], s38 offen lds
  s_add_u32 m0, s35, 40960
  s_nop 0
  buffer_load_dwordx4 v3, s[12:15], s38 offen lds
  s_add_u32 s38, s34, 294912
  s_add_u32 m0, s35, 49152
  s_nop 0
  buffer_load_dwordx4 v3, s[8:11], s38 offen lds
  s_add_u32 m0, s35, 57344
  s_nop 0
  buffer_load_dwordx4 v3, s[12:15], s38 offen lds
  s_add_u32 s38, s34, 393216
  s_add_u32 m0, s35, 65536
  s_nop 0
  buffer_load_dwordx4 v3, s[8:11], s38 offen lds
  s_add_u32 m0, s35, 73728
  s_nop 0
  buffer_load_dwordx4 v3, s[12:15], s38 offen lds
  s_add_u32 s38, s34, 491520
  s_add_u32 m0, s35, 81920
  s_nop 0
  buffer_load_dwordx4 v3, s[8:11], s38 offen lds
  s_add_u32 m0, s35, 90112
  s_nop 0
  buffer_load_dwordx4 v3, s[12:15], s38 offen lds
  s_add_u32 s38, s34, 589824
  s_add_u32 m0, s35, 98304
  s_nop 0
  buffer_load_dwordx4 v3, s[8:11], s38 offen lds
  s_add_u32 m0, s35, 106496
  s_nop 0
  buffer_load_dwordx4 v3, s[12:15], s38 offen lds
  s_add_u32 s38, s34, 688128
  s_add_u32 m0, s35, 114688
  s_nop 0
  buffer_load_dwordx4 v3, s[8:11], s38 offen lds
  s_add_u32 m0, s35, 122880
  s_nop 0
  buffer_load_dwordx4 v3, s[12:15], s38 offen lds
  v_bfe_u32 v6, v1, 4, 2
  v_lshlrev_b32 v6, 11, v6
  v_bfe_u32 v8, v1, 2, 2
  v_lshl_add_u32 v6, v8, 8, v6
  v_bfe_u32 v8, v1, 2, 3
  s_and_b32 s38, s20, 6
  v_bfe_u32 v9, v1, 1, 1
  v_or_b32 v9, s38, v9
  v_xor_b32 v8, v8, v9
  v_lshl_add_u32 v6, v8, 5, v6
  v_and_b32 v9, 1, v1
  v_lshl_add_u32 v6, v9, 3, v6
  s_and_b32 s38, s20, 1
  s_lshl_b32 s38, s38, 4
  v_add_u32 v6, s38, v6
  v_add_u32 v7, 8192, v6
  s_waitcnt vmcnt(8)
  s_barrier
  ds_read_b64_tr_b16 v[96:97], v6 offset:0
  ds_read_b64_tr_b16 v[98:99], v6 offset:1024
  ds_read_b64_tr_b16 v[176:177], v7 offset:0
  ds_read_b64_tr_b16 v[178:179], v7 offset:1024
  ds_read_b64_tr_b16 v[100:101], v6 offset:16384
  ds_read_b64_tr_b16 v[102:103], v6 offset:17408
  ds_read_b64_tr_b16 v[180:181], v7 offset:16384
  ds_read_b64_tr_b16 v[182:183], v7 offset:17408
  ds_read_b64_tr_b16 v[104:105], v6 offset:32768
  ds_read_b64_tr_b16 v[106:107], v6 offset:33792
  ds_read_b64_tr_b16 v[184:185], v7 offset:32768
  ds_read_b64_tr_b16 v[186:187], v7 offset:33792
  ds_read_b64_tr_b16 v[108:109], v6 offset:49152
  ds_read_b64_tr_b16 v[110:111], v6 offset:50176
  ds_read_b64_tr_b16 v[188:189], v7 offset:49152
  ds_read_b64_tr_b16 v[190:191], v7 offset:50176
  v_xor_b32 v6, 0x10000, v6
  v_xor_b32 v7, 0x10000, v7
  s_waitcnt lgkmcnt(0)
  s_barrier
  s_add_u32 s38, s34, 786432
  s_add_u32 m0, s35, 0
  s_nop 0
  buffer_load_dwordx4 v3, s[8:11], s38 offen lds
  s_add_u32 m0, s35, 8192
  s_nop 0
  buffer_load_dwordx4 v3, s[12:15], s38 offen lds
  s_add_u32 s38, s34, 884736
  s_add_u32 m0, s35, 16384
  s_nop 0
  buffer_load_dwordx4 v3, s[8:11], s38 offen lds
  s_add_u32 m0, s35, 24576
  s_nop 0
  buffer_load_dwordx4 v3, s[12:15], s38 offen lds
  s_add_u32 s38, s34, 983040
  s_add_u32 m0, s35, 32768
  s_nop 0
  buffer_load_dwordx4 v3, s[8:11], s38 offen lds
  s_add_u32 m0, s35, 40960
  s_nop 0
  buffer_load_dwordx4 v3, s[12:15], s38 offen lds
  s_add_u32 s38, s34, 1081344
  s_add_u32 m0, s35, 49152
  s_nop 0
  buffer_load_dwordx4 v3, s[8:11], s38 offen lds
  s_add_u32 m0, s35, 57344
  s_nop 0
  buffer_load_dwordx4 v3, s[12:15], s38 offen lds
  s_waitcnt vmcnt(8)
  s_barrier
  ds_read_b64_tr_b16 v[112:113], v6 offset:0
  ds_read_b64_tr_b16 v[114:115], v6 offset:1024
  ds_read_b64_tr_b16 v[192:193], v7 offset:0
  ds_read_b64_tr_b16 v[194:195], v7 offset:1024
  ds_read_b64_tr_b16 v[116:117], v6 offset:16384
  ds_read_b64_tr_b16 v[118:119], v6 offset:17408
  ds_read_b64_tr_b16 v[196:197], v7 offset:16384
  ds_read_b64_tr_b16 v[198:199], v7 offset:17408
  ds_read_b64_tr_b16 v[120:121], v6 offset:32768
  ds_read_b64_tr_b16 v[122:123], v6 offset:33792
  ds_read_b64_tr_b16 v[200:201], v7 offset:32768
  ds_read_b64_tr_b16 v[202:203], v7 offset:33792
  ds_read_b64_tr_b16 v[124:125], v6 offset:49152
  ds_read_b64_tr_b16 v[126:127], v6 offset:50176
  ds_read_b64_tr_b16 v[204:205], v7 offset:49152
  ds_read_b64_tr_b16 v[206:207], v7 offset:50176
  v_xor_b32 v6, 0x10000, v6
  v_xor_b32 v7, 0x10000, v7
  s_waitcnt lgkmcnt(0)
  s_barrier
  s_add_u32 s38, s34, 1179648
  s_add_u32 m0, s35, 65536
  s_nop 0
  buffer_load_dwordx4 v3, s[8:11], s38 offen lds
  s_add_u32 m0, s35, 73728
  s_nop 0
  buffer_load_dwordx4 v3, s[12:15], s38 offen lds
  s_add_u32 s38, s34, 1277952
  s_add_u32 m0, s35, 81920
  s_nop 0
  buffer_load_dwordx4 v3, s[8:11], s38 offen lds
  s_add_u32 m0, s35, 90112
  s_nop 0
  buffer_load_dwordx4 v3, s[12:15], s38 offen lds
  s_add_u32 s38, s34, 1376256
  s_add_u32 m0, s35, 98304
  s_nop 0
  buffer_load_dwordx4 v3, s[8:11], s38 offen lds
  s_add_u32 m0, s35, 106496
  s_nop 0
  buffer_load_dwordx4 v3, s[12:15], s38 offen lds
  s_add_u32 s38, s34, 1474560
  s_add_u32 m0, s35, 114688
  s_nop 0
  buffer_load_dwordx4 v3, s[8:11], s38 offen lds
  s_add_u32 m0, s35, 122880
  s_nop 0
  buffer_load_dwordx4 v3, s[12:15], s38 offen lds
  s_waitcnt vmcnt(8)
  s_barrier
  ds_read_b64_tr_b16 v[128:129], v6 offset:0
  ds_read_b64_tr_b16 v[130:131], v6 offset:1024
  ds_read_b64_tr_b16 v[208:209], v7 offset:0
  ds_read_b64_tr_b16 v[210:211], v7 offset:1024
  ds_read_b64_tr_b16 v[132:133], v6 offset:16384
  ds_read_b64_tr_b16 v[134:135], v6 offset:17408
  ds_read_b64_tr_b16 v[212:213], v7 offset:16384
  ds_read_b64_tr_b16 v[214:215], v7 offset:17408
  ds_read_b64_tr_b16 v[136:137], v6 offset:32768
  ds_read_b64_tr_b16 v[138:139], v6 offset:33792
  ds_read_b64_tr_b16 v[216:217], v7 offset:32768
  ds_read_b64_tr_b16 v[218:219], v7 offset:33792
  ds_read_b64_tr_b16 v[140:141], v6 offset:49152
  ds_read_b64_tr_b16 v[142:143], v6 offset:50176
  ds_read_b64_tr_b16 v[220:221], v7 offset:49152
  ds_read_b64_tr_b16 v[222:223], v7 offset:50176
  v_xor_b32 v6, 0x10000, v6
  v_xor_b32 v7, 0x10000, v7
  s_waitcnt lgkmcnt(0)
  s_barrier
  s_add_u32 s38, s34, 1572864
  s_add_u32 m0, s35, 0
  s_nop 0
  buffer_load_dwordx4 v3, s[8:11], s38 offen lds
  s_add_u32 m0, s35, 8192
  s_nop 0
  buffer_load_dwordx4 v3, s[12:15], s38 offen lds
  s_add_u32 s38, s34, 1671168
  s_add_u32 m0, s35, 16384
  s_nop 0
  buffer_load_dwordx4 v3, s[8:11], s38 offen lds
  s_add_u32 m0, s35, 24576
  s_nop 0
  buffer_load_dwordx4 v3, s[12:15], s38 offen lds
  s_add_u32 s38, s34, 1769472
  s_add_u32 m0, s35, 32768
  s_nop 0
  buffer_load_dwordx4 v3, s[8:11], s38 offen lds
  s_add_u32 m0, s35, 40960
  s_nop 0
  buffer_load_dwordx4 v3, s[12:15], s38 offen lds
  s_add_u32 s38, s34, 1867776
  s_add_u32 m0, s35, 49152
  s_nop 0
  buffer_load_dwordx4 v3, s[8:11], s38 offen lds
  s_add_u32 m0, s35, 57344
  s_nop 0
  buffer_load_dwordx4 v3, s[12:15], s38 offen lds
  s_waitcnt vmcnt(8)
  s_barrier
  ds_read_b64_tr_b16 v[144:145], v6 offset:0
  ds_read_b64_tr_b16 v[146:147], v6 offset:1024
  ds_read_b64_tr_b16 v[224:225], v7 offset:0
  ds_read_b64_tr_b16 v[226:227], v7 offset:1024
  ds_read_b64_tr_b16 v[148:149], v6 offset:16384
  ds_read_b64_tr_b16 v[150:151], v6 offset:17408
  ds_read_b64_tr_b16 v[228:229], v7 offset:16384
  ds_read_b64_tr_b16 v[230:231], v7 offset:17408
  ds_read_b64_tr_b16 v[152:153], v6 offset:32768
  ds_read_b64_tr_b16 v[154:155], v6 offset:33792
  ds_read_b64_tr_b16 v[232:233], v7 offset:32768
  ds_read_b64_tr_b16 v[234:235], v7 offset:33792
  ds_read_b64_tr_b16 v[156:157], v6 offset:49152
  ds_read_b64_tr_b16 v[158:159], v6 offset:50176
  ds_read_b64_tr_b16 v[236:237], v7 offset:49152
  ds_read_b64_tr_b16 v[238:239], v7 offset:50176
  v_xor_b32 v6, 0x10000, v6
  v_xor_b32 v7, 0x10000, v7
  s_waitcnt lgkmcnt(0)
  s_waitcnt vmcnt(0)
  s_barrier
  ds_read_b64_tr_b16 v[160:161], v6 offset:0
  ds_read_b64_tr_b16 v[162:163], v6 offset:1024
  ds_read_b64_tr_b16 v[240:241], v7 offset:0
  ds_read_b64_tr_b16 v[242:243], v7 offset:1024
  ds_read_b64_tr_b16 v[164:165], v6 offset:16384
  ds_read_b64_tr_b16 v[166:167], v6 offset:17408
  ds_read_b64_tr_b16 v[244:245], v7 offset:16384
  ds_read_b64_tr_b16 v[246:247], v7 offset:17408
  ds_read_b64_tr_b16 v[168:169], v6 offset:32768
  ds_read_b64_tr_b16 v[170:171], v6 offset:33792
  ds_read_b64_tr_b16 v[248:249], v7 offset:32768
  ds_read_b64_tr_b16 v[250:251], v7 offset:33792
  ds_read_b64_tr_b16 v[172:173], v6 offset:49152
  ds_read_b64_tr_b16 v[174:175], v6 offset:50176
  ds_read_b64_tr_b16 v[252:253], v7 offset:49152
  ds_read_b64_tr_b16 v[254:255], v7 offset:50176
  v_xor_b32 v6, 0x10000, v6
  v_xor_b32 v7, 0x10000, v7
  s_waitcnt lgkmcnt(0)
  s_barrier
  s_lshl_b32 s38, s18, 3
  s_add_u32 s38, s38, s20
  s_mul_i32 s39, s16, 3
  s_add_u32 s39, s39, s18
  s_lshl_b32 s39, s39, 7
  s_add_u32 s39, s39, 1861632
  s_cmp_eq_u32 s20, 0
  s_cselect_b32 s39, s39, 0x40000000
  v_mov_b32 v4, 0x40000000
  v_writelane_b32 v4, s39, 0
  v_bfe_u32 v5, v1, 5, 1
  v_lshlrev_b32 v5, 10, v5
  v_bfe_u32 v6, v1, 0, 5
  v_lshl_add_u32 v5, v6, 4, v5
  s_lshr_b32 s39, s38, 1
  s_lshl_b32 s39, s39, 11
  s_and_b32 s38, s38, 1
  s_lshl_b32 s38, s38, 9
  s_add_u32 s38, s38, s39
  s_mul_i32 s29, s16, 122880
  s_add_u32 s29, s29, s38
  s_add_u32 s29, s29, 68255744
  s_mov_b32 s25, 122880
  s_mov_b32 s26, 135168
  s_mov_b32 s27, 147456
  s_mov_b32 s22, 0
  s_mul_i32 s35, s20, 10240
  s_add_u32 s28, s35, 14680064
  s_mov_b32 s30, 0
  s_mov_b32 s31, 40960
  s_mov_b32 s32, 81920
  s_cmp_lt_u32 s20, 4
  s_cbranch_scc0 Lpb0_68
  s_add_u32 m0, s30, s35
  s_add_u32 s38, s28, 4096
  s_add_u32 s39, s28, 8192
  buffer_load_dwordx4 v2, s[4:7], s28 offen offset:0 sc1 lds
  buffer_load_dwordx4 v2, s[4:7], s28 offen offset:1024 sc1 lds
  buffer_load_dwordx4 v2, s[4:7], s28 offen offset:2048 sc1 lds
  buffer_load_dwordx4 v2, s[4:7], s28 offen offset:3072 sc1 lds
  s_add_u32 m0, m0, 4096
  s_nop 0
  buffer_load_dwordx4 v2, s[4:7], s38 offen offset:0 sc1 lds
  buffer_load_dwordx4 v2, s[4:7], s38 offen offset:1024 sc1 lds
  buffer_load_dwordx4 v2, s[4:7], s38 offen offset:2048 sc1 lds
  buffer_load_dwordx4 v2, s[4:7], s38 offen offset:3072 sc1 lds
  s_add_u32 m0, m0, 4096
  s_nop 0
  buffer_load_dwordx4 v2, s[4:7], s39 offen offset:0 sc1 lds
  buffer_load_dwordx4 v2, s[4:7], s39 offen offset:1024 sc1 lds
  s_add_u32 s28, s28, 40960
  s_setprio 1
  s_waitcnt vmcnt(0)
Lpa_66:
  v_add_u32 v3, s30, v2
  s_barrier
  ds_read_b128 v[32:35], v3 offset:0
  ds_read_b128 v[36:39], v3 offset:1024
  ds_read_b128 v[40:43], v3 offset:2048
  ds_read_b128 v[44:47], v3 offset:3072
  ds_read_b128 v[48:51], v3 offset:4096
  ds_read_b128 v[52:55], v3 offset:5120
  s_sub_u32 s40, s22, 1
  s_max_i32 s40, s40, 0
  v_mov_b32 v6, s40
  buffer_store_dword v6, v4, s[4:7], 0 offen sc1
  s_cmp_eq_u32 s22, 63
  s_cbranch_scc1 Lpnd_71
  s_add_u32 m0, s31, s35
  s_add_u32 s38, s28, 4096
  s_add_u32 s39, s28, 8192
  buffer_load_dwordx4 v2, s[4:7], s28 offen offset:0 sc1 lds
  buffer_load_dwordx4 v2, s[4:7], s28 offen offset:1024 sc1 lds
  buffer_load_dwordx4 v2, s[4:7], s28 offen offset:2048 sc1 lds
  buffer_load_dwordx4 v2, s[4:7], s28 offen offset:3072 sc1 lds
  s_add_u32 m0, m0, 4096
  s_nop 0
  buffer_load_dwordx4 v2, s[4:7], s38 offen offset:0 sc1 lds
  buffer_load_dwordx4 v2, s[4:7], s38 offen offset:1024 sc1 lds
  buffer_load_dwordx4 v2, s[4:7], s38 offen offset:2048 sc1 lds
  buffer_load_dwordx4 v2, s[4:7], s38 offen offset:3072 sc1 lds
  s_add_u32 m0, m0, 4096
  s_nop 0
  buffer_load_dwordx4 v2, s[4:7], s39 offen offset:0 sc1 lds
  buffer_load_dwordx4 v2, s[4:7], s39 offen offset:1024 sc1 lds
  s_add_u32 s28, s28, 40960
Lpnd_71:
  s_waitcnt lgkmcnt(4)
  v_mfma_f32_16x16x32_bf16 v[16:19], v[96:99], v[32:35], 0
  ds_read_b128 v[56:59], v3 offset:6144
  v_mfma_f32_16x16x32_bf16 v[24:27], v[176:179], v[32:35], 0
  ds_read_b128 v[60:63], v3 offset:7168
  v_mfma_f32_16x16x32_bf16 v[20:23], v[96:99], v[36:39], 0
  v_mfma_f32_16x16x32_bf16 v[28:31], v[176:179], v[36:39], 0
  s_waitcnt lgkmcnt(4)
  v_mfma_f32_16x16x32_bf16 v[16:19], v[100:103], v[40:43], v[16:19]
  ds_read_b128 v[32:35], v3 offset:8192
  v_mfma_f32_16x16x32_bf16 v[24:27], v[180:183], v[40:43], v[24:27]
  ds_read_b128 v[36:39], v3 offset:9216
  v_mfma_f32_16x16x32_bf16 v[20:23], v[100:103], v[44:47], v[20:23]
  v_mfma_f32_16x16x32_bf16 v[28:31], v[180:183], v[44:47], v[28:31]
  s_waitcnt lgkmcnt(4)
  v_mfma_f32_16x16x32_bf16 v[16:19], v[104:107], v[48:51], v[16:19]
  ds_read_b128 v[40:43], v3 offset:10240
  v_mfma_f32_16x16x32_bf16 v[24:27], v[184:187], v[48:51], v[24:27]
  ds_read_b128 v[44:47], v3 offset:11264
  v_mfma_f32_16x16x32_bf16 v[20:23], v[104:107], v[52:55], v[20:23]
  v_mfma_f32_16x16x32_bf16 v[28:31], v[184:187], v[52:55], v[28:31]
  s_waitcnt lgkmcnt(4)
  v_mfma_f32_16x16x32_bf16 v[16:19], v[108:111], v[56:59], v[16:19]
  ds_read_b128 v[48:51], v3 offset:12288
  v_mfma_f32_16x16x32_bf16 v[24:27], v[188:191], v[56:59], v[24:27]
  ds_read_b128 v[52:55], v3 offset:13312
  v_mfma_f32_16x16x32_bf16 v[20:23], v[108:111], v[60:63], v[20:23]
  v_mfma_f32_16x16x32_bf16 v[28:31], v[188:191], v[60:63], v[28:31]
  s_waitcnt lgkmcnt(4)
  v_mfma_f32_16x16x32_bf16 v[16:19], v[112:115], v[32:35], v[16:19]
  ds_read_b128 v[56:59], v3 offset:14336
  v_mfma_f32_16x16x32_bf16 v[24:27], v[192:195], v[32:35], v[24:27]
  ds_read_b128 v[60:63], v3 offset:15360
  v_mfma_f32_16x16x32_bf16 v[20:23], v[112:115], v[36:39], v[20:23]
  v_mfma_f32_16x16x32_bf16 v[28:31], v[192:195], v[36:39], v[28:31]
  s_waitcnt lgkmcnt(4)
  v_mfma_f32_16x16x32_bf16 v[16:19], v[116:119], v[40:43], v[16:19]
  ds_read_b128 v[32:35], v3 offset:16384
  v_mfma_f32_16x16x32_bf16 v[24:27], v[196:199], v[40:43], v[24:27]
  ds_read_b128 v[36:39], v3 offset:17408
  v_mfma_f32_16x16x32_bf16 v[20:23], v[116:119], v[44:47], v[20:23]
  v_mfma_f32_16x16x32_bf16 v[28:31], v[196:199], v[44:47], v[28:31]
  s_waitcnt lgkmcnt(4)
  v_mfma_f32_16x16x32_bf16 v[16:19], v[120:123], v[48:51], v[16:19]
  ds_read_b128 v[40:43], v3 offset:18432
  v_mfma_f32_16x16x32_bf16 v[24:27], v[200:203], v[48:51], v[24:27]
  ds_read_b128 v[44:47], v3 offset:19456
  v_mfma_f32_16x16x32_bf16 v[20:23], v[120:123], v[52:55], v[20:23]
  v_mfma_f32_16x16x32_bf16 v[28:31], v[200:203], v[52:55], v[28:31]
  s_waitcnt lgkmcnt(4)
  v_mfma_f32_16x16x32_bf16 v[16:19], v[124:127], v[56:59], v[16:19]
  ds_read_b128 v[48:51], v3 offset:20480
  v_mfma_f32_16x16x32_bf16 v[24:27], v[204:207], v[56:59], v[24:27]
  ds_read_b128 v[52:55], v3 offset:21504
  v_mfma_f32_16x16x32_bf16 v[20:23], v[124:127], v[60:63], v[20:23]
  v_mfma_f32_16x16x32_bf16 v[28:31], v[204:207], v[60:63], v[28:31]
  s_waitcnt lgkmcnt(4)
  v_mfma_f32_16x16x32_bf16 v[16:19], v[128:131], v[32:35], v[16:19]
  ds_read_b128 v[56:59], v3 offset:22528
  v_mfma_f32_16x16x32_bf16 v[24:27], v[208:211], v[32:35], v[24:27]
  ds_read_b128 v[60:63], v3 offset:23552
  v_mfma_f32_16x16x32_bf16 v[20:23], v[128:131], v[36:39], v[20:23]
  v_mfma_f32_16x16x32_bf16 v[28:31], v[208:211], v[36:39], v[28:31]
  s_waitcnt lgkmcnt(4)
  v_mfma_f32_16x16x32_bf16 v[16:19], v[132:135], v[40:43], v[16:19]
  ds_read_b128 v[32:35], v3 offset:24576
  v_mfma_f32_16x16x32_bf16 v[24:27], v[212:215], v[40:43], v[24:27]
  ds_read_b128 v[36:39], v3 offset:25600
  v_mfma_f32_16x16x32_bf16 v[20:23], v[132:135], v[44:47], v[20:23]
  v_mfma_f32_16x16x32_bf16 v[28:31], v[212:215], v[44:47], v[28:31]
  s_waitcnt lgkmcnt(4)
  v_mfma_f32_16x16x32_bf16 v[16:19], v[136:139], v[48:51], v[16:19]
  ds_read_b128 v[40:43], v3 offset:26624
  v_mfma_f32_16x16x32_bf16 v[24:27], v[216:219], v[48:51], v[24:27]
  ds_read_b128 v[44:47], v3 offset:27648
  v_mfma_f32_16x16x32_bf16 v[20:23], v[136:139], v[52:55], v[20:23]
  v_mfma_f32_16x16x32_bf16 v[28:31], v[216:219], v[52:55], v[28:31]
  s_waitcnt lgkmcnt(4)
  v_mfma_f32_16x16x32_bf16 v[16:19], v[140:143], v[56:59], v[16:19]
  ds_read_b128 v[48:51], v3 offset:28672
  v_mfma_f32_16x16x32_bf16 v[24:27], v[220:223], v[56:59], v[24:27]
  ds_read_b128 v[52:55], v3 offset:29696
  v_mfma_f32_16x16x32_bf16 v[20:23], v[140:143], v[60:63], v[20:23]
  v_mfma_f32_16x16x32_bf16 v[28:31], v[220:223], v[60:63], v[28:31]
  s_waitcnt lgkmcnt(4)
  v_mfma_f32_16x16x32_bf16 v[16:19], v[144:147], v[32:35], v[16:19]
  ds_read_b128 v[56:59], v3 offset:30720
  v_mfma_f32_16x16x32_bf16 v[24:27], v[224:227], v[32:35], v[24:27]
  ds_read_b128 v[60:63], v3 offset:31744
  v_mfma_f32_16x16x32_bf16 v[20:23], v[144:147], v[36:39], v[20:23]
  v_mfma_f32_16x16x32_bf16 v[28:31], v[224:227], v[36:39], v[28:31]
  s_waitcnt lgkmcnt(4)
  v_mfma_f32_16x16x32_bf16 v[16:19], v[148:151], v[40:43], v[16:19]
  ds_read_b128 v[32:35], v3 offset:32768
  v_mfma_f32_16x16x32_bf16 v[24:27], v[228:231], v[40:43], v[24:27]
  ds_read_b128 v[36:39], v3 offset:33792
  v_mfma_f32_16x16x32_bf16 v[20:23], v[148:151], v[44:47], v[20:23]
  v_mfma_f32_16x16x32_bf16 v[28:31], v[228:231], v[44:47], v[28:31]
  s_waitcnt lgkmcnt(4)
  v_mfma_f32_16x16x32_bf16 v[16:19], v[152:155], v[48:51], v[16:19]
  ds_read_b128 v[40:43], v3 offset:34816
  v_mfma_f32_16x16x32_bf16 v[24:27], v[232:235], v[48:51], v[24:27]
  ds_read_b128 v[44:47], v3 offset:35840
  v_mfma_f32_16x16x32_bf16 v[20:23], v[152:155], v[52:55], v[20:23]
  v_mfma_f32_16x16x32_bf16 v[28:31], v[232:235], v[52:55], v[28:31]
  s_waitcnt lgkmcnt(4)
  v_mfma_f32_16x16x32_bf16 v[16:19], v[156:159], v[56:59], v[16:19]
  ds_read_b128 v[48:51], v3 offset:36864
  v_mfma_f32_16x16x32_bf16 v[24:27], v[236:239], v[56:59], v[24:27]
  ds_read_b128 v[52:55], v3 offset:37888
  v_mfma_f32_16x16x32_bf16 v[20:23], v[156:159], v[60:63], v[20:23]
  v_mfma_f32_16x16x32_bf16 v[28:31], v[236:239], v[60:63], v[28:31]
  s_waitcnt lgkmcnt(4)
  v_mfma_f32_16x16x32_bf16 v[16:19], v[160:163], v[32:35], v[16:19]
  ds_read_b128 v[56:59], v3 offset:38912
  v_mfma_f32_16x16x32_bf16 v[24:27], v[240:243], v[32:35], v[24:27]
  ds_read_b128 v[60:63], v3 offset:39936
  v_mfma_f32_16x16x32_bf16 v[20:23], v[160:163], v[36:39], v[20:23]
  v_mfma_f32_16x16x32_bf16 v[28:31], v[240:243], v[36:39], v[28:31]
  s_waitcnt lgkmcnt(4)
  v_mfma_f32_16x16x32_bf16 v[16:19], v[164:167], v[40:43], v[16:19]
  v_mfma_f32_16x16x32_bf16 v[24:27], v[244:247], v[40:43], v[24:27]
  v_mfma_f32_16x16x32_bf16 v[20:23], v[164:167], v[44:47], v[20:23]
  v_mfma_f32_16x16x32_bf16 v[28:31], v[244:247], v[44:47], v[28:31]
  s_waitcnt lgkmcnt(2)
  v_mfma_f32_16x16x32_bf16 v[16:19], v[168:171], v[48:51], v[16:19]
  v_mfma_f32_16x16x32_bf16 v[24:27], v[248:251], v[48:51], v[24:27]
  v_mfma_f32_16x16x32_bf16 v[20:23], v[168:171], v[52:55], v[20:23]
  v_mfma_f32_16x16x32_bf16 v[28:31], v[248:251], v[52:55], v[28:31]
  s_waitcnt lgkmcnt(0)
  v_mfma_f32_16x16x32_bf16 v[16:19], v[172:175], v[56:59], v[16:19]
  v_mfma_f32_16x16x32_bf16 v[24:27], v[252:255], v[56:59], v[24:27]
  v_mfma_f32_16x16x32_bf16 v[20:23], v[172:175], v[60:63], v[20:23]
  v_mfma_f32_16x16x32_bf16 v[28:31], v[252:255], v[60:63], v[28:31]
  s_mov_b32 s38, s30
  s_mov_b32 s30, s31
  s_mov_b32 s31, s32
  s_mov_b32 s32, s38
  s_add_u32 s22, s22, 1
  s_waitcnt vmcnt(0)
  v_mul_f32 v16, v16, v24
  v_mul_f32 v17, v17, v25
  v_mul_f32 v18, v18, v26
  v_mul_f32 v19, v19, v27
  v_mul_f32 v20, v20, v28
  v_mul_f32 v21, v21, v29
  v_mul_f32 v22, v22, v30
  v_mul_f32 v23, v23, v31
  v_cvt_pk_bf16_f32 v64, v16, v17
  v_cvt_pk_bf16_f32 v65, v18, v19
  v_cvt_pk_bf16_f32 v66, v20, v21
  v_cvt_pk_bf16_f32 v67, v22, v23
  s_nop 0
  v_permlane32_swap_b32 v64, v66
  v_permlane32_swap_b32 v65, v67
  buffer_store_dwordx4 v[64:67], v5, s[4:7], s29 offen sc1
  s_add_u32 s29, s29, 491520
  s_cmp_lt_u32 s22, 64
  s_cbranch_scc1 Lpa_66
  s_barrier
  v_mov_b32 v6, 63
  buffer_store_dword v6, v4, s[4:7], 0 offen sc1
  s_waitcnt vmcnt(0)
  s_barrier
  v_mov_b32 v6, 64
  buffer_store_dword v6, v4, s[4:7], 0 offen sc1
  s_branch Lw_end
Lpb0_68:
  s_barrier
  v_add_u32 v3, s30, v2
  ds_read_b128 v[32:35], v3 offset:0
  ds_read_b128 v[36:39], v3 offset:1024
  ds_read_b128 v[40:43], v3 offset:2048
  ds_read_b128 v[44:47], v3 offset:3072
  ds_read_b128 v[48:51], v3 offset:4096
  ds_read_b128 v[52:55], v3 offset:5120
  s_branch Lpb1_69
Lpb_67:
  s_setprio 2
  s_barrier
  s_waitcnt lgkmcnt(4)
  v_mfma_f32_16x16x32_bf16 v[16:19], v[136:139], v[48:51], v[16:19]
  ds_read_b128 v[40:43], v3 offset:26624
  v_mfma_f32_16x16x32_bf16 v[24:27], v[216:219], v[48:51], v[24:27]
  ds_read_b128 v[44:47], v3 offset:27648
  v_mfma_f32_16x16x32_bf16 v[20:23], v[136:139], v[52:55], v[20:23]
  v_mfma_f32_16x16x32_bf16 v[28:31], v[216:219], v[52:55], v[28:31]
  s_waitcnt lgkmcnt(4)
  v_mfma_f32_16x16x32_bf16 v[16:19], v[140:143], v[56:59], v[16:19]
  ds_read_b128 v[48:51], v3 offset:28672
  v_mfma_f32_16x16x32_bf16 v[24:27], v[220:223], v[56:59], v[24:27]
  ds_read_b128 v[52:55], v3 offset:29696
  v_mfma_f32_16x16x32_bf16 v[20:23], v[140:143], v[60:63], v[20:23]
  v_mfma_f32_16x16x32_bf16 v[28:31], v[220:223], v[60:63], v[28:31]
  s_waitcnt lgkmcnt(4)
  v_mfma_f32_16x16x32_bf16 v[16:19], v[144:147], v[32:35], v[16:19]
  ds_read_b128 v[56:59], v3 offset:30720
  v_mfma_f32_16x16x32_bf16 v[24:27], v[224:227], v[32:35], v[24:27]
  ds_read_b128 v[60:63], v3 offset:31744
  v_mfma_f32_16x16x32_bf16 v[20:23], v[144:147], v[36:39], v[20:23]
  v_mfma_f32_16x16x32_bf16 v[28:31], v[224:227], v[36:39], v[28:31]
  s_waitcnt lgkmcnt(4)
  v_mfma_f32_16x16x32_bf16 v[16:19], v[148:151], v[40:43], v[16:19]
  ds_read_b128 v[32:35], v3 offset:32768
  v_mfma_f32_16x16x32_bf16 v[24:27], v[228:231], v[40:43], v[24:27]
  ds_read_b128 v[36:39], v3 offset:33792
  v_mfma_f32_16x16x32_bf16 v[20:23], v[148:151], v[44:47], v[20:23]
  v_mfma_f32_16x16x32_bf16 v[28:31], v[228:231], v[44:47], v[28:31]
  s_waitcnt lgkmcnt(4)
  v_mfma_f32_16x16x32_bf16 v[16:19], v[152:155], v[48:51], v[16:19]
  ds_read_b128 v[40:43], v3 offset:34816
  v_mfma_f32_16x16x32_bf16 v[24:27], v[232:235], v[48:51], v[24:27]
  ds_read_b128 v[44:47], v3 offset:35840
  v_mfma_f32_16x16x32_bf16 v[20:23], v[152:155], v[52:55], v[20:23]
  v_mfma_f32_16x16x32_bf16 v[28:31], v[232:235], v[52:55], v[28:31]
  s_waitcnt lgkmcnt(4)
  v_mfma_f32_16x16x32_bf16 v[16:19], v[156:159], v[56:59], v[16:19]
  ds_read_b128 v[48:51], v3 offset:36864
  v_mfma_f32_16x16x32_bf16 v[24:27], v[236:239], v[56:59], v[24:27]
  ds_read_b128 v[52:55], v3 offset:37888
  v_mfma_f32_16x16x32_bf16 v[20:23], v[156:159], v[60:63], v[20:23]
  v_mfma_f32_16x16x32_bf16 v[28:31], v[236:239], v[60:63], v[28:31]
  s_waitcnt lgkmcnt(4)
  v_mfma_f32_16x16x32_bf16 v[16:19], v[160:163], v[32:35], v[16:19]
  ds_read_b128 v[56:59], v3 offset:38912
  v_mfma_f32_16x16x32_bf16 v[24:27], v[240:243], v[32:35], v[24:27]
  ds_read_b128 v[60:63], v3 offset:39936
  v_mfma_f32_16x16x32_bf16 v[20:23], v[160:163], v[36:39], v[20:23]
  v_mfma_f32_16x16x32_bf16 v[28:31], v[240:243], v[36:39], v[28:31]
  s_waitcnt lgkmcnt(4)
  v_mfma_f32_16x16x32_bf16 v[16:19], v[164:167], v[40:43], v[16:19]
  v_mfma_f32_16x16x32_bf16 v[24:27], v[244:247], v[40:43], v[24:27]
  v_mfma_f32_16x16x32_bf16 v[20:23], v[164:167], v[44:47], v[20:23]
  v_mfma_f32_16x16x32_bf16 v[28:31], v[244:247], v[44:47], v[28:31]
  s_waitcnt lgkmcnt(2)
  v_mfma_f32_16x16x32_bf16 v[16:19], v[168:171], v[48:51], v[16:19]
  v_mfma_f32_16x16x32_bf16 v[24:27], v[248:251], v[48:51], v[24:27]
  v_mfma_f32_16x16x32_bf16 v[20:23], v[168:171], v[52:55], v[20:23]
  v_mfma_f32_16x16x32_bf16 v[28:31], v[248:251], v[52:55], v[28:31]
  s_waitcnt lgkmcnt(0)
  v_mfma_f32_16x16x32_bf16 v[16:19], v[172:175], v[56:59], v[16:19]
  v_mfma_f32_16x16x32_bf16 v[24:27], v[252:255], v[56:59], v[24:27]
  v_mfma_f32_16x16x32_bf16 v[20:23], v[172:175], v[60:63], v[20:23]
  v_mfma_f32_16x16x32_bf16 v[28:31], v[252:255], v[60:63], v[28:31]
  s_mov_b32 s38, s30
  s_mov_b32 s30, s31
  s_mov_b32 s31, s32
  s_mov_b32 s32, s38
  s_add_u32 s22, s22, 1
  s_setprio 0
  s_cmp_eq_u32 s22, 64
  s_cbranch_scc1 Lpbe_70
  v_add_u32 v3, s30, v2
  ds_read_b128 v[32:35], v3 offset:0
  ds_read_b128 v[36:39], v3 offset:1024
  ds_read_b128 v[40:43], v3 offset:2048
  ds_read_b128 v[44:47], v3 offset:3072
  ds_read_b128 v[48:51], v3 offset:4096
  ds_read_b128 v[52:55], v3 offset:5120
  v_mul_f32 v16, v16, v24
  v_mul_f32 v17, v17, v25
  v_mul_f32 v18, v18, v26
  v_mul_f32 v19, v19, v27
  v_mul_f32 v20, v20, v28
  v_mul_f32 v21, v21, v29
  v_mul_f32 v22, v22, v30
  v_mul_f32 v23, v23, v31
  v_cvt_pk_bf16_f32 v64, v16, v17
  v_cvt_pk_bf16_f32 v65, v18, v19
  v_cvt_pk_bf16_f32 v66, v20, v21
  v_cvt_pk_bf16_f32 v67, v22, v23
  s_nop 0
  v_permlane32_swap_b32 v64, v66
  v_permlane32_swap_b32 v65, v67
  buffer_store_dwordx4 v[64:67], v5, s[4:7], s29 offen sc1
  s_add_u32 s29, s29, 491520
Lpb1_69:
  s_waitcnt lgkmcnt(4)
  v_mfma_f32_16x16x32_bf16 v[16:19], v[96:99], v[32:35], 0
  ds_read_b128 v[56:59], v3 offset:6144
  v_mfma_f32_16x16x32_bf16 v[24:27], v[176:179], v[32:35], 0
  ds_read_b128 v[60:63], v3 offset:7168
  v_mfma_f32_16x16x32_bf16 v[20:23], v[96:99], v[36:39], 0
  v_mfma_f32_16x16x32_bf16 v[28:31], v[176:179], v[36:39], 0
  s_waitcnt lgkmcnt(4)
  v_mfma_f32_16x16x32_bf16 v[16:19], v[100:103], v[40:43], v[16:19]
  ds_read_b128 v[32:35], v3 offset:8192
  v_mfma_f32_16x16x32_bf16 v[24:27], v[180:183], v[40:43], v[24:27]
  ds_read_b128 v[36:39], v3 offset:9216
  v_mfma_f32_16x16x32_bf16 v[20:23], v[100:103], v[44:47], v[20:23]
  v_mfma_f32_16x16x32_bf16 v[28:31], v[180:183], v[44:47], v[28:31]
  s_waitcnt lgkmcnt(4)
  v_mfma_f32_16x16x32_bf16 v[16:19], v[104:107], v[48:51], v[16:19]
  ds_read_b128 v[40:43], v3 offset:10240
  v_mfma_f32_16x16x32_bf16 v[24:27], v[184:187], v[48:51], v[24:27]
  ds_read_b128 v[44:47], v3 offset:11264
  v_mfma_f32_16x16x32_bf16 v[20:23], v[104:107], v[52:55], v[20:23]
  v_mfma_f32_16x16x32_bf16 v[28:31], v[184:187], v[52:55], v[28:31]
  s_waitcnt lgkmcnt(4)
  v_mfma_f32_16x16x32_bf16 v[16:19], v[108:111], v[56:59], v[16:19]
  ds_read_b128 v[48:51], v3 offset:12288
  v_mfma_f32_16x16x32_bf16 v[24:27], v[188:191], v[56:59], v[24:27]
  ds_read_b128 v[52:55], v3 offset:13312
  v_mfma_f32_16x16x32_bf16 v[20:23], v[108:111], v[60:63], v[20:23]
  v_mfma_f32_16x16x32_bf16 v[28:31], v[188:191], v[60:63], v[28:31]
  s_waitcnt lgkmcnt(4)
  v_mfma_f32_16x16x32_bf16 v[16:19], v[112:115], v[32:35], v[16:19]
  ds_read_b128 v[56:59], v3 offset:14336
  v_mfma_f32_16x16x32_bf16 v[24:27], v[192:195], v[32:35], v[24:27]
  ds_read_b128 v[60:63], v3 offset:15360
  v_mfma_f32_16x16x32_bf16 v[20:23], v[112:115], v[36:39], v[20:23]
  v_mfma_f32_16x16x32_bf16 v[28:31], v[192:195], v[36:39], v[28:31]
  s_waitcnt lgkmcnt(4)
  v_mfma_f32_16x16x32_bf16 v[16:19], v[116:119], v[40:43], v[16:19]
  ds_read_b128 v[32:35], v3 offset:16384
  v_mfma_f32_16x16x32_bf16 v[24:27], v[196:199], v[40:43], v[24:27]
  ds_read_b128 v[36:39], v3 offset:17408
  v_mfma_f32_16x16x32_bf16 v[20:23], v[116:119], v[44:47], v[20:23]
  v_mfma_f32_16x16x32_bf16 v[28:31], v[196:199], v[44:47], v[28:31]
  s_waitcnt lgkmcnt(4)
  v_mfma_f32_16x16x32_bf16 v[16:19], v[120:123], v[48:51], v[16:19]
  ds_read_b128 v[40:43], v3 offset:18432
  v_mfma_f32_16x16x32_bf16 v[24:27], v[200:203], v[48:51], v[24:27]
  ds_read_b128 v[44:47], v3 offset:19456
  v_mfma_f32_16x16x32_bf16 v[20:23], v[120:123], v[52:55], v[20:23]
  v_mfma_f32_16x16x32_bf16 v[28:31], v[200:203], v[52:55], v[28:31]
  s_waitcnt lgkmcnt(4)
  v_mfma_f32_16x16x32_bf16 v[16:19], v[124:127], v[56:59], v[16:19]
  ds_read_b128 v[48:51], v3 offset:20480
  v_mfma_f32_16x16x32_bf16 v[24:27], v[204:207], v[56:59], v[24:27]
  ds_read_b128 v[52:55], v3 offset:21504
  v_mfma_f32_16x16x32_bf16 v[20:23], v[124:127], v[60:63], v[20:23]
  v_mfma_f32_16x16x32_bf16 v[28:31], v[204:207], v[60:63], v[28:31]
  s_waitcnt lgkmcnt(4)
  v_mfma_f32_16x16x32_bf16 v[16:19], v[128:131], v[32:35], v[16:19]
  ds_read_b128 v[56:59], v3 offset:22528
  v_mfma_f32_16x16x32_bf16 v[24:27], v[208:211], v[32:35], v[24:27]
  ds_read_b128 v[60:63], v3 offset:23552
  v_mfma_f32_16x16x32_bf16 v[20:23], v[128:131], v[36:39], v[20:23]
  v_mfma_f32_16x16x32_bf16 v[28:31], v[208:211], v[36:39], v[28:31]
  s_waitcnt lgkmcnt(4)
  v_mfma_f32_16x16x32_bf16 v[16:19], v[132:135], v[40:43], v[16:19]
  ds_read_b128 v[32:35], v3 offset:24576
  v_mfma_f32_16x16x32_bf16 v[24:27], v[212:215], v[40:43], v[24:27]
  ds_read_b128 v[36:39], v3 offset:25600
  v_mfma_f32_16x16x32_bf16 v[20:23], v[132:135], v[44:47], v[20:23]
  v_mfma_f32_16x16x32_bf16 v[28:31], v[212:215], v[44:47], v[28:31]
  s_waitcnt vmcnt(0)
  s_branch Lpb_67
Lpbe_70:
  v_mul_f32 v16, v16, v24
  v_mul_f32 v17, v17, v25
  v_mul_f32 v18, v18, v26
  v_mul_f32 v19, v19, v27
  v_mul_f32 v20, v20, v28
  v_mul_f32 v21, v21, v29
  v_mul_f32 v22, v22, v30
  v_mul_f32 v23, v23, v31
  v_cvt_pk_bf16_f32 v64, v16, v17
  v_cvt_pk_bf16_f32 v65, v18, v19
  v_cvt_pk_bf16_f32 v66, v20, v21
  v_cvt_pk_bf16_f32 v67, v22, v23
  s_nop 0
  v_permlane32_swap_b32 v64, v66
  v_permlane32_swap_b32 v65, v67
  buffer_store_dwordx4 v[64:67], v5, s[4:7], s29 offen sc1
  s_add_u32 s29, s29, 491520
  s_waitcnt vmcnt(0)
  s_barrier
  s_branch Lw_end
Lw_fin:
  s_sub_u32 s18, s17, 23
  s_mov_b32 s23, 0
  s_branch Lw_fin1
Lw_help:
  s_cmp_lt_u32 s17, 8
  s_cbranch_scc0 Lw_rhelp
  s_setprio 0
  s_mov_b32 s18, s17
  s_mov_b32 s23, 1
Lw_fin1:
  s_load_dwordx2 s[84:85], s[0:1], 40
  s_load_dwordx2 s[86:87], s[0:1], 80
  s_mov_b32 s11, 0x20000
  s_mul_i32 s25, s20, 6
  s_lshl_b32 s38, s20, 1
  s_add_u32 s39, s20, 4
  s_min_u32 s38, s38, s39
  s_add_u32 s21, s38, 42
  s_mul_i32 s35, s20, 20480
  s_mul_i32 s36, s18, 160
  s_mov_b32 s37, 7864320
  v_add_u32 v8, 0, v1
  v_mul_u32_u24 v9, 6554, v8
  v_lshrrev_b32 v9, 16, v9
  v_mul_u32_u24 v10, 1120, v9
  v_lshl_add_u32 v12, v8, 4, v10
  v_add_u32 v8, 64, v1
  v_mul_u32_u24 v9, 6554, v8
  v_lshrrev_b32 v9, 16, v9
  v_mul_u32_u24 v10, 1120, v9
  v_lshl_add_u32 v13, v8, 4, v10
  v_add_u32 v8, 128, v1
  v_mul_u32_u24 v9, 6554, v8
  v_lshrrev_b32 v9, 16, v9
  v_mul_u32_u24 v10, 1120, v9
  v_lshl_add_u32 v14, v8, 4, v10
  v_add_u32 v8, 192, v1
  v_mul_u32_u24 v9, 6554, v8
  v_lshrrev_b32 v9, 16, v9
  v_mul_u32_u24 v10, 1120, v9
  v_lshl_add_u32 v15, v8, 4, v10
  v_add_u32 v8, 256, v1
  v_mul_u32_u24 v9, 6554, v8
  v_lshrrev_b32 v9, 16, v9
  v_mul_u32_u24 v10, 1120, v9
  v_lshl_add_u32 v16, v8, 4, v10
  v_mul_u32_u24 v17, 40, v1
  v_add_u32 v17, s35, v17
  s_waitcnt lgkmcnt(0)
  s_cmp_eq_u32 s20, 0
  s_cbranch_scc0 Lw0_72
Lp_73:
  buffer_load_ubyte v10, off, s[80:83], 0 offset:128 sc1
  s_waitcnt vmcnt(0)
  v_cmp_gt_u32 vcc, 36, v10
  s_cbranch_vccz Lpd_74
  s_sleep 16
  s_sub_u32 s24, s24, 1
  s_cbranch_scc0 Lp_73
  s_branch Lw_fail
Lpd_74:
  s_mul_i32 s38, s16, 1536
  s_add_u32 s38, s38, 1835008
  v_min_u32 v11, 11, v1
  v_lshlrev_b32 v11, 7, v11
Lp_75:
  buffer_load_dword v10, v11, s[4:7], s38 offen sc1
  s_waitcnt vmcnt(0)
  v_cmp_gt_u32 vcc, 1, v10
  s_cbranch_vccz Lpd_76
  s_sleep 8
  s_sub_u32 s24, s24, 1
  s_cbranch_scc0 Lp_75
  s_branch Lw_fail
Lpd_76:
Lw0_72:
  s_barrier
  s_add_u32 s38, s25, 0
  s_mul_i32 s39, s16, 48
  s_mul_i32 s40, s16, 12
  s_sub_u32 s40, s40, 48
  s_cmp_lt_u32 s38, 48
  s_cselect_b32 s39, s39, s40
  s_cselect_b32 s8, s84, s86
  s_cselect_b32 s9, s85, s87
  s_cselect_b32 s10, s37, 1966080
  s_add_u32 s38, s38, s39
  s_mul_i32 s38, s38, 40960
  s_add_u32 s38, s38, s36
  s_add_u32 m0, s35, 0
  s_nop 0
  buffer_load_dwordx4 v12, s[8:11], s38 offen lds
  s_add_u32 m0, s35, 1024
  s_nop 0
  buffer_load_dwordx4 v13, s[8:11], s38 offen lds
  s_add_u32 m0, s35, 2048
  s_nop 0
  buffer_load_dwordx4 v14, s[8:11], s38 offen lds
  s_add_u32 m0, s35, 3072
  s_nop 0
  buffer_load_dwordx4 v15, s[8:11], s38 offen lds
  s_add_u32 m0, s35, 4096
  s_nop 0
  buffer_load_dwordx4 v16, s[8:11], s38 offen lds
  s_add_u32 s38, s25, 1
  s_mul_i32 s39, s16, 48
  s_mul_i32 s40, s16, 12
  s_sub_u32 s40, s40, 48
  s_cmp_lt_u32 s38, 48
  s_cselect_b32 s39, s39, s40
  s_cselect_b32 s8, s84, s86
  s_cselect_b32 s9, s85, s87
  s_cselect_b32 s10, s37, 1966080
  s_add_u32 s38, s38, s39
  s_mul_i32 s38, s38, 40960
  s_add_u32 s38, s38, s36
  s_add_u32 m0, s35, 5120
  s_nop 0
  buffer_load_dwordx4 v12, s[8:11], s38 offen lds
  s_add_u32 m0, s35, 6144
  s_nop 0
  buffer_load_dwordx4 v13, s[8:11], s38 offen lds
  s_add_u32 m0, s35, 7168
  s_nop 0
  buffer_load_dwordx4 v14, s[8:11], s38 offen lds
  s_add_u32 m0, s35, 8192
  s_nop 0
  buffer_load_dwordx4 v15, s[8:11], s38 offen lds
  s_add_u32 m0, s35, 9216
  s_nop 0
  buffer_load_dwordx4 v16, s[8:11], s38 offen lds
  s_add_u32 s38, s25, 2
  s_mul_i32 s39, s16, 48
  s_mul_i32 s40, s16, 12
  s_sub_u32 s40, s40, 48
  s_cmp_lt_u32 s38, 48
  s_cselect_b32 s39, s39, s40
  s_cselect_b32 s8, s84, s86
  s_cselect_b32 s9, s85, s87
  s_cselect_b32 s10, s37, 1966080
  s_add_u32 s38, s38, s39
  s_mul_i32 s38, s38, 40960
  s_add_u32 s38, s38, s36
  s_add_u32 m0, s35, 10240
  s_nop 0
  buffer_load_dwordx4 v12, s[8:11], s38 offen lds
  s_add_u32 m0, s35, 11264
  s_nop 0
  buffer_load_dwordx4 v13, s[8:11], s38 offen lds
  s_add_u32 m0, s35, 12288
  s_nop 0
  buffer_load_dwordx4 v14, s[8:11], s38 offen lds
  s_add_u32 m0, s35, 13312
  s_nop 0
  buffer_load_dwordx4 v15, s[8:11], s38 offen lds
  s_add_u32 m0, s35, 14336
  s_nop 0
  buffer_load_dwordx4 v16, s[8:11], s38 offen lds
  s_add_u32 s38, s25, 3
  s_mul_i32 s39, s16, 48
  s_mul_i32 s40, s16, 12
  s_sub_u32 s40, s40, 48
  s_cmp_lt_u32 s38, 48
  s_cselect_b32 s39, s39, s40
  s_cselect_b32 s8, s84, s86
  s_cselect_b32 s9, s85, s87
  s_cselect_b32 s10, s37, 1966080
  s_add_u32 s38, s38, s39
  s_mul_i32 s38, s38, 40960
  s_add_u32 s38, s38, s36
  s_add_u32 m0, s35, 15360
  s_nop 0
  buffer_load_dwordx4 v12, s[8:11], s38 offen lds
  s_add_u32 m0, s35, 16384
  s_nop 0
  buffer_load_dwordx4 v13, s[8:11], s38 offen lds
  s_add_u32 m0, s35, 17408
  s_nop 0
  buffer_load_dwordx4 v14, s[8:11], s38 offen lds
  s_add_u32 m0, s35, 18432
  s_nop 0
  buffer_load_dwordx4 v15, s[8:11], s38 offen lds
  s_add_u32 m0, s35, 19456
  s_nop 0
  buffer_load_dwordx4 v16, s[8:11], s38 offen lds
  s_waitcnt vmcnt(15)
  ds_read_b64_tr_b16 v[96:97], v17 offset:0
  ds_read_b64_tr_b16 v[98:99], v17 offset:2560
  ds_read_b64_tr_b16 v[100:101], v17 offset:8
  ds_read_b64_tr_b16 v[102:103], v17 offset:2568
  ds_read_b64_tr_b16 v[104:105], v17 offset:16
  ds_read_b64_tr_b16 v[106:107], v17 offset:2576
  ds_read_b64_tr_b16 v[108:109], v17 offset:24
  ds_read_b64_tr_b16 v[110:111], v17 offset:2584
  ds_read_b64_tr_b16 v[112:113], v17 offset:32
  ds_read_b64_tr_b16 v[114:115], v17 offset:2592
  s_waitcnt lgkmcnt(0)
  s_add_u32 s38, s25, 4
  s_mul_i32 s39, s16, 48
  s_mul_i32 s40, s16, 12
  s_sub_u32 s40, s40, 48
  s_cmp_lt_u32 s38, 48
  s_cselect_b32 s39, s39, s40
  s_cselect_b32 s8, s84, s86
  s_cselect_b32 s9, s85, s87
  s_cselect_b32 s10, s37, 1966080
  s_add_u32 s38, s38, s39
  s_mul_i32 s38, s38, 40960
  s_add_u32 s38, s38, s36
  s_add_u32 m0, s35, 0
  s_nop 0
  buffer_load_dwordx4 v12, s[8:11], s38 offen lds
  s_add_u32 m0, s35, 1024
  s_nop 0
  buffer_load_dwordx4 v13, s[8:11], s38 offen lds
  s_add_u32 m0, s35, 2048
  s_nop 0
  buffer_load_dwordx4 v14, s[8:11], s38 offen lds
  s_add_u32 m0, s35, 3072
  s_nop 0
  buffer_load_dwordx4 v15, s[8:11], s38 offen lds
  s_add_u32 m0, s35, 4096
  s_nop 0
  buffer_load_dwordx4 v16, s[8:11], s38 offen lds
  s_waitcnt vmcnt(15)
  ds_read_b64_tr_b16 v[116:117], v17 offset:5120
  ds_read_b64_tr_b16 v[118:119], v17 offset:7680
  ds_read_b64_tr_b16 v[120:121], v17 offset:5128
  ds_read_b64_tr_b16 v[122:123], v17 offset:7688
  ds_read_b64_tr_b16 v[124:125], v17 offset:5136
  ds_read_b64_tr_b16 v[126:127], v17 offset:7696
  ds_read_b64_tr_b16 v[128:129], v17 offset:5144
  ds_read_b64_tr_b16 v[130:131], v17 offset:7704
  ds_read_b64_tr_b16 v[132:133], v17 offset:5152
  ds_read_b64_tr_b16 v[134:135], v17 offset:7712
  s_waitcnt lgkmcnt(0)
  s_add_u32 s38, s25, 5
  s_mul_i32 s39, s16, 48
  s_mul_i32 s40, s16, 12
  s_sub_u32 s40, s40, 48
  s_cmp_lt_u32 s38, 48
  s_cselect_b32 s39, s39, s40
  s_cselect_b32 s8, s84, s86
  s_cselect_b32 s9, s85, s87
  s_cselect_b32 s10, s37, 1966080
  s_add_u32 s38, s38, s39
  s_mul_i32 s38, s38, 40960
  s_add_u32 s38, s38, s36
  s_add_u32 m0, s35, 5120
  s_nop 0
  buffer_load_dwordx4 v12, s[8:11], s38 offen lds
  s_add_u32 m0, s35, 6144
  s_nop 0
  buffer_load_dwordx4 v13, s[8:11], s38 offen lds
  s_add_u32 m0, s35, 7168
  s_nop 0
  buffer_load_dwordx4 v14, s[8:11], s38 offen lds
  s_add_u32 m0, s35, 8192
  s_nop 0
  buffer_load_dwordx4 v15, s[8:11], s38 offen lds
  s_add_u32 m0, s35, 9216
  s_nop 0
  buffer_load_dwordx4 v16, s[8:11], s38 offen lds
  s_waitcnt vmcnt(15)
  ds_read_b64_tr_b16 v[136:137], v17 offset:10240
  ds_read_b64_tr_b16 v[138:139], v17 offset:12800
  ds_read_b64_tr_b16 v[140:141], v17 offset:10248
  ds_read_b64_tr_b16 v[142:143], v17 offset:12808
  ds_read_b64_tr_b16 v[144:145], v17 offset:10256
  ds_read_b64_tr_b16 v[146:147], v17 offset:12816
  ds_read_b64_tr_b16 v[148:149], v17 offset:10264
  ds_read_b64_tr_b16 v[150:151], v17 offset:12824
  ds_read_b64_tr_b16 v[152:153], v17 offset:10272
  ds_read_b64_tr_b16 v[154:155], v17 offset:12832
  s_waitcnt lgkmcnt(0)
  s_add_u32 s38, s21, 6
  s_mul_i32 s39, s16, 48
  s_mul_i32 s40, s16, 12
  s_sub_u32 s40, s40, 48
  s_cmp_lt_u32 s38, 48
  s_cselect_b32 s39, s39, s40
  s_cselect_b32 s8, s84, s86
  s_cselect_b32 s9, s85, s87
  s_cselect_b32 s10, s37, 1966080
  s_add_u32 s38, s38, s39
  s_mul_i32 s38, s38, 40960
  s_add_u32 s38, s38, s36
  s_add_u32 m0, s35, 10240
  s_nop 0
  buffer_load_dwordx4 v12, s[8:11], s38 offen lds
  s_add_u32 m0, s35, 11264
  s_nop 0
  buffer_load_dwordx4 v13, s[8:11], s38 offen lds
  s_add_u32 m0, s35, 12288
  s_nop 0
  buffer_load_dwordx4 v14, s[8:11], s38 offen lds
  s_add_u32 m0, s35, 13312
  s_nop 0
  buffer_load_dwordx4 v15, s[8:11], s38 offen lds
  s_add_u32 m0, s35, 14336
  s_nop 0
  buffer_load_dwordx4 v16, s[8:11], s38 offen lds
  s_waitcnt vmcnt(15)
  ds_read_b64_tr_b16 v[156:157], v17 offset:15360
  ds_read_b64_tr_b16 v[158:159], v17 offset:17920
  ds_read_b64_tr_b16 v[160:161], v17 offset:15368
  ds_read_b64_tr_b16 v[162:163], v17 offset:17928
  ds_read_b64_tr_b16 v[164:165], v17 offset:15376
  ds_read_b64_tr_b16 v[166:167], v17 offset:17936
  ds_read_b64_tr_b16 v[168:169], v17 offset:15384
  ds_read_b64_tr_b16 v[170:171], v17 offset:17944
  ds_read_b64_tr_b16 v[172:173], v17 offset:15392
  ds_read_b64_tr_b16 v[174:175], v17 offset:17952
  s_waitcnt lgkmcnt(0)
  s_add_u32 s38, s21, 7
  s_mul_i32 s39, s16, 48
  s_mul_i32 s40, s16, 12
  s_sub_u32 s40, s40, 48
  s_cmp_lt_u32 s38, 48
  s_cselect_b32 s39, s39, s40
  s_cselect_b32 s8, s84, s86
  s_cselect_b32 s9, s85, s87
  s_cselect_b32 s10, s37, 1966080
  s_add_u32 s38, s38, s39
  s_mul_i32 s38, s38, 40960
  s_add_u32 s38, s38, s36
  s_add_u32 m0, s35, 15360
  s_nop 0
  buffer_load_dwordx4 v12, s[8:11], s38 offen lds
  s_add_u32 m0, s35, 16384
  s_nop 0
  buffer_load_dwordx4 v13, s[8:11], s38 offen lds
  s_add_u32 m0, s35, 17408
  s_nop 0
  buffer_load_dwordx4 v14, s[8:11], s38 offen lds
  s_add_u32 m0, s35, 18432
  s_nop 0
  buffer_load_dwordx4 v15, s[8:11], s38 offen lds
  s_add_u32 m0, s35, 19456
  s_nop 0
  buffer_load_dwordx4 v16, s[8:11], s38 offen lds
  s_waitcnt vmcnt(15)
  ds_read_b64_tr_b16 v[176:177], v17 offset:0
  ds_read_b64_tr_b16 v[178:179], v17 offset:2560
  ds_read_b64_tr_b16 v[180:181], v17 offset:8
  ds_read_b64_tr_b16 v[182:183], v17 offset:2568
  ds_read_b64_tr_b16 v[184:185], v17 offset:16
  ds_read_b64_tr_b16 v[186:187], v17 offset:2576
  ds_read_b64_tr_b16 v[188:189], v17 offset:24
  ds_read_b64_tr_b16 v[190:191], v17 offset:2584
  ds_read_b64_tr_b16 v[192:193], v17 offset:32
  ds_read_b64_tr_b16 v[194:195], v17 offset:2592
  s_waitcnt lgkmcnt(0)
  s_waitcnt vmcnt(10)
  ds_read_b64_tr_b16 v[196:197], v17 offset:5120
  ds_read_b64_tr_b16 v[198:199], v17 offset:7680
  ds_read_b64_tr_b16 v[200:201], v17 offset:5128
  ds_read_b64_tr_b16 v[202:203], v17 offset:7688
  ds_read_b64_tr_b16 v[204:205], v17 offset:5136
  ds_read_b64_tr_b16 v[206:207], v17 offset:7696
  ds_read_b64_tr_b16 v[208:209], v17 offset:5144
  ds_read_b64_tr_b16 v[210:211], v17 offset:7704
  ds_read_b64_tr_b16 v[212:213], v17 offset:5152
  ds_read_b64_tr_b16 v[214:215], v17 offset:7712
  s_waitcnt lgkmcnt(0)
  s_waitcnt vmcnt(5)
  ds_read_b64_tr_b16 v[216:217], v17 offset:10240
  ds_read_b64_tr_b16 v[218:219], v17 offset:12800
  ds_read_b64_tr_b16 v[220:221], v17 offset:10248
  ds_read_b64_tr_b16 v[222:223], v17 offset:12808
  ds_read_b64_tr_b16 v[224:225], v17 offset:10256
  ds_read_b64_tr_b16 v[226:227], v17 offset:12816
  ds_read_b64_tr_b16 v[228:229], v17 offset:10264
  ds_read_b64_tr_b16 v[230:231], v17 offset:12824
  ds_read_b64_tr_b16 v[232:233], v17 offset:10272
  ds_read_b64_tr_b16 v[234:235], v17 offset:12832
  s_waitcnt lgkmcnt(0)
  s_waitcnt vmcnt(0)
  ds_read_b64_tr_b16 v[236:237], v17 offset:15360
  ds_read_b64_tr_b16 v[238:239], v17 offset:17920
  ds_read_b64_tr_b16 v[240:241], v17 offset:15368
  ds_read_b64_tr_b16 v[242:243], v17 offset:17928
  ds_read_b64_tr_b16 v[244:245], v17 offset:15376
  ds_read_b64_tr_b16 v[246:247], v17 offset:17936
  ds_read_b64_tr_b16 v[248:249], v17 offset:15384
  ds_read_b64_tr_b16 v[250:251], v17 offset:17944
  ds_read_b64_tr_b16 v[252:253], v17 offset:15392
  ds_read_b64_tr_b16 v[254:255], v17 offset:17952
  s_waitcnt lgkmcnt(0)
  v_and_b32 v8, 7, v1
  s_cmp_lt_u32 s20, 4
  s_cselect_b32 s38, 7, 6
  v_min_u32 v8, s38, v8
  v_add_u32 v9, s21, v8
  v_cmp_gt_u32 vcc, 6, v8
  v_add_u32 v8, s25, v8
  s_nop 0
  v_cndmask_b32 v8, v9, v8, vcc
  s_sub_u32 s19, s21, s25
  s_add_u32 s19, s19, 6
  s_lshl_b32 s19, s19, 11
  v_mul_u32_u24 v9, 43, v8
  v_lshrrev_b32 v9, 8, v9
  v_bfe_u32 v10, v1, 3, 1
  v_lshl_add_u32 v9, v9, 1, v10
  s_lshl_b32 s38, s16, 11
  s_add_u32 s38, s38, 1853440
  v_lshl_add_u32 v9, v9, 7, s38
  v_lshrrev_b32 v10, 2, v8
  s_mul_i32 s38, s16, 384
  s_add_u32 s38, s38, 1860096
  v_lshl_add_u32 v10, v10, 7, s38
  v_cmp_gt_u32 vcc, 48, v8
  s_nop 1
  v_cndmask_b32 v3, v10, v9, vcc
  s_and_b32 s41, s20, 3
  s_lshl_b32 s38, s18, 2
  s_add_u32 s38, s38, s16
  s_lshl_b32 s38, s38, 2
  s_add_u32 s38, s38, s41
  s_lshl_b32 s38, s38, 7
  s_add_u32 s38, s38, 1863168
  v_mov_b32 v4, 0x40000000
  v_writelane_b32 v4, s38, 0
  v_bfe_u32 v5, v1, 4, 2
  v_lshlrev_b32 v5, 6, v5
  v_bfe_u32 v8, v1, 0, 3
  v_lshl_add_u32 v5, v8, 3, v5
  v_bfe_u32 v8, v1, 3, 1
  v_mul_u32_u24 v8, 40960, v8
  v_add_u32 v5, v5, v8
  s_mul_i32 s26, s18, 5120
  s_mul_i32 s39, s16, 1280
  s_add_u32 s26, s26, s39
  s_lshl_b32 s39, s41, 8
  s_add_u32 s26, s26, s39
  s_add_u32 s26, s26, 99614720
  s_cmp_eq_u32 s41, 0
  s_cselect_b32 s39, 0, 80640
  s_add_u32 s30, s26, s39
  s_add_u32 s30, s30, 1024
  s_add_u32 s31, s26, 82688
  s_mul_i32 s38, s20, 10240
  v_add_u32 v6, s38, v2
  s_lshl_b32 s38, s41, 10
  v_add_u32 v7, s38, v2
  v_add_u32 v8, 40960, v7
  s_mul_i32 s29, s16, 122880
  s_lshl_b32 s38, s25, 11
  s_add_u32 s29, s29, s38
  s_add_u32 s29, s29, 68157440
  s_mov_b32 s22, 0
  s_mov_b32 s27, 0
  s_mov_b32 s32, 0
  s_mov_b32 s33, 81920
  s_barrier
  s_cmp_eq_u32 s23, 1
  s_cbranch_scc1 Lw_fhalf
  s_cmp_lt_u32 s20, 4
  s_cbranch_scc0 Lw_fin7x
  s_setprio 1
Lf_77:
  s_cmp_eq_u32 s22, 44
  s_cbranch_scc1 Lw_fhalf
  s_add_u32 s41, s22, 1
  s_cmp_eq_u32 s41, 44
  s_cselect_b32 s41, -1, s41
  s_cmp_eq_u32 s32, 1
  s_cbranch_scc1 Lfh_81
Lfp_78:
  buffer_load_dword v9, v3, s[4:7], 0 offen sc1
  s_waitcnt vmcnt(0)
  v_cmp_ge_u32 vcc, s22, v9
  s_cbranch_vccz Lfd_80
  s_sleep 1
  s_sub_u32 s24, s24, 1
  s_cbranch_scc0 Lfp_78
  s_branch Lw_fail
Lfd_80:
  s_add_u32 s38, s29, 4096
  s_add_u32 s39, s29, 8192
  s_add_u32 s40, s29, s19
  buffer_load_dwordx4 v[32:35], v2, s[4:7], s29 offen offset:0 sc1
  buffer_load_dwordx4 v[36:39], v2, s[4:7], s29 offen offset:2048 sc1
  buffer_load_dwordx4 v[40:43], v2, s[4:7], s38 offen offset:0 sc1
  buffer_load_dwordx4 v[44:47], v2, s[4:7], s38 offen offset:2048 sc1
  buffer_load_dwordx4 v[48:51], v2, s[4:7], s39 offen offset:0 sc1
  buffer_load_dwordx4 v[52:55], v2, s[4:7], s39 offen offset:2048 sc1
  buffer_load_dwordx4 v[56:59], v2, s[4:7], s40 offen offset:0 sc1
  buffer_load_dwordx4 v[60:63], v2, s[4:7], s40 offen offset:2048 sc1
  buffer_load_dwordx4 v[64:67], v2, s[4:7], s29 offen offset:1024 sc1
  buffer_load_dwordx4 v[68:71], v2, s[4:7], s29 offen offset:3072 sc1
  buffer_load_dwordx4 v[72:75], v2, s[4:7], s38 offen offset:1024 sc1
  buffer_load_dwordx4 v[76:79], v2, s[4:7], s38 offen offset:3072 sc1
  buffer_load_dwordx4 v[80:83], v2, s[4:7], s39 offen offset:1024 sc1
  buffer_load_dwordx4 v[84:87], v2, s[4:7], s39 offen offset:3072 sc1
  buffer_load_dwordx4 v[88:91], v2, s[4:7], s40 offen offset:1024 sc1
  buffer_load_dwordx4 v[92:95], v2, s[4:7], s40 offen offset:3072 sc1
  s_add_u32 s29, s29, 491520
  s_waitcnt vmcnt(15)
  v_mfma_f32_16x16x32_bf16 v[12:15], v[96:99], v[32:35], 0
  v_mfma_f32_16x16x32_bf16 v[16:19], v[100:103], v[32:35], 0
  v_mfma_f32_16x16x32_bf16 v[20:23], v[104:107], v[32:35], 0
  v_mfma_f32_16x16x32_bf16 v[24:27], v[108:111], v[32:35], 0
  v_mfma_f32_16x16x32_bf16 v[28:31], v[112:115], v[32:35], 0
  s_waitcnt vmcnt(14)
  v_mfma_f32_16x16x32_bf16 v[12:15], v[116:119], v[36:39], v[12:15]
  v_mfma_f32_16x16x32_bf16 v[16:19], v[120:123], v[36:39], v[16:19]
  v_mfma_f32_16x16x32_bf16 v[20:23], v[124:127], v[36:39], v[20:23]
  v_mfma_f32_16x16x32_bf16 v[24:27], v[128:131], v[36:39], v[24:27]
  v_mfma_f32_16x16x32_bf16 v[28:31], v[132:135], v[36:39], v[28:31]
  s_waitcnt vmcnt(13)
  v_mfma_f32_16x16x32_bf16 v[12:15], v[136:139], v[40:43], v[12:15]
  v_mfma_f32_16x16x32_bf16 v[16:19], v[140:143], v[40:43], v[16:19]
  v_mfma_f32_16x16x32_bf16 v[20:23], v[144:147], v[40:43], v[20:23]
  v_mfma_f32_16x16x32_bf16 v[24:27], v[148:151], v[40:43], v[24:27]
  v_mfma_f32_16x16x32_bf16 v[28:31], v[152:155], v[40:43], v[28:31]
  s_waitcnt vmcnt(12)
  v_mfma_f32_16x16x32_bf16 v[12:15], v[156:159], v[44:47], v[12:15]
  v_mfma_f32_16x16x32_bf16 v[16:19], v[160:163], v[44:47], v[16:19]
  v_mfma_f32_16x16x32_bf16 v[20:23], v[164:167], v[44:47], v[20:23]
  v_mfma_f32_16x16x32_bf16 v[24:27], v[168:171], v[44:47], v[24:27]
  v_mfma_f32_16x16x32_bf16 v[28:31], v[172:175], v[44:47], v[28:31]
  s_waitcnt vmcnt(11)
  v_mfma_f32_16x16x32_bf16 v[12:15], v[176:179], v[48:51], v[12:15]
  v_mfma_f32_16x16x32_bf16 v[16:19], v[180:183], v[48:51], v[16:19]
  v_mfma_f32_16x16x32_bf16 v[20:23], v[184:187], v[48:51], v[20:23]
  v_mfma_f32_16x16x32_bf16 v[24:27], v[188:191], v[48:51], v[24:27]
  v_mfma_f32_16x16x32_bf16 v[28:31], v[192:195], v[48:51], v[28:31]
  s_waitcnt vmcnt(10)
  v_mfma_f32_16x16x32_bf16 v[12:15], v[196:199], v[52:55], v[12:15]
  v_mfma_f32_16x16x32_bf16 v[16:19], v[200:203], v[52:55], v[16:19]
  v_mfma_f32_16x16x32_bf16 v[20:23], v[204:207], v[52:55], v[20:23]
  v_mfma_f32_16x16x32_bf16 v[24:27], v[208:211], v[52:55], v[24:27]
  v_mfma_f32_16x16x32_bf16 v[28:31], v[212:215], v[52:55], v[28:31]
  s_waitcnt vmcnt(9)
  v_mfma_f32_16x16x32_bf16 v[12:15], v[216:219], v[56:59], v[12:15]
  v_mfma_f32_16x16x32_bf16 v[16:19], v[220:223], v[56:59], v[16:19]
  v_mfma_f32_16x16x32_bf16 v[20:23], v[224:227], v[56:59], v[20:23]
  v_mfma_f32_16x16x32_bf16 v[24:27], v[228:231], v[56:59], v[24:27]
  v_mfma_f32_16x16x32_bf16 v[28:31], v[232:235], v[56:59], v[28:31]
  s_waitcnt vmcnt(8)
  v_mfma_f32_16x16x32_bf16 v[12:15], v[236:239], v[60:63], v[12:15]
  v_mfma_f32_16x16x32_bf16 v[16:19], v[240:243], v[60:63], v[16:19]
  v_mfma_f32_16x16x32_bf16 v[20:23], v[244:247], v[60:63], v[20:23]
  v_mfma_f32_16x16x32_bf16 v[24:27], v[248:251], v[60:63], v[24:27]
  v_mfma_f32_16x16x32_bf16 v[28:31], v[252:255], v[60:63], v[28:31]
  s_nop 3
  ds_write_b128 v6, v[12:15] offset:0
  ds_write_b128 v6, v[16:19] offset:1024
  ds_write_b128 v6, v[20:23] offset:2048
  ds_write_b128 v6, v[24:27] offset:3072
  ds_write_b128 v6, v[28:31] offset:4096
  v_cmp_ge_u32 vcc, s41, v9
  s_cbranch_vccz Lfn_83
  s_waitcnt vmcnt(7)
  v_mfma_f32_16x16x32_bf16 v[12:15], v[96:99], v[64:67], 0
  v_mfma_f32_16x16x32_bf16 v[16:19], v[100:103], v[64:67], 0
  v_mfma_f32_16x16x32_bf16 v[20:23], v[104:107], v[64:67], 0
  v_mfma_f32_16x16x32_bf16 v[24:27], v[108:111], v[64:67], 0
  v_mfma_f32_16x16x32_bf16 v[28:31], v[112:115], v[64:67], 0
  s_waitcnt vmcnt(6)
  v_mfma_f32_16x16x32_bf16 v[12:15], v[116:119], v[68:71], v[12:15]
  v_mfma_f32_16x16x32_bf16 v[16:19], v[120:123], v[68:71], v[16:19]
  v_mfma_f32_16x16x32_bf16 v[20:23], v[124:127], v[68:71], v[20:23]
  v_mfma_f32_16x16x32_bf16 v[24:27], v[128:131], v[68:71], v[24:27]
  v_mfma_f32_16x16x32_bf16 v[28:31], v[132:135], v[68:71], v[28:31]
  s_waitcnt vmcnt(5)
  v_mfma_f32_16x16x32_bf16 v[12:15], v[136:139], v[72:75], v[12:15]
  v_mfma_f32_16x16x32_bf16 v[16:19], v[140:143], v[72:75], v[16:19]
  v_mfma_f32_16x16x32_bf16 v[20:23], v[144:147], v[72:75], v[20:23]
  v_mfma_f32_16x16x32_bf16 v[24:27], v[148:151], v[72:75], v[24:27]
  v_mfma_f32_16x16x32_bf16 v[28:31], v[152:155], v[72:75], v[28:31]
  s_waitcnt vmcnt(4)
  v_mfma_f32_16x16x32_bf16 v[12:15], v[156:159], v[76:79], v[12:15]
  v_mfma_f32_16x16x32_bf16 v[16:19], v[160:163], v[76:79], v[16:19]
  v_mfma_f32_16x16x32_bf16 v[20:23], v[164:167], v[76:79], v[20:23]
  v_mfma_f32_16x16x32_bf16 v[24:27], v[168:171], v[76:79], v[24:27]
  v_mfma_f32_16x16x32_bf16 v[28:31], v[172:175], v[76:79], v[28:31]
  s_waitcnt vmcnt(3)
  v_mfma_f32_16x16x32_bf16 v[12:15], v[176:179], v[80:83], v[12:15]
  v_mfma_f32_16x16x32_bf16 v[16:19], v[180:183], v[80:83], v[16:19]
  v_mfma_f32_16x16x32_bf16 v[20:23], v[184:187], v[80:83], v[20:23]
  v_mfma_f32_16x16x32_bf16 v[24:27], v[188:191], v[80:83], v[24:27]
  v_mfma_f32_16x16x32_bf16 v[28:31], v[192:195], v[80:83], v[28:31]
  s_waitcnt vmcnt(2)
  v_mfma_f32_16x16x32_bf16 v[12:15], v[196:199], v[84:87], v[12:15]
  v_mfma_f32_16x16x32_bf16 v[16:19], v[200:203], v[84:87], v[16:19]
  v_mfma_f32_16x16x32_bf16 v[20:23], v[204:207], v[84:87], v[20:23]
  v_mfma_f32_16x16x32_bf16 v[24:27], v[208:211], v[84:87], v[24:27]
  v_mfma_f32_16x16x32_bf16 v[28:31], v[212:215], v[84:87], v[28:31]
  s_waitcnt vmcnt(1)
  v_mfma_f32_16x16x32_bf16 v[12:15], v[216:219], v[88:91], v[12:15]
  v_mfma_f32_16x16x32_bf16 v[16:19], v[220:223], v[88:91], v[16:19]
  v_mfma_f32_16x16x32_bf16 v[20:23], v[224:227], v[88:91], v[20:23]
  v_mfma_f32_16x16x32_bf16 v[24:27], v[228:231], v[88:91], v[24:27]
  v_mfma_f32_16x16x32_bf16 v[28:31], v[232:235], v[88:91], v[28:31]
  s_waitcnt vmcnt(0)
  v_mfma_f32_16x16x32_bf16 v[12:15], v[236:239], v[92:95], v[12:15]
  v_mfma_f32_16x16x32_bf16 v[16:19], v[240:243], v[92:95], v[16:19]
  v_mfma_f32_16x16x32_bf16 v[20:23], v[244:247], v[92:95], v[20:23]
  v_mfma_f32_16x16x32_bf16 v[24:27], v[248:251], v[92:95], v[24:27]
  v_mfma_f32_16x16x32_bf16 v[28:31], v[252:255], v[92:95], v[28:31]
  s_branch Lfz_89
Lfh_81:
  buffer_load_dword v9, v3, s[4:7], 0 offen sc1
  s_waitcnt vmcnt(9)
  v_cmp_ge_u32 vcc, s41, v11
  s_cbranch_vccz Lfe_87
  v_mfma_f32_16x16x32_bf16 v[12:15], v[96:99], v[32:35], 0
  v_mfma_f32_16x16x32_bf16 v[16:19], v[100:103], v[32:35], 0
  v_mfma_f32_16x16x32_bf16 v[20:23], v[104:107], v[32:35], 0
  v_mfma_f32_16x16x32_bf16 v[24:27], v[108:111], v[32:35], 0
  v_mfma_f32_16x16x32_bf16 v[28:31], v[112:115], v[32:35], 0
  v_mfma_f32_16x16x32_bf16 v[12:15], v[116:119], v[36:39], v[12:15]
  v_mfma_f32_16x16x32_bf16 v[16:19], v[120:123], v[36:39], v[16:19]
  v_mfma_f32_16x16x32_bf16 v[20:23], v[124:127], v[36:39], v[20:23]
  v_mfma_f32_16x16x32_bf16 v[24:27], v[128:131], v[36:39], v[24:27]
  v_mfma_f32_16x16x32_bf16 v[28:31], v[132:135], v[36:39], v[28:31]
  v_mfma_f32_16x16x32_bf16 v[12:15], v[136:139], v[40:43], v[12:15]
  v_mfma_f32_16x16x32_bf16 v[16:19], v[140:143], v[40:43], v[16:19]
  v_mfma_f32_16x16x32_bf16 v[20:23], v[144:147], v[40:43], v[20:23]
  v_mfma_f32_16x16x32_bf16 v[24:27], v[148:151], v[40:43], v[24:27]
  v_mfma_f32_16x16x32_bf16 v[28:31], v[152:155], v[40:43], v[28:31]
  v_mfma_f32_16x16x32_bf16 v[12:15], v[156:159], v[44:47], v[12:15]
  v_mfma_f32_16x16x32_bf16 v[16:19], v[160:163], v[44:47], v[16:19]
  v_mfma_f32_16x16x32_bf16 v[20:23], v[164:167], v[44:47], v[20:23]
  v_mfma_f32_16x16x32_bf16 v[24:27], v[168:171], v[44:47], v[24:27]
  v_mfma_f32_16x16x32_bf16 v[28:31], v[172:175], v[44:47], v[28:31]
  v_mfma_f32_16x16x32_bf16 v[12:15], v[176:179], v[48:51], v[12:15]
  v_mfma_f32_16x16x32_bf16 v[16:19], v[180:183], v[48:51], v[16:19]
  v_mfma_f32_16x16x32_bf16 v[20:23], v[184:187], v[48:51], v[20:23]
  v_mfma_f32_16x16x32_bf16 v[24:27], v[188:191], v[48:51], v[24:27]
  v_mfma_f32_16x16x32_bf16 v[28:31], v[192:195], v[48:51], v[28:31]
  v_mfma_f32_16x16x32_bf16 v[12:15], v[196:199], v[52:55], v[12:15]
  v_mfma_f32_16x16x32_bf16 v[16:19], v[200:203], v[52:55], v[16:19]
  v_mfma_f32_16x16x32_bf16 v[20:23], v[204:207], v[52:55], v[20:23]
  v_mfma_f32_16x16x32_bf16 v[24:27], v[208:211], v[52:55], v[24:27]
  v_mfma_f32_16x16x32_bf16 v[28:31], v[212:215], v[52:55], v[28:31]
  v_mfma_f32_16x16x32_bf16 v[12:15], v[216:219], v[56:59], v[12:15]
  v_mfma_f32_16x16x32_bf16 v[16:19], v[220:223], v[56:59], v[16:19]
  v_mfma_f32_16x16x32_bf16 v[20:23], v[224:227], v[56:59], v[20:23]
  v_mfma_f32_16x16x32_bf16 v[24:27], v[228:231], v[56:59], v[24:27]
  v_mfma_f32_16x16x32_bf16 v[28:31], v[232:235], v[56:59], v[28:31]
  v_mfma_f32_16x16x32_bf16 v[12:15], v[236:239], v[60:63], v[12:15]
  v_mfma_f32_16x16x32_bf16 v[16:19], v[240:243], v[60:63], v[16:19]
  v_mfma_f32_16x16x32_bf16 v[20:23], v[244:247], v[60:63], v[20:23]
  v_mfma_f32_16x16x32_bf16 v[24:27], v[248:251], v[60:63], v[24:27]
  v_mfma_f32_16x16x32_bf16 v[28:31], v[252:255], v[60:63], v[28:31]
  s_waitcnt vmcnt(0)
  s_nop 2
  ds_write_b128 v6, v[12:15] offset:0
  ds_write_b128 v6, v[16:19] offset:1024
  ds_write_b128 v6, v[20:23] offset:2048
  ds_write_b128 v6, v[24:27] offset:3072
  ds_write_b128 v6, v[28:31] offset:4096
  v_cmp_ge_u32 vcc, s41, v9
  s_cbranch_vccz Lfm_88
  s_mov_b32 s32, 0
  v_mfma_f32_16x16x32_bf16 v[12:15], v[96:99], v[64:67], 0
  v_mfma_f32_16x16x32_bf16 v[16:19], v[100:103], v[64:67], 0
  v_mfma_f32_16x16x32_bf16 v[20:23], v[104:107], v[64:67], 0
  v_mfma_f32_16x16x32_bf16 v[24:27], v[108:111], v[64:67], 0
  v_mfma_f32_16x16x32_bf16 v[28:31], v[112:115], v[64:67], 0
  v_mfma_f32_16x16x32_bf16 v[12:15], v[116:119], v[68:71], v[12:15]
  v_mfma_f32_16x16x32_bf16 v[16:19], v[120:123], v[68:71], v[16:19]
  v_mfma_f32_16x16x32_bf16 v[20:23], v[124:127], v[68:71], v[20:23]
  v_mfma_f32_16x16x32_bf16 v[24:27], v[128:131], v[68:71], v[24:27]
  v_mfma_f32_16x16x32_bf16 v[28:31], v[132:135], v[68:71], v[28:31]
  v_mfma_f32_16x16x32_bf16 v[12:15], v[136:139], v[72:75], v[12:15]
  v_mfma_f32_16x16x32_bf16 v[16:19], v[140:143], v[72:75], v[16:19]
  v_mfma_f32_16x16x32_bf16 v[20:23], v[144:147], v[72:75], v[20:23]
  v_mfma_f32_16x16x32_bf16 v[24:27], v[148:151], v[72:75], v[24:27]
  v_mfma_f32_16x16x32_bf16 v[28:31], v[152:155], v[72:75], v[28:31]
  v_mfma_f32_16x16x32_bf16 v[12:15], v[156:159], v[76:79], v[12:15]
  v_mfma_f32_16x16x32_bf16 v[16:19], v[160:163], v[76:79], v[16:19]
  v_mfma_f32_16x16x32_bf16 v[20:23], v[164:167], v[76:79], v[20:23]
  v_mfma_f32_16x16x32_bf16 v[24:27], v[168:171], v[76:79], v[24:27]
  v_mfma_f32_16x16x32_bf16 v[28:31], v[172:175], v[76:79], v[28:31]
  v_mfma_f32_16x16x32_bf16 v[12:15], v[176:179], v[80:83], v[12:15]
  v_mfma_f32_16x16x32_bf16 v[16:19], v[180:183], v[80:83], v[16:19]
  v_mfma_f32_16x16x32_bf16 v[20:23], v[184:187], v[80:83], v[20:23]
  v_mfma_f32_16x16x32_bf16 v[24:27], v[188:191], v[80:83], v[24:27]
  v_mfma_f32_16x16x32_bf16 v[28:31], v[192:195], v[80:83], v[28:31]
  v_mfma_f32_16x16x32_bf16 v[12:15], v[196:199], v[84:87], v[12:15]
  v_mfma_f32_16x16x32_bf16 v[16:19], v[200:203], v[84:87], v[16:19]
  v_mfma_f32_16x16x32_bf16 v[20:23], v[204:207], v[84:87], v[20:23]
  v_mfma_f32_16x16x32_bf16 v[24:27], v[208:211], v[84:87], v[24:27]
  v_mfma_f32_16x16x32_bf16 v[28:31], v[212:215], v[84:87], v[28:31]
  v_mfma_f32_16x16x32_bf16 v[12:15], v[216:219], v[88:91], v[12:15]
  v_mfma_f32_16x16x32_bf16 v[16:19], v[220:223], v[88:91], v[16:19]
  v_mfma_f32_16x16x32_bf16 v[20:23], v[224:227], v[88:91], v[20:23]
  v_mfma_f32_16x16x32_bf16 v[24:27], v[228:231], v[88:91], v[24:27]
  v_mfma_f32_16x16x32_bf16 v[28:31], v[232:235], v[88:91], v[28:31]
  v_mfma_f32_16x16x32_bf16 v[12:15], v[236:239], v[92:95], v[12:15]
  v_mfma_f32_16x16x32_bf16 v[16:19], v[240:243], v[92:95], v[16:19]
  v_mfma_f32_16x16x32_bf16 v[20:23], v[244:247], v[92:95], v[20:23]
  v_mfma_f32_16x16x32_bf16 v[24:27], v[248:251], v[92:95], v[24:27]
  v_mfma_f32_16x16x32_bf16 v[28:31], v[252:255], v[92:95], v[28:31]
  s_branch Lfz_89
Lfn_83:
  s_waitcnt vmcnt(0)
Lfm_88:
  s_mov_b32 s32, 1
  buffer_load_dword v11, v3, s[4:7], 0 offen sc1
  s_add_u32 s38, s29, 4096
  s_add_u32 s39, s29, 8192
  s_add_u32 s40, s29, s19
  v_mfma_f32_16x16x32_bf16 v[12:15], v[96:99], v[64:67], 0
  v_mfma_f32_16x16x32_bf16 v[16:19], v[100:103], v[64:67], 0
  v_mfma_f32_16x16x32_bf16 v[20:23], v[104:107], v[64:67], 0
  v_mfma_f32_16x16x32_bf16 v[24:27], v[108:111], v[64:67], 0
  v_mfma_f32_16x16x32_bf16 v[28:31], v[112:115], v[64:67], 0
  v_mfma_f32_16x16x32_bf16 v[12:15], v[116:119], v[68:71], v[12:15]
  buffer_load_dwordx4 v[32:35], v2, s[4:7], s29 offen offset:0 sc1
  v_mfma_f32_16x16x32_bf16 v[16:19], v[120:123], v[68:71], v[16:19]
  v_mfma_f32_16x16x32_bf16 v[20:23], v[124:127], v[68:71], v[20:23]
  buffer_load_dwordx4 v[36:39], v2, s[4:7], s29 offen offset:2048 sc1
  v_mfma_f32_16x16x32_bf16 v[24:27], v[128:131], v[68:71], v[24:27]
  v_mfma_f32_16x16x32_bf16 v[28:31], v[132:135], v[68:71], v[28:31]
  v_mfma_f32_16x16x32_bf16 v[12:15], v[136:139], v[72:75], v[12:15]
  buffer_load_dwordx4 v[40:43], v2, s[4:7], s38 offen offset:0 sc1
  v_mfma_f32_16x16x32_bf16 v[16:19], v[140:143], v[72:75], v[16:19]
  v_mfma_f32_16x16x32_bf16 v[20:23], v[144:147], v[72:75], v[20:23]
  buffer_load_dwordx4 v[44:47], v2, s[4:7], s38 offen offset:2048 sc1
  v_mfma_f32_16x16x32_bf16 v[24:27], v[148:151], v[72:75], v[24:27]
  v_mfma_f32_16x16x32_bf16 v[28:31], v[152:155], v[72:75], v[28:31]
  v_mfma_f32_16x16x32_bf16 v[12:15], v[156:159], v[76:79], v[12:15]
  buffer_load_dwordx4 v[48:51], v2, s[4:7], s39 offen offset:0 sc1
  v_mfma_f32_16x16x32_bf16 v[16:19], v[160:163], v[76:79], v[16:19]
  v_mfma_f32_16x16x32_bf16 v[20:23], v[164:167], v[76:79], v[20:23]
  buffer_load_dwordx4 v[52:55], v2, s[4:7], s39 offen offset:2048 sc1
  v_mfma_f32_16x16x32_bf16 v[24:27], v[168:171], v[76:79], v[24:27]
  v_mfma_f32_16x16x32_bf16 v[28:31], v[172:175], v[76:79], v[28:31]
  v_mfma_f32_16x16x32_bf16 v[12:15], v[176:179], v[80:83], v[12:15]
  buffer_load_dwordx4 v[56:59], v2, s[4:7], s40 offen offset:0 sc1
  v_mfma_f32_16x16x32_bf16 v[16:19], v[180:183], v[80:83], v[16:19]
  v_mfma_f32_16x16x32_bf16 v[20:23], v[184:187], v[80:83], v[20:23]
  buffer_load_dwordx4 v[60:63], v2, s[4:7], s40 offen offset:2048 sc1
  v_mfma_f32_16x16x32_bf16 v[24:27], v[188:191], v[80:83], v[24:27]
  v_mfma_f32_16x16x32_bf16 v[28:31], v[192:195], v[80:83], v[28:31]
  v_mfma_f32_16x16x32_bf16 v[12:15], v[196:199], v[84:87], v[12:15]
  buffer_load_dwordx4 v[64:67], v2, s[4:7], s29 offen offset:1024 sc1
  v_mfma_f32_16x16x32_bf16 v[16:19], v[200:203], v[84:87], v[16:19]
  v_mfma_f32_16x16x32_bf16 v[20:23], v[204:207], v[84:87], v[20:23]
  buffer_load_dwordx4 v[68:71], v2, s[4:7], s29 offen offset:3072 sc1
  v_mfma_f32_16x16x32_bf16 v[24:27], v[208:211], v[84:87], v[24:27]
  v_mfma_f32_16x16x32_bf16 v[28:31], v[212:215], v[84:87], v[28:31]
  v_mfma_f32_16x16x32_bf16 v[12:15], v[216:219], v[88:91], v[12:15]
  buffer_load_dwordx4 v[72:75], v2, s[4:7], s38 offen offset:1024 sc1
  v_mfma_f32_16x16x32_bf16 v[16:19], v[220:223], v[88:91], v[16:19]
  v_mfma_f32_16x16x32_bf16 v[20:23], v[224:227], v[88:91], v[20:23]
  buffer_load_dwordx4 v[76:79], v2, s[4:7], s38 offen offset:3072 sc1
  v_mfma_f32_16x16x32_bf16 v[24:27], v[228:231], v[88:91], v[24:27]
  v_mfma_f32_16x16x32_bf16 v[28:31], v[232:235], v[88:91], v[28:31]
  v_mfma_f32_16x16x32_bf16 v[12:15], v[236:239], v[92:95], v[12:15]
  buffer_load_dwordx4 v[80:83], v2, s[4:7], s39 offen offset:1024 sc1
  v_mfma_f32_16x16x32_bf16 v[16:19], v[240:243], v[92:95], v[16:19]
  v_mfma_f32_16x16x32_bf16 v[20:23], v[244:247], v[92:95], v[20:23]
  buffer_load_dwordx4 v[84:87], v2, s[4:7], s39 offen offset:3072 sc1
  v_mfma_f32_16x16x32_bf16 v[24:27], v[248:251], v[92:95], v[24:27]
  v_mfma_f32_16x16x32_bf16 v[28:31], v[252:255], v[92:95], v[28:31]
  buffer_load_dwordx4 v[88:91], v2, s[4:7], s40 offen offset:1024 sc1
  buffer_load_dwordx4 v[92:95], v2, s[4:7], s40 offen offset:3072 sc1
  s_add_u32 s29, s29, 491520
  s_branch Lfz_89
Lfe_87:
  s_add_u32 s38, s29, 4096
  s_add_u32 s39, s29, 8192
  s_add_u32 s40, s29, s19
  v_mfma_f32_16x16x32_bf16 v[12:15], v[96:99], v[32:35], 0
  v_mfma_f32_16x16x32_bf16 v[16:19], v[100:103], v[32:35], 0
  v_mfma_f32_16x16x32_bf16 v[20:23], v[104:107], v[32:35], 0
  v_mfma_f32_16x16x32_bf16 v[24:27], v[108:111], v[32:35], 0
  v_mfma_f32_16x16x32_bf16 v[28:31], v[112:115], v[32:35], 0
  v_mfma_f32_16x16x32_bf16 v[12:15], v[116:119], v[36:39], v[12:15]
  buffer_load_dwordx4 v[32:35], v2, s[4:7], s29 offen offset:0 sc1
  v_mfma_f32_16x16x32_bf16 v[16:19], v[120:123], v[36:39], v[16:19]
  v_mfma_f32_16x16x32_bf16 v[20:23], v[124:127], v[36:39], v[20:23]
  v_mfma_f32_16x16x32_bf16 v[24:27], v[128:131], v[36:39], v[24:27]
  v_mfma_f32_16x16x32_bf16 v[28:31], v[132:135], v[36:39], v[28:31]
  v_mfma_f32_16x16x32_bf16 v[12:15], v[136:139], v[40:43], v[12:15]
  buffer_load_dwordx4 v[36:39], v2, s[4:7], s29 offen offset:2048 sc1
  v_mfma_f32_16x16x32_bf16 v[16:19], v[140:143], v[40:43], v[16:19]
  v_mfma_f32_16x16x32_bf16 v[20:23], v[144:147], v[40:43], v[20:23]
  v_mfma_f32_16x16x32_bf16 v[24:27], v[148:151], v[40:43], v[24:27]
  v_mfma_f32_16x16x32_bf16 v[28:31], v[152:155], v[40:43], v[28:31]
  v_mfma_f32_16x16x32_bf16 v[12:15], v[156:159], v[44:47], v[12:15]
  buffer_load_dwordx4 v[40:43], v2, s[4:7], s38 offen offset:0 sc1
  v_mfma_f32_16x16x32_bf16 v[16:19], v[160:163], v[44:47], v[16:19]
  v_mfma_f32_16x16x32_bf16 v[20:23], v[164:167], v[44:47], v[20:23]
  v_mfma_f32_16x16x32_bf16 v[24:27], v[168:171], v[44:47], v[24:27]
  v_mfma_f32_16x16x32_bf16 v[28:31], v[172:175], v[44:47], v[28:31]
  v_mfma_f32_16x16x32_bf16 v[12:15], v[176:179], v[48:51], v[12:15]
  buffer_load_dwordx4 v[44:47], v2, s[4:7], s38 offen offset:2048 sc1
  v_mfma_f32_16x16x32_bf16 v[16:19], v[180:183], v[48:51], v[16:19]
  v_mfma_f32_16x16x32_bf16 v[20:23], v[184:187], v[48:51], v[20:23]
  v_mfma_f32_16x16x32_bf16 v[24:27], v[188:191], v[48:51], v[24:27]
  v_mfma_f32_16x16x32_bf16 v[28:31], v[192:195], v[48:51], v[28:31]
  v_mfma_f32_16x16x32_bf16 v[12:15], v[196:199], v[52:55], v[12:15]
  buffer_load_dwordx4 v[48:51], v2, s[4:7], s39 offen offset:0 sc1
  v_mfma_f32_16x16x32_bf16 v[16:19], v[200:203], v[52:55], v[16:19]
  v_mfma_f32_16x16x32_bf16 v[20:23], v[204:207], v[52:55], v[20:23]
  v_mfma_f32_16x16x32_bf16 v[24:27], v[208:211], v[52:55], v[24:27]
  v_mfma_f32_16x16x32_bf16 v[28:31], v[212:215], v[52:55], v[28:31]
  v_mfma_f32_16x16x32_bf16 v[12:15], v[216:219], v[56:59], v[12:15]
  buffer_load_dwordx4 v[52:55], v2, s[4:7], s39 offen offset:2048 sc1
  v_mfma_f32_16x16x32_bf16 v[16:19], v[220:223], v[56:59], v[16:19]
  v_mfma_f32_16x16x32_bf16 v[20:23], v[224:227], v[56:59], v[20:23]
  v_mfma_f32_16x16x32_bf16 v[24:27], v[228:231], v[56:59], v[24:27]
  v_mfma_f32_16x16x32_bf16 v[28:31], v[232:235], v[56:59], v[28:31]
  v_mfma_f32_16x16x32_bf16 v[12:15], v[236:239], v[60:63], v[12:15]
  buffer_load_dwordx4 v[56:59], v2, s[4:7], s40 offen offset:0 sc1
  v_mfma_f32_16x16x32_bf16 v[16:19], v[240:243], v[60:63], v[16:19]
  v_mfma_f32_16x16x32_bf16 v[20:23], v[244:247], v[60:63], v[20:23]
  v_mfma_f32_16x16x32_bf16 v[24:27], v[248:251], v[60:63], v[24:27]
  v_mfma_f32_16x16x32_bf16 v[28:31], v[252:255], v[60:63], v[28:31]
  buffer_load_dwordx4 v[60:63], v2, s[4:7], s40 offen offset:2048 sc1
  s_waitcnt vmcnt(8)
  s_nop 0
  ds_write_b128 v6, v[12:15] offset:0
  s_nop 0
  ds_write_b128 v6, v[16:19] offset:1024
  ds_write_b128 v6, v[20:23] offset:2048
  ds_write_b128 v6, v[24:27] offset:3072
  ds_write_b128 v6, v[28:31] offset:4096
  buffer_load_dword v11, v3, s[4:7], 0 offen sc1
  v_mfma_f32_16x16x32_bf16 v[12:15], v[96:99], v[64:67], 0
  v_mfma_f32_16x16x32_bf16 v[16:19], v[100:103], v[64:67], 0
  v_mfma_f32_16x16x32_bf16 v[20:23], v[104:107], v[64:67], 0
  v_mfma_f32_16x16x32_bf16 v[24:27], v[108:111], v[64:67], 0
  v_mfma_f32_16x16x32_bf16 v[28:31], v[112:115], v[64:67], 0
  v_mfma_f32_16x16x32_bf16 v[12:15], v[116:119], v[68:71], v[12:15]
  buffer_load_dwordx4 v[64:67], v2, s[4:7], s29 offen offset:1024 sc1
  v_mfma_f32_16x16x32_bf16 v[16:19], v[120:123], v[68:71], v[16:19]
  v_mfma_f32_16x16x32_bf16 v[20:23], v[124:127], v[68:71], v[20:23]
  v_mfma_f32_16x16x32_bf16 v[24:27], v[128:131], v[68:71], v[24:27]
  v_mfma_f32_16x16x32_bf16 v[28:31], v[132:135], v[68:71], v[28:31]
  v_mfma_f32_16x16x32_bf16 v[12:15], v[136:139], v[72:75], v[12:15]
  buffer_load_dwordx4 v[68:71], v2, s[4:7], s29 offen offset:3072 sc1
  v_mfma_f32_16x16x32_bf16 v[16:19], v[140:143], v[72:75], v[16:19]
  v_mfma_f32_16x16x32_bf16 v[20:23], v[144:147], v[72:75], v[20:23]
  v_mfma_f32_16x16x32_bf16 v[24:27], v[148:151], v[72:75], v[24:27]
  v_mfma_f32_16x16x32_bf16 v[28:31], v[152:155], v[72:75], v[28:31]
  v_mfma_f32_16x16x32_bf16 v[12:15], v[156:159], v[76:79], v[12:15]
  buffer_load_dwordx4 v[72:75], v2, s[4:7], s38 offen offset:1024 sc1
  v_mfma_f32_16x16x32_bf16 v[16:19], v[160:163], v[76:79], v[16:19]
  v_mfma_f32_16x16x32_bf16 v[20:23], v[164:167], v[76:79], v[20:23]
  v_mfma_f32_16x16x32_bf16 v[24:27], v[168:171], v[76:79], v[24:27]
  v_mfma_f32_16x16x32_bf16 v[28:31], v[172:175], v[76:79], v[28:31]
  v_mfma_f32_16x16x32_bf16 v[12:15], v[176:179], v[80:83], v[12:15]
  buffer_load_dwordx4 v[76:79], v2, s[4:7], s38 offen offset:3072 sc1
  v_mfma_f32_16x16x32_bf16 v[16:19], v[180:183], v[80:83], v[16:19]
  v_mfma_f32_16x16x32_bf16 v[20:23], v[184:187], v[80:83], v[20:23]
  v_mfma_f32_16x16x32_bf16 v[24:27], v[188:191], v[80:83], v[24:27]
  v_mfma_f32_16x16x32_bf16 v[28:31], v[192:195], v[80:83], v[28:31]
  v_mfma_f32_16x16x32_bf16 v[12:15], v[196:199], v[84:87], v[12:15]
  buffer_load_dwordx4 v[80:83], v2, s[4:7], s39 offen offset:1024 sc1
  v_mfma_f32_16x16x32_bf16 v[16:19], v[200:203], v[84:87], v[16:19]
  v_mfma_f32_16x16x32_bf16 v[20:23], v[204:207], v[84:87], v[20:23]
  v_mfma_f32_16x16x32_bf16 v[24:27], v[208:211], v[84:87], v[24:27]
  v_mfma_f32_16x16x32_bf16 v[28:31], v[212:215], v[84:87], v[28:31]
  v_mfma_f32_16x16x32_bf16 v[12:15], v[216:219], v[88:91], v[12:15]
  buffer_load_dwordx4 v[84:87], v2, s[4:7], s39 offen offset:3072 sc1
  v_mfma_f32_16x16x32_bf16 v[16:19], v[220:223], v[88:91], v[16:19]
  v_mfma_f32_16x16x32_bf16 v[20:23], v[224:227], v[88:91], v[20:23]
  v_mfma_f32_16x16x32_bf16 v[24:27], v[228:231], v[88:91], v[24:27]
  v_mfma_f32_16x16x32_bf16 v[28:31], v[232:235], v[88:91], v[28:31]
  v_mfma_f32_16x16x32_bf16 v[12:15], v[236:239], v[92:95], v[12:15]
  buffer_load_dwordx4 v[88:91], v2, s[4:7], s40 offen offset:1024 sc1
  v_mfma_f32_16x16x32_bf16 v[16:19], v[240:243], v[92:95], v[16:19]
  v_mfma_f32_16x16x32_bf16 v[20:23], v[244:247], v[92:95], v[20:23]
  v_mfma_f32_16x16x32_bf16 v[24:27], v[248:251], v[92:95], v[24:27]
  v_mfma_f32_16x16x32_bf16 v[28:31], v[252:255], v[92:95], v[28:31]
  buffer_load_dwordx4 v[92:95], v2, s[4:7], s40 offen offset:3072 sc1
  s_add_u32 s29, s29, 491520
Lfz_89:
  s_nop 2
  ds_write_b128 v6, v[12:15] offset:5120
  ds_write_b128 v6, v[16:19] offset:6144
  ds_write_b128 v6, v[20:23] offset:7168
  ds_write_b128 v6, v[24:27] offset:8192
  ds_write_b128 v6, v[28:31] offset:9216
  v_add_u32 v6, s33, v6
  s_sub_u32 s33, 0, s33
  s_add_u32 s22, s22, 1
  s_waitcnt lgkmcnt(0)
  s_barrier
  s_branch Lf_77
Lf_91:
  s_setprio 3
  ds_read_b128 v[12:15], v7 offset:0
  ds_read_b128 v[16:19], v7 offset:10240
  ds_read_b128 v[20:23], v7 offset:20480
  ds_read_b128 v[24:27], v7 offset:30720
  ds_read_b128 v[28:31], v8 offset:0
  ds_read_b128 v[60:63], v8 offset:10240
  ds_read_b128 v[92:95], v8 offset:20480
  ds_read_b128 v[236:239], v8 offset:30720
  s_waitcnt lgkmcnt(6)
  v_add_f32 v12, v12, v16
  v_add_f32 v13, v13, v17
  v_add_f32 v14, v14, v18
  v_add_f32 v15, v15, v19
  s_waitcnt lgkmcnt(4)
  v_add_f32 v20, v20, v24
  v_add_f32 v21, v21, v25
  v_add_f32 v22, v22, v26
  v_add_f32 v23, v23, v27
  s_waitcnt lgkmcnt(2)
  v_add_f32 v28, v28, v60
  v_add_f32 v29, v29, v61
  v_add_f32 v30, v30, v62
  v_add_f32 v31, v31, v63
  s_waitcnt lgkmcnt(0)
  v_add_f32 v92, v92, v236
  v_add_f32 v93, v93, v237
  v_add_f32 v94, v94, v238
  v_add_f32 v95, v95, v239
  v_add_f32 v12, v12, v20
  v_add_f32 v13, v13, v21
  v_add_f32 v14, v14, v22
  v_add_f32 v15, v15, v23
  v_add_f32 v28, v28, v92
  v_add_f32 v29, v29, v93
  v_add_f32 v30, v30, v94
  v_add_f32 v31, v31, v95
  v_add_f32 v240, v12, v28
  v_add_f32 v241, v13, v29
  v_add_f32 v242, v14, v30
  v_add_f32 v243, v15, v31
  v_cvt_pk_bf16_f32 v240, v240, v241
  v_cvt_pk_bf16_f32 v241, v242, v243
  buffer_store_dwordx2 v[240:241], v5, s[4:7], s26 offen sc1
  s_add_u32 s26, s26, 163840
  ds_read_b128 v[12:15], v7 offset:4096
  ds_read_b128 v[16:19], v7 offset:14336
  ds_read_b128 v[20:23], v7 offset:24576
  ds_read_b128 v[24:27], v7 offset:34816
  ds_read_b128 v[28:31], v8 offset:4096
  ds_read_b128 v[60:63], v8 offset:14336
  ds_read_b128 v[92:95], v8 offset:24576
  ds_read_b128 v[236:239], v8 offset:34816
  s_waitcnt lgkmcnt(6)
  v_add_f32 v12, v12, v16
  v_add_f32 v13, v13, v17
  v_add_f32 v14, v14, v18
  v_add_f32 v15, v15, v19
  s_waitcnt lgkmcnt(4)
  v_add_f32 v20, v20, v24
  v_add_f32 v21, v21, v25
  v_add_f32 v22, v22, v26
  v_add_f32 v23, v23, v27
  s_waitcnt lgkmcnt(2)
  v_add_f32 v28, v28, v60
  v_add_f32 v29, v29, v61
  v_add_f32 v30, v30, v62
  v_add_f32 v31, v31, v63
  s_waitcnt lgkmcnt(0)
  v_add_f32 v92, v92, v236
  v_add_f32 v93, v93, v237
  v_add_f32 v94, v94, v238
  v_add_f32 v95, v95, v239
  v_add_f32 v12, v12, v20
  v_add_f32 v13, v13, v21
  v_add_f32 v14, v14, v22
  v_add_f32 v15, v15, v23
  v_add_f32 v28, v28, v92
  v_add_f32 v29, v29, v93
  v_add_f32 v30, v30, v94
  v_add_f32 v31, v31, v95
  v_add_f32 v244, v12, v28
  v_add_f32 v245, v13, v29
  v_add_f32 v246, v14, v30
  v_add_f32 v247, v15, v31
  v_cvt_pk_bf16_f32 v244, v244, v245
  v_cvt_pk_bf16_f32 v245, v246, v247
  buffer_store_dwordx2 v[244:245], v5, s[4:7], s30 offen sc1
  s_add_u32 s30, s30, 163840
  s_cmp_lt_u32 s20, 6
  s_cbranch_scc0 Lfu_100
  ds_read_b128 v[12:15], v7 offset:8192
  ds_read_b128 v[16:19], v7 offset:18432
  ds_read_b128 v[20:23], v7 offset:28672
  ds_read_b128 v[24:27], v7 offset:38912
  ds_read_b128 v[28:31], v8 offset:8192
  ds_read_b128 v[60:63], v8 offset:18432
  ds_read_b128 v[92:95], v8 offset:28672
  ds_read_b128 v[236:239], v8 offset:38912
  s_waitcnt lgkmcnt(6)
  v_add_f32 v12, v12, v16
  v_add_f32 v13, v13, v17
  v_add_f32 v14, v14, v18
  v_add_f32 v15, v15, v19
  s_waitcnt lgkmcnt(4)
  v_add_f32 v20, v20, v24
  v_add_f32 v21, v21, v25
  v_add_f32 v22, v22, v26
  v_add_f32 v23, v23, v27
  s_waitcnt lgkmcnt(2)
  v_add_f32 v28, v28, v60
  v_add_f32 v29, v29, v61
  v_add_f32 v30, v30, v62
  v_add_f32 v31, v31, v63
  s_waitcnt lgkmcnt(0)
  v_add_f32 v92, v92, v236
  v_add_f32 v93, v93, v237
  v_add_f32 v94, v94, v238
  v_add_f32 v95, v95, v239
  v_add_f32 v12, v12, v20
  v_add_f32 v13, v13, v21
  v_add_f32 v14, v14, v22
  v_add_f32 v15, v15, v23
  v_add_f32 v28, v28, v92
  v_add_f32 v29, v29, v93
  v_add_f32 v30, v30, v94
  v_add_f32 v31, v31, v95
  v_add_f32 v248, v12, v28
  v_add_f32 v249, v13, v29
  v_add_f32 v250, v14, v30
  v_add_f32 v251, v15, v31
  v_cvt_pk_bf16_f32 v248, v248, v249
  v_cvt_pk_bf16_f32 v249, v250, v251
  buffer_store_dwordx2 v[248:249], v5, s[4:7], s31 offen sc1
  s_add_u32 s31, s31, 163840
Lfu_100:
  s_setprio 1
  v_subrev_u32 v7, s33, v7
  v_subrev_u32 v8, s33, v8
  s_mov_b32 s27, 1
  s_cmp_eq_u32 s22, 44
  s_cbranch_scc0 Lw_fin7x
  s_waitcnt vmcnt(0)
  v_mov_b32 v10, s22
  buffer_store_dword v10, v4, s[4:7], 0 offen sc1
  s_branch Lw_fhalf
Lw_fin7x:
  s_add_u32 s41, s22, 1
  s_cmp_eq_u32 s41, 44
  s_cselect_b32 s41, -1, s41
  s_cmp_eq_u32 s32, 1
  s_cbranch_scc1 Lfh_95
Lfp_92:
  buffer_load_dword v9, v3, s[4:7], 0 offen sc1
  s_waitcnt vmcnt(0)
  s_cmp_eq_u32 s27, 0
  s_cbranch_scc1 Lfq_93
  v_mov_b32 v10, s22
  buffer_store_dword v10, v4, s[4:7], 0 offen sc1
  s_mov_b32 s27, 0
Lfq_93:
  v_cmp_ge_u32 vcc, s22, v9
  s_cbranch_vccz Lfd_94
  s_sleep 1
  s_sub_u32 s24, s24, 1
  s_cbranch_scc0 Lfp_92
  s_branch Lw_fail
Lfd_94:
  s_add_u32 s38, s29, 4096
  s_add_u32 s39, s29, 8192
  s_add_u32 s40, s29, s19
  buffer_load_dwordx4 v[32:35], v2, s[4:7], s29 offen offset:0 sc1
  buffer_load_dwordx4 v[36:39], v2, s[4:7], s29 offen offset:2048 sc1
  buffer_load_dwordx4 v[40:43], v2, s[4:7], s38 offen offset:0 sc1
  buffer_load_dwordx4 v[44:47], v2, s[4:7], s38 offen offset:2048 sc1
  buffer_load_dwordx4 v[48:51], v2, s[4:7], s39 offen offset:0 sc1
  buffer_load_dwordx4 v[52:55], v2, s[4:7], s39 offen offset:2048 sc1
  buffer_load_dwordx4 v[56:59], v2, s[4:7], s40 offen offset:0 sc1
  buffer_load_dwordx4 v[64:67], v2, s[4:7], s29 offen offset:1024 sc1
  buffer_load_dwordx4 v[68:71], v2, s[4:7], s29 offen offset:3072 sc1
  buffer_load_dwordx4 v[72:75], v2, s[4:7], s38 offen offset:1024 sc1
  buffer_load_dwordx4 v[76:79], v2, s[4:7], s38 offen offset:3072 sc1
  buffer_load_dwordx4 v[80:83], v2, s[4:7], s39 offen offset:1024 sc1
  buffer_load_dwordx4 v[84:87], v2, s[4:7], s39 offen offset:3072 sc1
  buffer_load_dwordx4 v[88:91], v2, s[4:7], s40 offen offset:1024 sc1
  s_add_u32 s29, s29, 491520
  s_waitcnt vmcnt(13)
  v_mfma_f32_16x16x32_bf16 v[12:15], v[96:99], v[32:35], 0
  v_mfma_f32_16x16x32_bf16 v[16:19], v[100:103], v[32:35], 0
  v_mfma_f32_16x16x32_bf16 v[20:23], v[104:107], v[32:35], 0
  v_mfma_f32_16x16x32_bf16 v[24:27], v[108:111], v[32:35], 0
  v_mfma_f32_16x16x32_bf16 v[28:31], v[112:115], v[32:35], 0
  s_waitcnt vmcnt(12)
  v_mfma_f32_16x16x32_bf16 v[12:15], v[116:119], v[36:39], v[12:15]
  v_mfma_f32_16x16x32_bf16 v[16:19], v[120:123], v[36:39], v[16:19]
  v_mfma_f32_16x16x32_bf16 v[20:23], v[124:127], v[36:39], v[20:23]
  v_mfma_f32_16x16x32_bf16 v[24:27], v[128:131], v[36:39], v[24:27]
  v_mfma_f32_16x16x32_bf16 v[28:31], v[132:135], v[36:39], v[28:31]
  s_waitcnt vmcnt(11)
  v_mfma_f32_16x16x32_bf16 v[12:15], v[136:139], v[40:43], v[12:15]
  v_mfma_f32_16x16x32_bf16 v[16:19], v[140:143], v[40:43], v[16:19]
  v_mfma_f32_16x16x32_bf16 v[20:23], v[144:147], v[40:43], v[20:23]
  v_mfma_f32_16x16x32_bf16 v[24:27], v[148:151], v[40:43], v[24:27]
  v_mfma_f32_16x16x32_bf16 v[28:31], v[152:155], v[40:43], v[28:31]
  s_waitcnt vmcnt(10)
  v_mfma_f32_16x16x32_bf16 v[12:15], v[156:159], v[44:47], v[12:15]
  v_mfma_f32_16x16x32_bf16 v[16:19], v[160:163], v[44:47], v[16:19]
  v_mfma_f32_16x16x32_bf16 v[20:23], v[164:167], v[44:47], v[20:23]
  v_mfma_f32_16x16x32_bf16 v[24:27], v[168:171], v[44:47], v[24:27]
  v_mfma_f32_16x16x32_bf16 v[28:31], v[172:175], v[44:47], v[28:31]
  s_waitcnt vmcnt(9)
  v_mfma_f32_16x16x32_bf16 v[12:15], v[176:179], v[48:51], v[12:15]
  v_mfma_f32_16x16x32_bf16 v[16:19], v[180:183], v[48:51], v[16:19]
  v_mfma_f32_16x16x32_bf16 v[20:23], v[184:187], v[48:51], v[20:23]
  v_mfma_f32_16x16x32_bf16 v[24:27], v[188:191], v[48:51], v[24:27]
  v_mfma_f32_16x16x32_bf16 v[28:31], v[192:195], v[48:51], v[28:31]
  s_waitcnt vmcnt(8)
  v_mfma_f32_16x16x32_bf16 v[12:15], v[196:199], v[52:55], v[12:15]
  v_mfma_f32_16x16x32_bf16 v[16:19], v[200:203], v[52:55], v[16:19]
  v_mfma_f32_16x16x32_bf16 v[20:23], v[204:207], v[52:55], v[20:23]
  v_mfma_f32_16x16x32_bf16 v[24:27], v[208:211], v[52:55], v[24:27]
  v_mfma_f32_16x16x32_bf16 v[28:31], v[212:215], v[52:55], v[28:31]
  s_waitcnt vmcnt(7)
  v_mfma_f32_16x16x32_bf16 v[12:15], v[216:219], v[56:59], v[12:15]
  v_mfma_f32_16x16x32_bf16 v[16:19], v[220:223], v[56:59], v[16:19]
  v_mfma_f32_16x16x32_bf16 v[20:23], v[224:227], v[56:59], v[20:23]
  v_mfma_f32_16x16x32_bf16 v[24:27], v[228:231], v[56:59], v[24:27]
  v_mfma_f32_16x16x32_bf16 v[28:31], v[232:235], v[56:59], v[28:31]
  s_nop 3
  ds_write_b128 v6, v[12:15] offset:0
  ds_write_b128 v6, v[16:19] offset:1024
  ds_write_b128 v6, v[20:23] offset:2048
  ds_write_b128 v6, v[24:27] offset:3072
  ds_write_b128 v6, v[28:31] offset:4096
  v_cmp_ge_u32 vcc, s41, v9
  s_cbranch_vccz Lfn_97
  s_waitcnt vmcnt(6)
  v_mfma_f32_16x16x32_bf16 v[12:15], v[96:99], v[64:67], 0
  v_mfma_f32_16x16x32_bf16 v[16:19], v[100:103], v[64:67], 0
  v_mfma_f32_16x16x32_bf16 v[20:23], v[104:107], v[64:67], 0
  v_mfma_f32_16x16x32_bf16 v[24:27], v[108:111], v[64:67], 0
  v_mfma_f32_16x16x32_bf16 v[28:31], v[112:115], v[64:67], 0
  s_waitcnt vmcnt(5)
  v_mfma_f32_16x16x32_bf16 v[12:15], v[116:119], v[68:71], v[12:15]
  v_mfma_f32_16x16x32_bf16 v[16:19], v[120:123], v[68:71], v[16:19]
  v_mfma_f32_16x16x32_bf16 v[20:23], v[124:127], v[68:71], v[20:23]
  v_mfma_f32_16x16x32_bf16 v[24:27], v[128:131], v[68:71], v[24:27]
  v_mfma_f32_16x16x32_bf16 v[28:31], v[132:135], v[68:71], v[28:31]
  s_waitcnt vmcnt(4)
  v_mfma_f32_16x16x32_bf16 v[12:15], v[136:139], v[72:75], v[12:15]
  v_mfma_f32_16x16x32_bf16 v[16:19], v[140:143], v[72:75], v[16:19]
  v_mfma_f32_16x16x32_bf16 v[20:23], v[144:147], v[72:75], v[20:23]
  v_mfma_f32_16x16x32_bf16 v[24:27], v[148:151], v[72:75], v[24:27]
  v_mfma_f32_16x16x32_bf16 v[28:31], v[152:155], v[72:75], v[28:31]
  s_waitcnt vmcnt(3)
  v_mfma_f32_16x16x32_bf16 v[12:15], v[156:159], v[76:79], v[12:15]
  v_mfma_f32_16x16x32_bf16 v[16:19], v[160:163], v[76:79], v[16:19]
  v_mfma_f32_16x16x32_bf16 v[20:23], v[164:167], v[76:79], v[20:23]
  v_mfma_f32_16x16x32_bf16 v[24:27], v[168:171], v[76:79], v[24:27]
  v_mfma_f32_16x16x32_bf16 v[28:31], v[172:175], v[76:79], v[28:31]
  s_waitcnt vmcnt(2)
  v_mfma_f32_16x16x32_bf16 v[12:15], v[176:179], v[80:83], v[12:15]
  v_mfma_f32_16x16x32_bf16 v[16:19], v[180:183], v[80:83], v[16:19]
  v_mfma_f32_16x16x32_bf16 v[20:23], v[184:187], v[80:83], v[20:23]
  v_mfma_f32_16x16x32_bf16 v[24:27], v[188:191], v[80:83], v[24:27]
  v_mfma_f32_16x16x32_bf16 v[28:31], v[192:195], v[80:83], v[28:31]
  s_waitcnt vmcnt(1)
  v_mfma_f32_16x16x32_bf16 v[12:15], v[196:199], v[84:87], v[12:15]
  v_mfma_f32_16x16x32_bf16 v[16:19], v[200:203], v[84:87], v[16:19]
  v_mfma_f32_16x16x32_bf16 v[20:23], v[204:207], v[84:87], v[20:23]
  v_mfma_f32_16x16x32_bf16 v[24:27], v[208:211], v[84:87], v[24:27]
  v_mfma_f32_16x16x32_bf16 v[28:31], v[212:215], v[84:87], v[28:31]
  s_waitcnt vmcnt(0)
  v_mfma_f32_16x16x32_bf16 v[12:15], v[216:219], v[88:91], v[12:15]
  v_mfma_f32_16x16x32_bf16 v[16:19], v[220:223], v[88:91], v[16:19]
  v_mfma_f32_16x16x32_bf16 v[20:23], v[224:227], v[88:91], v[20:23]
  v_mfma_f32_16x16x32_bf16 v[24:27], v[228:231], v[88:91], v[24:27]
  v_mfma_f32_16x16x32_bf16 v[28:31], v[232:235], v[88:91], v[28:31]
  s_branch Lfz_103
Lfh_95:
  buffer_load_dword v9, v3, s[4:7], 0 offen sc1
  s_waitcnt vmcnt(10)
  v_cmp_ge_u32 vcc, s41, v11
  s_cbranch_vccz Lfe_101
  v_mfma_f32_16x16x32_bf16 v[12:15], v[96:99], v[32:35], 0
  v_mfma_f32_16x16x32_bf16 v[16:19], v[100:103], v[32:35], 0
  v_mfma_f32_16x16x32_bf16 v[20:23], v[104:107], v[32:35], 0
  v_mfma_f32_16x16x32_bf16 v[24:27], v[108:111], v[32:35], 0
  v_mfma_f32_16x16x32_bf16 v[28:31], v[112:115], v[32:35], 0
  v_mfma_f32_16x16x32_bf16 v[12:15], v[116:119], v[36:39], v[12:15]
  v_mfma_f32_16x16x32_bf16 v[16:19], v[120:123], v[36:39], v[16:19]
  v_mfma_f32_16x16x32_bf16 v[20:23], v[124:127], v[36:39], v[20:23]
  v_mfma_f32_16x16x32_bf16 v[24:27], v[128:131], v[36:39], v[24:27]
  v_mfma_f32_16x16x32_bf16 v[28:31], v[132:135], v[36:39], v[28:31]
  v_mfma_f32_16x16x32_bf16 v[12:15], v[136:139], v[40:43], v[12:15]
  v_mfma_f32_16x16x32_bf16 v[16:19], v[140:143], v[40:43], v[16:19]
  v_mfma_f32_16x16x32_bf16 v[20:23], v[144:147], v[40:43], v[20:23]
  v_mfma_f32_16x16x32_bf16 v[24:27], v[148:151], v[40:43], v[24:27]
  v_mfma_f32_16x16x32_bf16 v[28:31], v[152:155], v[40:43], v[28:31]
  v_mfma_f32_16x16x32_bf16 v[12:15], v[156:159], v[44:47], v[12:15]
  v_mfma_f32_16x16x32_bf16 v[16:19], v[160:163], v[44:47], v[16:19]
  v_mfma_f32_16x16x32_bf16 v[20:23], v[164:167], v[44:47], v[20:23]
  v_mfma_f32_16x16x32_bf16 v[24:27], v[168:171], v[44:47], v[24:27]
  v_mfma_f32_16x16x32_bf16 v[28:31], v[172:175], v[44:47], v[28:31]
  v_mfma_f32_16x16x32_bf16 v[12:15], v[176:179], v[48:51], v[12:15]
  v_mfma_f32_16x16x32_bf16 v[16:19], v[180:183], v[48:51], v[16:19]
  v_mfma_f32_16x16x32_bf16 v[20:23], v[184:187], v[48:51], v[20:23]
  v_mfma_f32_16x16x32_bf16 v[24:27], v[188:191], v[48:51], v[24:27]
  v_mfma_f32_16x16x32_bf16 v[28:31], v[192:195], v[48:51], v[28:31]
  v_mfma_f32_16x16x32_bf16 v[12:15], v[196:199], v[52:55], v[12:15]
  v_mfma_f32_16x16x32_bf16 v[16:19], v[200:203], v[52:55], v[16:19]
  v_mfma_f32_16x16x32_bf16 v[20:23], v[204:207], v[52:55], v[20:23]
  v_mfma_f32_16x16x32_bf16 v[24:27], v[208:211], v[52:55], v[24:27]
  v_mfma_f32_16x16x32_bf16 v[28:31], v[212:215], v[52:55], v[28:31]
  v_mfma_f32_16x16x32_bf16 v[12:15], v[216:219], v[56:59], v[12:15]
  v_mfma_f32_16x16x32_bf16 v[16:19], v[220:223], v[56:59], v[16:19]
  v_mfma_f32_16x16x32_bf16 v[20:23], v[224:227], v[56:59], v[20:23]
  v_mfma_f32_16x16x32_bf16 v[24:27], v[228:231], v[56:59], v[24:27]
  v_mfma_f32_16x16x32_bf16 v[28:31], v[232:235], v[56:59], v[28:31]
  s_waitcnt vmcnt(0)
  s_nop 2
  ds_write_b128 v6, v[12:15] offset:0
  ds_write_b128 v6, v[16:19] offset:1024
  ds_write_b128 v6, v[20:23] offset:2048
  ds_write_b128 v6, v[24:27] offset:3072
  ds_write_b128 v6, v[28:31] offset:4096
  s_cmp_eq_u32 s27, 0
  s_cbranch_scc1 Lfq_99
  v_mov_b32 v10, s22
  buffer_store_dword v10, v4, s[4:7], 0 offen sc1
  s_mov_b32 s27, 0
Lfq_99:
  v_cmp_ge_u32 vcc, s41, v9
  s_cbranch_vccz Lfm_102
  s_mov_b32 s32, 0
  v_mfma_f32_16x16x32_bf16 v[12:15], v[96:99], v[64:67], 0
  v_mfma_f32_16x16x32_bf16 v[16:19], v[100:103], v[64:67], 0
  v_mfma_f32_16x16x32_bf16 v[20:23], v[104:107], v[64:67], 0
  v_mfma_f32_16x16x32_bf16 v[24:27], v[108:111], v[64:67], 0
  v_mfma_f32_16x16x32_bf16 v[28:31], v[112:115], v[64:67], 0
  v_mfma_f32_16x16x32_bf16 v[12:15], v[116:119], v[68:71], v[12:15]
  v_mfma_f32_16x16x32_bf16 v[16:19], v[120:123], v[68:71], v[16:19]
  v_mfma_f32_16x16x32_bf16 v[20:23], v[124:127], v[68:71], v[20:23]
  v_mfma_f32_16x16x32_bf16 v[24:27], v[128:131], v[68:71], v[24:27]
  v_mfma_f32_16x16x32_bf16 v[28:31], v[132:135], v[68:71], v[28:31]
  v_mfma_f32_16x16x32_bf16 v[12:15], v[136:139], v[72:75], v[12:15]
  v_mfma_f32_16x16x32_bf16 v[16:19], v[140:143], v[72:75], v[16:19]
  v_mfma_f32_16x16x32_bf16 v[20:23], v[144:147], v[72:75], v[20:23]
  v_mfma_f32_16x16x32_bf16 v[24:27], v[148:151], v[72:75], v[24:27]
  v_mfma_f32_16x16x32_bf16 v[28:31], v[152:155], v[72:75], v[28:31]
  v_mfma_f32_16x16x32_bf16 v[12:15], v[156:159], v[76:79], v[12:15]
  v_mfma_f32_16x16x32_bf16 v[16:19], v[160:163], v[76:79], v[16:19]
  v_mfma_f32_16x16x32_bf16 v[20:23], v[164:167], v[76:79], v[20:23]
  v_mfma_f32_16x16x32_bf16 v[24:27], v[168:171], v[76:79], v[24:27]
  v_mfma_f32_16x16x32_bf16 v[28:31], v[172:175], v[76:79], v[28:31]
  v_mfma_f32_16x16x32_bf16 v[12:15], v[176:179], v[80:83], v[12:15]
  v_mfma_f32_16x16x32_bf16 v[16:19], v[180:183], v[80:83], v[16:19]
  v_mfma_f32_16x16x32_bf16 v[20:23], v[184:187], v[80:83], v[20:23]
  v_mfma_f32_16x16x32_bf16 v[24:27], v[188:191], v[80:83], v[24:27]
  v_mfma_f32_16x16x32_bf16 v[28:31], v[192:195], v[80:83], v[28:31]
  v_mfma_f32_16x16x32_bf16 v[12:15], v[196:199], v[84:87], v[12:15]
  v_mfma_f32_16x16x32_bf16 v[16:19], v[200:203], v[84:87], v[16:19]
  v_mfma_f32_16x16x32_bf16 v[20:23], v[204:207], v[84:87], v[20:23]
  v_mfma_f32_16x16x32_bf16 v[24:27], v[208:211], v[84:87], v[24:27]
  v_mfma_f32_16x16x32_bf16 v[28:31], v[212:215], v[84:87], v[28:31]
  v_mfma_f32_16x16x32_bf16 v[12:15], v[216:219], v[88:91], v[12:15]
  v_mfma_f32_16x16x32_bf16 v[16:19], v[220:223], v[88:91], v[16:19]
  v_mfma_f32_16x16x32_bf16 v[20:23], v[224:227], v[88:91], v[20:23]
  v_mfma_f32_16x16x32_bf16 v[24:27], v[228:231], v[88:91], v[24:27]
  v_mfma_f32_16x16x32_bf16 v[28:31], v[232:235], v[88:91], v[28:31]
  s_branch Lfz_103
Lfn_97:
  s_waitcnt vmcnt(0)
Lfm_102:
  s_mov_b32 s32, 1
  buffer_load_dword v11, v3, s[4:7], 0 offen sc1
  s_add_u32 s38, s29, 4096
  s_add_u32 s39, s29, 8192
  s_add_u32 s40, s29, s19
  v_mfma_f32_16x16x32_bf16 v[12:15], v[96:99], v[64:67], 0
  v_mfma_f32_16x16x32_bf16 v[16:19], v[100:103], v[64:67], 0
  v_mfma_f32_16x16x32_bf16 v[20:23], v[104:107], v[64:67], 0
  v_mfma_f32_16x16x32_bf16 v[24:27], v[108:111], v[64:67], 0
  v_mfma_f32_16x16x32_bf16 v[28:31], v[112:115], v[64:67], 0
  v_mfma_f32_16x16x32_bf16 v[12:15], v[116:119], v[68:71], v[12:15]
  buffer_load_dwordx4 v[32:35], v2, s[4:7], s29 offen offset:0 sc1
  v_mfma_f32_16x16x32_bf16 v[16:19], v[120:123], v[68:71], v[16:19]
  v_mfma_f32_16x16x32_bf16 v[20:23], v[124:127], v[68:71], v[20:23]
  buffer_load_dwordx4 v[36:39], v2, s[4:7], s29 offen offset:2048 sc1
  v_mfma_f32_16x16x32_bf16 v[24:27], v[128:131], v[68:71], v[24:27]
  v_mfma_f32_16x16x32_bf16 v[28:31], v[132:135], v[68:71], v[28:31]
  v_mfma_f32_16x16x32_bf16 v[12:15], v[136:139], v[72:75], v[12:15]
  buffer_load_dwordx4 v[40:43], v2, s[4:7], s38 offen offset:0 sc1
  v_mfma_f32_16x16x32_bf16 v[16:19], v[140:143], v[72:75], v[16:19]
  v_mfma_f32_16x16x32_bf16 v[20:23], v[144:147], v[72:75], v[20:23]
  buffer_load_dwordx4 v[44:47], v2, s[4:7], s38 offen offset:2048 sc1
  v_mfma_f32_16x16x32_bf16 v[24:27], v[148:151], v[72:75], v[24:27]
  v_mfma_f32_16x16x32_bf16 v[28:31], v[152:155], v[72:75], v[28:31]
  v_mfma_f32_16x16x32_bf16 v[12:15], v[156:159], v[76:79], v[12:15]
  buffer_load_dwordx4 v[48:51], v2, s[4:7], s39 offen offset:0 sc1
  v_mfma_f32_16x16x32_bf16 v[16:19], v[160:163], v[76:79], v[16:19]
  v_mfma_f32_16x16x32_bf16 v[20:23], v[164:167], v[76:79], v[20:23]
  buffer_load_dwordx4 v[52:55], v2, s[4:7], s39 offen offset:2048 sc1
  v_mfma_f32_16x16x32_bf16 v[24:27], v[168:171], v[76:79], v[24:27]
  v_mfma_f32_16x16x32_bf16 v[28:31], v[172:175], v[76:79], v[28:31]
  v_mfma_f32_16x16x32_bf16 v[12:15], v[176:179], v[80:83], v[12:15]
  buffer_load_dwordx4 v[56:59], v2, s[4:7], s40 offen offset:0 sc1
  v_mfma_f32_16x16x32_bf16 v[16:19], v[180:183], v[80:83], v[16:19]
  v_mfma_f32_16x16x32_bf16 v[20:23], v[184:187], v[80:83], v[20:23]
  buffer_load_dwordx4 v[64:67], v2, s[4:7], s29 offen offset:1024 sc1
  v_mfma_f32_16x16x32_bf16 v[24:27], v[188:191], v[80:83], v[24:27]
  v_mfma_f32_16x16x32_bf16 v[28:31], v[192:195], v[80:83], v[28:31]
  v_mfma_f32_16x16x32_bf16 v[12:15], v[196:199], v[84:87], v[12:15]
  buffer_load_dwordx4 v[68:71], v2, s[4:7], s29 offen offset:3072 sc1
  v_mfma_f32_16x16x32_bf16 v[16:19], v[200:203], v[84:87], v[16:19]
  v_mfma_f32_16x16x32_bf16 v[20:23], v[204:207], v[84:87], v[20:23]
  buffer_load_dwordx4 v[72:75], v2, s[4:7], s38 offen offset:1024 sc1
  v_mfma_f32_16x16x32_bf16 v[24:27], v[208:211], v[84:87], v[24:27]
  v_mfma_f32_16x16x32_bf16 v[28:31], v[212:215], v[84:87], v[28:31]
  v_mfma_f32_16x16x32_bf16 v[12:15], v[216:219], v[88:91], v[12:15]
  buffer_load_dwordx4 v[76:79], v2, s[4:7], s38 offen offset:3072 sc1
  v_mfma_f32_16x16x32_bf16 v[16:19], v[220:223], v[88:91], v[16:19]
  v_mfma_f32_16x16x32_bf16 v[20:23], v[224:227], v[88:91], v[20:23]
  buffer_load_dwordx4 v[80:83], v2, s[4:7], s39 offen offset:1024 sc1
  v_mfma_f32_16x16x32_bf16 v[24:27], v[228:231], v[88:91], v[24:27]
  v_mfma_f32_16x16x32_bf16 v[28:31], v[232:235], v[88:91], v[28:31]
  buffer_load_dwordx4 v[84:87], v2, s[4:7], s39 offen offset:3072 sc1
  buffer_load_dwordx4 v[88:91], v2, s[4:7], s40 offen offset:1024 sc1
  s_add_u32 s29, s29, 491520
  s_branch Lfz_103
Lfe_101:
  s_add_u32 s38, s29, 4096
  s_add_u32 s39, s29, 8192
  s_add_u32 s40, s29, s19
  v_mfma_f32_16x16x32_bf16 v[12:15], v[96:99], v[32:35], 0
  v_mfma_f32_16x16x32_bf16 v[16:19], v[100:103], v[32:35], 0
  v_mfma_f32_16x16x32_bf16 v[20:23], v[104:107], v[32:35], 0
  v_mfma_f32_16x16x32_bf16 v[24:27], v[108:111], v[32:35], 0
  v_mfma_f32_16x16x32_bf16 v[28:31], v[112:115], v[32:35], 0
  v_mfma_f32_16x16x32_bf16 v[12:15], v[116:119], v[36:39], v[12:15]
  buffer_load_dwordx4 v[32:35], v2, s[4:7], s29 offen offset:0 sc1
  v_mfma_f32_16x16x32_bf16 v[16:19], v[120:123], v[36:39], v[16:19]
  v_mfma_f32_16x16x32_bf16 v[20:23], v[124:127], v[36:39], v[20:23]
  v_mfma_f32_16x16x32_bf16 v[24:27], v[128:131], v[36:39], v[24:27]
  v_mfma_f32_16x16x32_bf16 v[28:31], v[132:135], v[36:39], v[28:31]
  v_mfma_f32_16x16x32_bf16 v[12:15], v[136:139], v[40:43], v[12:15]
  buffer_load_dwordx4 v[36:39], v2, s[4:7], s29 offen offset:2048 sc1
  v_mfma_f32_16x16x32_bf16 v[16:19], v[140:143], v[40:43], v[16:19]
  v_mfma_f32_16x16x32_bf16 v[20:23], v[144:147], v[40:43], v[20:23]
  v_mfma_f32_16x16x32_bf16 v[24:27], v[148:151], v[40:43], v[24:27]
  v_mfma_f32_16x16x32_bf16 v[28:31], v[152:155], v[40:43], v[28:31]
  v_mfma_f32_16x16x32_bf16 v[12:15], v[156:159], v[44:47], v[12:15]
  buffer_load_dwordx4 v[40:43], v2, s[4:7], s38 offen offset:0 sc1
  v_mfma_f32_16x16x32_bf16 v[16:19], v[160:163], v[44:47], v[16:19]
  v_mfma_f32_16x16x32_bf16 v[20:23], v[164:167], v[44:47], v[20:23]
  v_mfma_f32_16x16x32_bf16 v[24:27], v[168:171], v[44:47], v[24:27]
  v_mfma_f32_16x16x32_bf16 v[28:31], v[172:175], v[44:47], v[28:31]
  v_mfma_f32_16x16x32_bf16 v[12:15], v[176:179], v[48:51], v[12:15]
  buffer_load_dwordx4 v[44:47], v2, s[4:7], s38 offen offset:2048 sc1
  v_mfma_f32_16x16x32_bf16 v[16:19], v[180:183], v[48:51], v[16:19]
  v_mfma_f32_16x16x32_bf16 v[20:23], v[184:187], v[48:51], v[20:23]
  v_mfma_f32_16x16x32_bf16 v[24:27], v[188:191], v[48:51], v[24:27]
  v_mfma_f32_16x16x32_bf16 v[28:31], v[192:195], v[48:51], v[28:31]
  v_mfma_f32_16x16x32_bf16 v[12:15], v[196:199], v[52:55], v[12:15]
  buffer_load_dwordx4 v[48:51], v2, s[4:7], s39 offen offset:0 sc1
  v_mfma_f32_16x16x32_bf16 v[16:19], v[200:203], v[52:55], v[16:19]
  v_mfma_f32_16x16x32_bf16 v[20:23], v[204:207], v[52:55], v[20:23]
  v_mfma_f32_16x16x32_bf16 v[24:27], v[208:211], v[52:55], v[24:27]
  v_mfma_f32_16x16x32_bf16 v[28:31], v[212:215], v[52:55], v[28:31]
  v_mfma_f32_16x16x32_bf16 v[12:15], v[216:219], v[56:59], v[12:15]
  buffer_load_dwordx4 v[52:55], v2, s[4:7], s39 offen offset:2048 sc1
  v_mfma_f32_16x16x32_bf16 v[16:19], v[220:223], v[56:59], v[16:19]
  v_mfma_f32_16x16x32_bf16 v[20:23], v[224:227], v[56:59], v[20:23]
  v_mfma_f32_16x16x32_bf16 v[24:27], v[228:231], v[56:59], v[24:27]
  v_mfma_f32_16x16x32_bf16 v[28:31], v[232:235], v[56:59], v[28:31]
  buffer_load_dwordx4 v[56:59], v2, s[4:7], s40 offen offset:0 sc1
  s_waitcnt vmcnt(7)
  s_nop 0
  ds_write_b128 v6, v[12:15] offset:0
  s_nop 0
  ds_write_b128 v6, v[16:19] offset:1024
  ds_write_b128 v6, v[20:23] offset:2048
  ds_write_b128 v6, v[24:27] offset:3072
  ds_write_b128 v6, v[28:31] offset:4096
  s_cmp_eq_u32 s27, 0
  s_cbranch_scc1 Lfq_104
  v_mov_b32 v10, s22
  buffer_store_dword v10, v4, s[4:7], 0 offen sc1
  s_mov_b32 s27, 0
Lfq_104:
  buffer_load_dword v11, v3, s[4:7], 0 offen sc1
  v_mfma_f32_16x16x32_bf16 v[12:15], v[96:99], v[64:67], 0
  v_mfma_f32_16x16x32_bf16 v[16:19], v[100:103], v[64:67], 0
  v_mfma_f32_16x16x32_bf16 v[20:23], v[104:107], v[64:67], 0
  v_mfma_f32_16x16x32_bf16 v[24:27], v[108:111], v[64:67], 0
  v_mfma_f32_16x16x32_bf16 v[28:31], v[112:115], v[64:67], 0
  v_mfma_f32_16x16x32_bf16 v[12:15], v[116:119], v[68:71], v[12:15]
  buffer_load_dwordx4 v[64:67], v2, s[4:7], s29 offen offset:1024 sc1
  v_mfma_f32_16x16x32_bf16 v[16:19], v[120:123], v[68:71], v[16:19]
  v_mfma_f32_16x16x32_bf16 v[20:23], v[124:127], v[68:71], v[20:23]
  v_mfma_f32_16x16x32_bf16 v[24:27], v[128:131], v[68:71], v[24:27]
  v_mfma_f32_16x16x32_bf16 v[28:31], v[132:135], v[68:71], v[28:31]
  v_mfma_f32_16x16x32_bf16 v[12:15], v[136:139], v[72:75], v[12:15]
  buffer_load_dwordx4 v[68:71], v2, s[4:7], s29 offen offset:3072 sc1
  v_mfma_f32_16x16x32_bf16 v[16:19], v[140:143], v[72:75], v[16:19]
  v_mfma_f32_16x16x32_bf16 v[20:23], v[144:147], v[72:75], v[20:23]
  v_mfma_f32_16x16x32_bf16 v[24:27], v[148:151], v[72:75], v[24:27]
  v_mfma_f32_16x16x32_bf16 v[28:31], v[152:155], v[72:75], v[28:31]
  v_mfma_f32_16x16x32_bf16 v[12:15], v[156:159], v[76:79], v[12:15]
  buffer_load_dwordx4 v[72:75], v2, s[4:7], s38 offen offset:1024 sc1
  v_mfma_f32_16x16x32_bf16 v[16:19], v[160:163], v[76:79], v[16:19]
  v_mfma_f32_16x16x32_bf16 v[20:23], v[164:167], v[76:79], v[20:23]
  v_mfma_f32_16x16x32_bf16 v[24:27], v[168:171], v[76:79], v[24:27]
  v_mfma_f32_16x16x32_bf16 v[28:31], v[172:175], v[76:79], v[28:31]
  v_mfma_f32_16x16x32_bf16 v[12:15], v[176:179], v[80:83], v[12:15]
  buffer_load_dwordx4 v[76:79], v2, s[4:7], s38 offen offset:3072 sc1
  v_mfma_f32_16x16x32_bf16 v[16:19], v[180:183], v[80:83], v[16:19]
  v_mfma_f32_16x16x32_bf16 v[20:23], v[184:187], v[80:83], v[20:23]
  v_mfma_f32_16x16x32_bf16 v[24:27], v[188:191], v[80:83], v[24:27]
  v_mfma_f32_16x16x32_bf16 v[28:31], v[192:195], v[80:83], v[28:31]
  v_mfma_f32_16x16x32_bf16 v[12:15], v[196:199], v[84:87], v[12:15]
  buffer_load_dwordx4 v[80:83], v2, s[4:7], s39 offen offset:1024 sc1
  v_mfma_f32_16x16x32_bf16 v[16:19], v[200:203], v[84:87], v[16:19]
  v_mfma_f32_16x16x32_bf16 v[20:23], v[204:207], v[84:87], v[20:23]
  v_mfma_f32_16x16x32_bf16 v[24:27], v[208:211], v[84:87], v[24:27]
  v_mfma_f32_16x16x32_bf16 v[28:31], v[212:215], v[84:87], v[28:31]
  v_mfma_f32_16x16x32_bf16 v[12:15], v[216:219], v[88:91], v[12:15]
  buffer_load_dwordx4 v[84:87], v2, s[4:7], s39 offen offset:3072 sc1
  v_mfma_f32_16x16x32_bf16 v[16:19], v[220:223], v[88:91], v[16:19]
  v_mfma_f32_16x16x32_bf16 v[20:23], v[224:227], v[88:91], v[20:23]
  v_mfma_f32_16x16x32_bf16 v[24:27], v[228:231], v[88:91], v[24:27]
  v_mfma_f32_16x16x32_bf16 v[28:31], v[232:235], v[88:91], v[28:31]
  buffer_load_dwordx4 v[88:91], v2, s[4:7], s40 offen offset:1024 sc1
  s_add_u32 s29, s29, 491520
Lfz_103:
  s_nop 2
  ds_write_b128 v6, v[12:15] offset:5120
  ds_write_b128 v6, v[16:19] offset:6144
  ds_write_b128 v6, v[20:23] offset:7168
  ds_write_b128 v6, v[24:27] offset:8192
  ds_write_b128 v6, v[28:31] offset:9216
  v_add_u32 v6, s33, v6
  s_sub_u32 s33, 0, s33
  s_add_u32 s22, s22, 1
  s_waitcnt lgkmcnt(0)
  s_barrier
  s_branch Lf_91
Lw_fhalf:
  s_setprio 0
  v_and_b32 v8, 6, v1
  v_cmp_eq_u32 s[42:43], 6, v8
Lp_105:
  buffer_load_dword v9, v3, s[4:7], 0 offen sc1
  s_waitcnt vmcnt(0)
  v_cmp_gt_u32 vcc, 64, v9
  s_and_b64 vcc, vcc, s[42:43]
  s_cbranch_scc0 Lpd_106
  s_sleep 2
  s_sub_u32 s24, s24, 1
  s_cbranch_scc0 Lp_105
  s_branch Lw_fail
Lpd_106:
  s_lshl_b32 s38, s16, 3
  s_add_u32 s38, s38, s20
  s_lshl_b32 s38, s38, 1
  s_add_u32 s38, s38, s23
  s_lshl_b32 s38, s38, 7
  s_add_u32 s30, s38, 1853440
  s_lshl_b32 s38, s18, 2
  s_add_u32 s38, s38, s16
  s_lshl_b32 s38, s38, 2
  s_add_u32 s38, s38, s23
  s_lshl_b32 s38, s38, 5
  s_add_u32 s38, s38, s20
  s_lshl_b32 s38, s38, 2
  s_add_u32 s38, s38, 1863200
  v_mov_b32 v4, 0x40000000
  v_writelane_b32 v4, s38, 0
  s_mul_i32 s38, s20, 40
  v_add_u32 v9, s38, v1
  v_lshlrev_b32 v7, 4, v9
  v_bfe_u32 v5, v9, 4, 2
  v_lshlrev_b32 v5, 6, v5
  v_bfe_u32 v8, v9, 0, 3
  v_lshl_add_u32 v5, v8, 3, v5
  v_bfe_u32 v8, v9, 6, 3
  v_lshl_add_u32 v5, v8, 8, v5
  v_bfe_u32 v8, v9, 3, 1
  v_mul_u32_u24 v8, 40960, v8
  v_add_u32 v5, v5, v8
  s_mul_i32 s26, s18, 5120
  s_mul_i32 s39, s16, 1280
  s_add_u32 s26, s26, s39
  s_mul_i32 s39, s23, 81920
  s_add_u32 s26, s26, s39
  s_add_u32 s26, s26, 106823680
  s_mul_i32 s38, s20, 5120
  v_add_u32 v6, s38, v2
  s_mul_i32 s29, s16, 122880
  s_lshl_b32 s38, s25, 11
  s_add_u32 s29, s29, s38
  s_lshl_b32 s38, s23, 10
  s_add_u32 s29, s29, s38
  s_add_u32 s29, s29, 89784320
  s_mov_b32 s22, 44
  s_mov_b32 s42, -1
  s_mov_b32 s43, 255
  v_mov_b32 v64, -1
  v_mov_b32 v65, -1
  s_mov_b64 exec, s[42:43]
  s_add_u32 s38, s26, 2457600
  buffer_store_dwordx2 v[64:65], v5, s[4:7], s38 offen sc1
  s_add_u32 s38, s26, 2621440
  buffer_store_dwordx2 v[64:65], v5, s[4:7], s38 offen sc1
  s_add_u32 s38, s26, 2785280
  buffer_store_dwordx2 v[64:65], v5, s[4:7], s38 offen sc1
  s_add_u32 s38, s26, 2949120
  buffer_store_dwordx2 v[64:65], v5, s[4:7], s38 offen sc1
  s_add_u32 s38, s26, 3112960
  buffer_store_dwordx2 v[64:65], v5, s[4:7], s38 offen sc1
  s_mov_b64 exec, -1
  s_barrier
  s_add_u32 s38, s29, 4096
  s_add_u32 s39, s29, 8192
  s_add_u32 s40, s29, s19
  s_add_u32 s31, s39, 3056
  s_cmp_ge_u32 s22, 59
  s_cselect_b32 s31, s31, s30
  s_cselect_b32 s33, -1, 0
  s_cselect_b32 s34, 0, s22
  s_cmp_eq_u32 s22, 64
  s_cselect_b32 s34, -1, s34
  buffer_load_dword v9, off, s[4:7], s31 sc1
  buffer_load_dwordx4 v[56:59], v2, s[4:7], s40 offen offset:0 sc1
  buffer_load_dwordx4 v[60:63], v2, s[4:7], s40 offen offset:2048 sc1
  s_branch Lw_fhp
Lw_fhl:
  s_mov_b64 exec, s[42:43]
  s_waitcnt lgkmcnt(6)
  v_add_f32 v64, v64, v68
  v_add_f32 v65, v65, v69
  v_add_f32 v66, v66, v70
  v_add_f32 v67, v67, v71
  s_waitcnt lgkmcnt(4)
  v_add_f32 v72, v72, v76
  v_add_f32 v73, v73, v77
  v_add_f32 v74, v74, v78
  v_add_f32 v75, v75, v79
  s_waitcnt lgkmcnt(2)
  v_add_f32 v80, v80, v84
  v_add_f32 v81, v81, v85
  v_add_f32 v82, v82, v86
  v_add_f32 v83, v83, v87
  s_waitcnt lgkmcnt(0)
  v_add_f32 v88, v88, v92
  v_add_f32 v89, v89, v93
  v_add_f32 v90, v90, v94
  v_add_f32 v91, v91, v95
  v_add_f32 v64, v64, v72
  v_add_f32 v65, v65, v73
  v_add_f32 v66, v66, v74
  v_add_f32 v67, v67, v75
  v_add_f32 v80, v80, v88
  v_add_f32 v81, v81, v89
  v_add_f32 v82, v82, v90
  v_add_f32 v83, v83, v91
  v_add_f32 v64, v64, v80
  v_add_f32 v65, v65, v81
  v_add_f32 v66, v66, v82
  v_add_f32 v67, v67, v83
  v_cvt_pk_bf16_f32 v64, v64, v65
  v_cvt_pk_bf16_f32 v65, v66, v67
  buffer_store_dwordx2 v[64:65], v5, s[4:7], s26 offen sc1
  s_mov_b64 exec, -1
  v_xor_b32 v7, 0x10000, v7
  v_mov_b32 v10, s22
  s_add_u32 s26, s26, 163840
  buffer_load_dword v9, off, s[4:7], s31 sc1
  s_cmp_eq_u32 s22, 64
  s_waitcnt vmcnt(0)
  buffer_store_dword v10, v4, s[4:7], 0 offen sc1
  s_cbranch_scc1 Lw_end
  v_subrev_u32 v11, s33, v9
  v_cmp_ge_u32 vcc, s34, v11
  s_cbranch_vccz Lw_fhg
Lw_fhp:
Lp_107:
  buffer_load_dword v9, off, s[4:7], s31 sc1
  s_waitcnt vmcnt(0)
  v_subrev_u32 v11, s33, v9
  v_cmp_ge_u32 vcc, s34, v11
  s_cbranch_vccz Lpd_108
  s_sleep 3
  s_sub_u32 s24, s24, 1
  s_cbranch_scc0 Lp_107
  s_branch Lw_fail
Lpd_108:
Lw_fhg:
  buffer_load_dwordx4 v[32:35], v2, s[4:7], s29 offen offset:0 sc1
  buffer_load_dwordx4 v[36:39], v2, s[4:7], s29 offen offset:2048 sc1
  buffer_load_dwordx4 v[40:43], v2, s[4:7], s38 offen offset:0 sc1
  buffer_load_dwordx4 v[44:47], v2, s[4:7], s38 offen offset:2048 sc1
  buffer_load_dwordx4 v[48:51], v2, s[4:7], s39 offen offset:0 sc1
  buffer_load_dwordx4 v[52:55], v2, s[4:7], s39 offen offset:2048 sc1
  v_mfma_f32_16x16x32_bf16 v[12:15], v[216:219], v[56:59], 0
  v_mfma_f32_16x16x32_bf16 v[16:19], v[220:223], v[56:59], 0
  v_mfma_f32_16x16x32_bf16 v[20:23], v[224:227], v[56:59], 0
  v_mfma_f32_16x16x32_bf16 v[24:27], v[228:231], v[56:59], 0
  v_mfma_f32_16x16x32_bf16 v[28:31], v[232:235], v[56:59], 0
  s_cmp_lt_u32 s20, 4
  s_cbranch_scc0 Lh7_109
  v_mfma_f32_16x16x32_bf16 v[12:15], v[236:239], v[60:63], v[12:15]
  v_mfma_f32_16x16x32_bf16 v[16:19], v[240:243], v[60:63], v[16:19]
  v_mfma_f32_16x16x32_bf16 v[20:23], v[244:247], v[60:63], v[20:23]
  v_mfma_f32_16x16x32_bf16 v[24:27], v[248:251], v[60:63], v[24:27]
  v_mfma_f32_16x16x32_bf16 v[28:31], v[252:255], v[60:63], v[28:31]
Lh7_109:
  s_waitcnt vmcnt(5)
  v_mfma_f32_16x16x32_bf16 v[12:15], v[96:99], v[32:35], v[12:15]
  v_mfma_f32_16x16x32_bf16 v[16:19], v[100:103], v[32:35], v[16:19]
  v_mfma_f32_16x16x32_bf16 v[20:23], v[104:107], v[32:35], v[20:23]
  v_mfma_f32_16x16x32_bf16 v[24:27], v[108:111], v[32:35], v[24:27]
  v_mfma_f32_16x16x32_bf16 v[28:31], v[112:115], v[32:35], v[28:31]
  s_waitcnt vmcnt(4)
  v_mfma_f32_16x16x32_bf16 v[12:15], v[116:119], v[36:39], v[12:15]
  v_mfma_f32_16x16x32_bf16 v[16:19], v[120:123], v[36:39], v[16:19]
  v_mfma_f32_16x16x32_bf16 v[20:23], v[124:127], v[36:39], v[20:23]
  v_mfma_f32_16x16x32_bf16 v[24:27], v[128:131], v[36:39], v[24:27]
  v_mfma_f32_16x16x32_bf16 v[28:31], v[132:135], v[36:39], v[28:31]
  s_waitcnt vmcnt(3)
  v_mfma_f32_16x16x32_bf16 v[12:15], v[136:139], v[40:43], v[12:15]
  v_mfma_f32_16x16x32_bf16 v[16:19], v[140:143], v[40:43], v[16:19]
  v_mfma_f32_16x16x32_bf16 v[20:23], v[144:147], v[40:43], v[20:23]
  v_mfma_f32_16x16x32_bf16 v[24:27], v[148:151], v[40:43], v[24:27]
  v_mfma_f32_16x16x32_bf16 v[28:31], v[152:155], v[40:43], v[28:31]
  s_waitcnt vmcnt(2)
  v_mfma_f32_16x16x32_bf16 v[12:15], v[156:159], v[44:47], v[12:15]
  v_mfma_f32_16x16x32_bf16 v[16:19], v[160:163], v[44:47], v[16:19]
  v_mfma_f32_16x16x32_bf16 v[20:23], v[164:167], v[44:47], v[20:23]
  v_mfma_f32_16x16x32_bf16 v[24:27], v[168:171], v[44:47], v[24:27]
  v_mfma_f32_16x16x32_bf16 v[28:31], v[172:175], v[44:47], v[28:31]
  s_waitcnt vmcnt(1)
  v_mfma_f32_16x16x32_bf16 v[12:15], v[176:179], v[48:51], v[12:15]
  v_mfma_f32_16x16x32_bf16 v[16:19], v[180:183], v[48:51], v[16:19]
  v_mfma_f32_16x16x32_bf16 v[20:23], v[184:187], v[48:51], v[20:23]
  v_mfma_f32_16x16x32_bf16 v[24:27], v[188:191], v[48:51], v[24:27]
  v_mfma_f32_16x16x32_bf16 v[28:31], v[192:195], v[48:51], v[28:31]
  s_waitcnt vmcnt(0)
  v_mfma_f32_16x16x32_bf16 v[12:15], v[196:199], v[52:55], v[12:15]
  v_mfma_f32_16x16x32_bf16 v[16:19], v[200:203], v[52:55], v[16:19]
  v_mfma_f32_16x16x32_bf16 v[20:23], v[204:207], v[52:55], v[20:23]
  v_mfma_f32_16x16x32_bf16 v[24:27], v[208:211], v[52:55], v[24:27]
  v_mfma_f32_16x16x32_bf16 v[28:31], v[212:215], v[52:55], v[28:31]
Lw_fhm:
  v_max3_u32 v11, v32, v36, v40
  v_max3_u32 v11, v11, v44, v48
  v_max3_u32 v11, v11, v52, v52
  v_cmp_eq_u32 vcc, -1, v11
  s_cbranch_vccz Lrd_110
  s_sub_u32 s24, s24, 1
  s_cbranch_scc0 Lw_fhg
  s_branch Lw_fail
Lrd_110:
Lw_fhn:
  s_add_u32 s29, s29, 491520
  s_add_u32 s22, s22, 1
  s_add_u32 s38, s29, 4096
  s_add_u32 s39, s29, 8192
  s_add_u32 s40, s29, s19
  s_add_u32 s31, s39, 3056
  s_cmp_ge_u32 s22, 59
  s_cselect_b32 s31, s31, s30
  s_cselect_b32 s33, -1, 0
  s_cselect_b32 s34, 0, s22
  s_cmp_eq_u32 s22, 64
  s_cselect_b32 s34, -1, s34
  buffer_load_dword v9, off, s[4:7], s31 sc1
  buffer_load_dwordx4 v[56:59], v2, s[4:7], s40 offen offset:0 sc1
  buffer_load_dwordx4 v[60:63], v2, s[4:7], s40 offen offset:2048 sc1
  ds_write_b128 v6, v[12:15] offset:0
  ds_write_b128 v6, v[16:19] offset:1024
  ds_write_b128 v6, v[20:23] offset:2048
  ds_write_b128 v6, v[24:27] offset:3072
  ds_write_b128 v6, v[28:31] offset:4096
  v_xor_b32 v6, 0x10000, v6
  s_waitcnt lgkmcnt(0)
  s_barrier
  s_mov_b64 exec, s[42:43]
  ds_read_b128 v[64:67], v7 offset:0
  ds_read_b128 v[68:71], v7 offset:5120
  ds_read_b128 v[72:75], v7 offset:10240
  ds_read_b128 v[76:79], v7 offset:15360
  ds_read_b128 v[80:83], v7 offset:20480
  ds_read_b128 v[84:87], v7 offset:25600
  ds_read_b128 v[88:91], v7 offset:30720
  ds_read_b128 v[92:95], v7 offset:35840
  s_mov_b64 exec, -1
  s_cmp_ge_u32 s22, 64
  s_cbranch_scc1 Lw_fhl
  s_waitcnt vmcnt(2)
  v_subrev_u32 v11, s33, v9
  v_cmp_ge_u32 vcc, s34, v11
  s_cbranch_vccnz Lw_fhl
  buffer_load_dwordx4 v[32:35], v2, s[4:7], s29 offen offset:0 sc1
  buffer_load_dwordx4 v[36:39], v2, s[4:7], s29 offen offset:2048 sc1
  buffer_load_dwordx4 v[40:43], v2, s[4:7], s38 offen offset:0 sc1
  buffer_load_dwordx4 v[44:47], v2, s[4:7], s38 offen offset:2048 sc1
  buffer_load_dwordx4 v[48:51], v2, s[4:7], s39 offen offset:0 sc1
  buffer_load_dwordx4 v[52:55], v2, s[4:7], s39 offen offset:2048 sc1
  s_mov_b64 exec, s[42:43]
  s_waitcnt lgkmcnt(6)
  v_add_f32 v64, v64, v68
  v_add_f32 v65, v65, v69
  v_add_f32 v66, v66, v70
  v_add_f32 v67, v67, v71
  s_waitcnt lgkmcnt(4)
  v_add_f32 v72, v72, v76
  v_add_f32 v73, v73, v77
  v_add_f32 v74, v74, v78
  v_add_f32 v75, v75, v79
  s_waitcnt lgkmcnt(2)
  v_add_f32 v80, v80, v84
  v_add_f32 v81, v81, v85
  v_add_f32 v82, v82, v86
  v_add_f32 v83, v83, v87
  s_waitcnt lgkmcnt(0)
  v_add_f32 v88, v88, v92
  v_add_f32 v89, v89, v93
  v_add_f32 v90, v90, v94
  v_add_f32 v91, v91, v95
  v_add_f32 v64, v64, v72
  v_add_f32 v65, v65, v73
  v_add_f32 v66, v66, v74
  v_add_f32 v67, v67, v75
  v_add_f32 v80, v80, v88
  v_add_f32 v81, v81, v89
  v_add_f32 v82, v82, v90
  v_add_f32 v83, v83, v91
  v_add_f32 v64, v64, v80
  v_add_f32 v65, v65, v81
  v_add_f32 v66, v66, v82
  v_add_f32 v67, v67, v83
  v_cvt_pk_bf16_f32 v64, v64, v65
  v_cvt_pk_bf16_f32 v65, v66, v67
  buffer_store_dwordx2 v[64:65], v5, s[4:7], s26 offen sc1
  s_mov_b64 exec, -1
  v_xor_b32 v7, 0x10000, v7
  v_mov_b32 v10, s22
  s_add_u32 s26, s26, 163840
  s_waitcnt vmcnt(7)
  v_mfma_f32_16x16x32_bf16 v[12:15], v[216:219], v[56:59], 0
  v_mfma_f32_16x16x32_bf16 v[16:19], v[220:223], v[56:59], 0
  v_mfma_f32_16x16x32_bf16 v[20:23], v[224:227], v[56:59], 0
  v_mfma_f32_16x16x32_bf16 v[24:27], v[228:231], v[56:59], 0
  v_mfma_f32_16x16x32_bf16 v[28:31], v[232:235], v[56:59], 0
  s_cmp_lt_u32 s20, 4
  s_cbranch_scc0 Lh7_111
  v_mfma_f32_16x16x32_bf16 v[12:15], v[236:239], v[60:63], v[12:15]
  v_mfma_f32_16x16x32_bf16 v[16:19], v[240:243], v[60:63], v[16:19]
  v_mfma_f32_16x16x32_bf16 v[20:23], v[244:247], v[60:63], v[20:23]
  v_mfma_f32_16x16x32_bf16 v[24:27], v[248:251], v[60:63], v[24:27]
  v_mfma_f32_16x16x32_bf16 v[28:31], v[252:255], v[60:63], v[28:31]
Lh7_111:
  s_waitcnt vmcnt(6)
  v_mfma_f32_16x16x32_bf16 v[12:15], v[96:99], v[32:35], v[12:15]
  v_mfma_f32_16x16x32_bf16 v[16:19], v[100:103], v[32:35], v[16:19]
  v_mfma_f32_16x16x32_bf16 v[20:23], v[104:107], v[32:35], v[20:23]
  v_mfma_f32_16x16x32_bf16 v[24:27], v[108:111], v[32:35], v[24:27]
  v_mfma_f32_16x16x32_bf16 v[28:31], v[112:115], v[32:35], v[28:31]
  s_waitcnt vmcnt(5)
  v_mfma_f32_16x16x32_bf16 v[12:15], v[116:119], v[36:39], v[12:15]
  v_mfma_f32_16x16x32_bf16 v[16:19], v[120:123], v[36:39], v[16:19]
  v_mfma_f32_16x16x32_bf16 v[20:23], v[124:127], v[36:39], v[20:23]
  v_mfma_f32_16x16x32_bf16 v[24:27], v[128:131], v[36:39], v[24:27]
  v_mfma_f32_16x16x32_bf16 v[28:31], v[132:135], v[36:39], v[28:31]
  s_waitcnt vmcnt(4)
  v_mfma_f32_16x16x32_bf16 v[12:15], v[136:139], v[40:43], v[12:15]
  v_mfma_f32_16x16x32_bf16 v[16:19], v[140:143], v[40:43], v[16:19]
  v_mfma_f32_16x16x32_bf16 v[20:23], v[144:147], v[40:43], v[20:23]
  v_mfma_f32_16x16x32_bf16 v[24:27], v[148:151], v[40:43], v[24:27]
  v_mfma_f32_16x16x32_bf16 v[28:31], v[152:155], v[40:43], v[28:31]
  s_waitcnt vmcnt(3)
  v_mfma_f32_16x16x32_bf16 v[12:15], v[156:159], v[44:47], v[12:15]
  v_mfma_f32_16x16x32_bf16 v[16:19], v[160:163], v[44:47], v[16:19]
  v_mfma_f32_16x16x32_bf16 v[20:23], v[164:167], v[44:47], v[20:23]
  v_mfma_f32_16x16x32_bf16 v[24:27], v[168:171], v[44:47], v[24:27]
  v_mfma_f32_16x16x32_bf16 v[28:31], v[172:175], v[44:47], v[28:31]
  s_waitcnt vmcnt(2)
  v_mfma_f32_16x16x32_bf16 v[12:15], v[176:179], v[48:51], v[12:15]
  v_mfma_f32_16x16x32_bf16 v[16:19], v[180:183], v[48:51], v[16:19]
  v_mfma_f32_16x16x32_bf16 v[20:23], v[184:187], v[48:51], v[20:23]
  v_mfma_f32_16x16x32_bf16 v[24:27], v[188:191], v[48:51], v[24:27]
  v_mfma_f32_16x16x32_bf16 v[28:31], v[192:195], v[48:51], v[28:31]
  s_waitcnt vmcnt(1)
  v_mfma_f32_16x16x32_bf16 v[12:15], v[196:199], v[52:55], v[12:15]
  v_mfma_f32_16x16x32_bf16 v[16:19], v[200:203], v[52:55], v[16:19]
  v_mfma_f32_16x16x32_bf16 v[20:23], v[204:207], v[52:55], v[20:23]
  v_mfma_f32_16x16x32_bf16 v[24:27], v[208:211], v[52:55], v[24:27]
  v_mfma_f32_16x16x32_bf16 v[28:31], v[212:215], v[52:55], v[28:31]
  s_waitcnt vmcnt(0)
  buffer_store_dword v10, v4, s[4:7], 0 offen sc1
  s_branch Lw_fhm
Lw_fail:
  s_mov_b32 s24, -1
Lw_end:
  s_waitcnt vmcnt(0)
  s_endpgm
Lexit:
  s_waitcnt vmcnt(0)
  s_endpgm
Lpre:
  s_mov_b32 s18, 0
  s_cmp_eq_u32 s20, 0
  s_cbranch_scc0 Lpend
  s_mov_b64 exec, 1
  v_mov_b32 v1, 1
  s_lshl_b32 s38, s16, 2
  v_mov_b32 v2, s38
  s_cmp_lt_u32 s17, 26
  s_cbranch_scc0 Lpdec
  buffer_atomic_add v1, v2, s[80:83], 0 offen offset:208
  s_sub_u32 s39, 0, s4
  s_and_b32 s39, s39, 0x1fffff
  s_lshl_b32 s40, s16, 1
  s_add_u32 s40, s40, s17
  s_lshl_b32 s40, s40, 13
  s_add_u32 s39, s39, s40
  s_add_u32 s39, s39, 123011072
  buffer_store_dword v1, off, s[4:7], s39 offset:4032 sc1
  s_mov_b32 s40, 64
Lpsync:
  buffer_load_dword v5, v2, s[80:83], 0 offen offset:208 sc1
  s_sub_u32 s40, s40, 1
  s_cbranch_scc1 Lpend
  s_waitcnt vmcnt(0)
  v_cmp_gt_u32 vcc, 2, v5
  s_cbranch_vccnz Lpsync
  s_mov_b32 s40, 11
Lprace:
  buffer_store_dword v1, off, s[4:7], s39 sc1
  s_add_u32 s39, s39, 256
  s_sub_u32 s40, s40, 1
  s_waitcnt vmcnt(0)
  s_cbranch_scc0 Lprace
  buffer_atomic_add v1, v2, s[80:83], 0 offen offset:224 sc0
  s_cmp_eq_u32 s16, 0
  s_cselect_b32 s39, 3, 2
  s_sub_u32 s40, 0, s39
  s_cmp_eq_u32 s17, 25
  s_cselect_b32 s39, s39, s40
  s_add_u32 s39, s39, 64
  v_mov_b32 v5, s39
  s_waitcnt vmcnt(0)
  v_cmp_eq_u32 vcc, 0, v1
  s_cbranch_vccz Lpend
  buffer_atomic_add v5, off, s[80:83], 0 offset:192
  s_branch Lpend
Lpdec:
  s_lshl_b32 s39, s16, 8
  s_add_u32 s39, s39, s17
  s_cmp_eq_u32 s39, 26
  s_cbranch_scc0 Lpend
  s_mov_b32 s40, 60
Lpdp:
  s_sleep 4
  buffer_load_dword v5, off, s[80:83], 0 offset:192 sc1
  buffer_load_dword v6, off, s[80:83], 0 sc1
  s_waitcnt vmcnt(0)
  v_readfirstlane_b32 s38, v5
  s_bfe_i32 s39, s38, 0x60000
  s_sub_u32 s40, s40, 1
  s_cbranch_scc1 Lpdd
  s_cmp_ge_u32 s38, 224
  s_cbranch_scc1 Lpdd
  s_abs_i32 s38, s39
  s_cmp_lt_u32 s38, 5
  s_cbranch_scc1 Lpdp
Lpdd:
  s_cmp_gt_i32 s39, 0
  s_cselect_b32 s18, 257, 1
  s_mov_b64 exec, -1
  v_readfirstlane_b32 s38, v6
  s_nop 1
  v_mov_b32 v10, s38
  s_branch Lpen2
Lpend:
  s_waitcnt vmcnt(0)
  s_mov_b64 exec, -1
  v_mov_b32 v10, 0
Lpen2:
  v_mov_b32 v11, 0
  s_cmp_eq_u32 s20, 0
  s_cbranch_scc0 Lcx_114
  s_mov_b32 s39, 200000
  s_branch Lcq_113
Lcr_112:
  s_sleep 64
  buffer_load_dword v10, off, s[80:83], 0 sc1
  s_waitcnt vmcnt(0)
Lcq_113:
  s_sub_u32 s39, s39, 1
  s_cbranch_scc1 Lcd_115
  v_cmp_eq_u32 vcc, 0, v10
  s_cbranch_vccnz Lcr_112
Lcd_115:
  ds_write_b32 v11, v10
  s_waitcnt lgkmcnt(0)
Lcx_114:
  s_barrier
  ds_read_b32 v10, v11
  s_waitcnt lgkmcnt(0)
  v_readfirstlane_b32 s38, v10
  s_sub_u32 s38, s38, 1
  s_cmp_eq_u32 s38, s46
  s_cbranch_scc0 Lrestart
  s_cmp_eq_u32 s20, 0
  s_cbranch_scc0 Lexit
  s_cmp_eq_u32 s18, 0
  s_cbranch_scc1 Lpnd
  v_mov_b32 v5, s18
  s_mov_b64 exec, 1
  buffer_atomic_add v5, off, s[80:83], 0 offset:64
  s_mov_b64 exec, -1
Lpnd:
  s_mov_b32 s24, 200000
  s_sub_u32 s17, s17, 24
  s_mul_i32 s38, s17, 3
  s_mul_i32 s39, s16, 24
  s_add_u32 s39, s39, s38
  s_lshl_b32 s28, s39, 13
  s_add_u32 s28, s28, 18612224
  s_lshl_b32 s39, s39, 7
  s_add_u32 s39, s39, 1880064
  v_mov_b32 v4, s39
  s_add_u32 s39, s38, 2
  s_lshr_b32 s38, s38, 2
  s_lshr_b32 s39, s39, 2
  s_mul_i32 s40, s16, 12
  s_add_u32 s38, s38, s40
  s_add_u32 s39, s39, s40
  s_lshl_b32 s38, s38, 7
  s_lshl_b32 s39, s39, 7
  s_add_u32 s38, s38, 1835008
  s_add_u32 s39, s39, 1835008
  v_writelane_b32 v4, s38, 0
  v_writelane_b32 v4, s39, 1
  s_add_u32 s38, s38, 768
  s_add_u32 s39, s39, 768
  v_writelane_b32 v4, s38, 2
  v_writelane_b32 v4, s39, 3
  v_cmp_gt_u32 vcc, 4, v0
  s_nop 1
  v_cndmask_b32 v5, -1, 2, vcc
  v_lshlrev_b32 v2, 4, v0
  s_mov_b32 s22, 1
Lpre_ln:
  buffer_load_ubyte v8, off, s[80:83], 0 offset:128 sc1
  s_sub_u32 s24, s24, 1
  s_cbranch_scc1 Lpre_end
  s_sleep 16
  s_waitcnt vmcnt(0)
  v_cmp_gt_u32 vcc, 36, v8
  s_cbranch_vccnz Lpre_ln
Lpre_p:
  buffer_load_dword v8, v4, s[4:7], 0 offen sc1
  s_sub_u32 s24, s24, 1
  s_cbranch_scc1 Lpre_end
  s_waitcnt vmcnt(0)
  v_cmp_gt_i32 vcc, v5, v8
  s_cbranch_vccnz Lpre_p
  s_add_u32 s38, s28, 0
  buffer_load_dwordx4 v[16:19], v2, s[4:7], s38 offen offset:0 sc1
  buffer_load_dwordx4 v[20:23], v2, s[4:7], s38 offen offset:1024 sc1
  buffer_load_dwordx4 v[24:27], v2, s[4:7], s38 offen offset:2048 sc1
  buffer_load_dwordx4 v[28:31], v2, s[4:7], s38 offen offset:3072 sc1
  s_add_u32 s38, s28, 4096
  buffer_load_dwordx4 v[32:35], v2, s[4:7], s38 offen offset:0 sc1
  buffer_load_dwordx4 v[36:39], v2, s[4:7], s38 offen offset:1024 sc1
  buffer_load_dwordx4 v[40:43], v2, s[4:7], s38 offen offset:2048 sc1
  buffer_load_dwordx4 v[44:47], v2, s[4:7], s38 offen offset:3072 sc1
  s_add_u32 s38, s28, 8192
  buffer_load_dwordx4 v[48:51], v2, s[4:7], s38 offen offset:0 sc1
  buffer_load_dwordx4 v[52:55], v2, s[4:7], s38 offen offset:1024 sc1
  buffer_load_dwordx4 v[56:59], v2, s[4:7], s38 offen offset:2048 sc1
  buffer_load_dwordx4 v[60:63], v2, s[4:7], s38 offen offset:3072 sc1
  s_add_u32 s38, s28, 12288
  buffer_load_dwordx4 v[64:67], v2, s[4:7], s38 offen offset:0 sc1
  buffer_load_dwordx4 v[68:71], v2, s[4:7], s38 offen offset:1024 sc1
  buffer_load_dwordx4 v[72:75], v2, s[4:7], s38 offen offset:2048 sc1
  buffer_load_dwordx4 v[76:79], v2, s[4:7], s38 offen offset:3072 sc1
  s_add_u32 s38, s28, 16384
  buffer_load_dwordx4 v[80:83], v2, s[4:7], s38 offen offset:0 sc1
  buffer_load_dwordx4 v[84:87], v2, s[4:7], s38 offen offset:1024 sc1
  buffer_load_dwordx4 v[88:91], v2, s[4:7], s38 offen offset:2048 sc1
  buffer_load_dwordx4 v[92:95], v2, s[4:7], s38 offen offset:3072 sc1
  s_add_u32 s38, s28, 20480
  buffer_load_dwordx4 v[96:99], v2, s[4:7], s38 offen offset:0 sc1
  buffer_load_dwordx4 v[100:103], v2, s[4:7], s38 offen offset:1024 sc1
  buffer_load_dwordx4 v[104:107], v2, s[4:7], s38 offen offset:2048 sc1
  buffer_load_dwordx4 v[108:111], v2, s[4:7], s38 offen offset:3072 sc1
  v_add_u32 v5, 1, v5
  s_add_u32 s28, s28, 786432
  s_add_u32 s22, s22, 1
  s_cmp_lt_u32 s22, 63
  s_cbranch_scc1 Lpre_p
Lpre_end:
  s_waitcnt vmcnt(0)
  s_endpgm
Lrec:
  s_cmp_lt_u32 s17, 24
  s_cbranch_scc0 Lpre
  v_lshrrev_b32 v2, 6, v0
  v_and_b32 v1, 63, v0
  v_readfirstlane_b32 s20, v2
  s_and_b32 s21, s20, 3
  s_mul_i32 s38, s17, 43
  s_lshr_b32 s38, s38, 7
  s_mul_i32 s39, s38, 3
  s_sub_u32 s19, s17, s39
  s_lshl_b32 s18, s16, 3
  s_add_u32 s18, s18, s38
  s_mov_b32 s24, 200000
  s_mov_b32 s42, 0x33333333
  s_mov_b32 s43, 0x33333333
  s_mov_b32 s44, 0xcccccccc
  s_mov_b32 s45, 0xcccccccc
  s_mov_b32 s37, 0x3dd53b95
  s_mul_i32 s40, s16, 24
  s_add_u32 s41, s40, s17
  s_lshl_b32 s35, s41, 12
  s_lshl_b32 s29, s41, 11
  s_add_u32 s29, s29, 2097152
  s_lshl_b32 s28, s41, 13
  s_add_u32 s28, s28, 17825792
  s_add_u32 s40, s40, s39
  s_add_u32 s38, s19, 1
  s_cmp_eq_u32 s38, 3
  s_cselect_b32 s38, 0, s38
  s_add_u32 s33, s40, s38
  s_lshl_b32 s33, s33, 12
  s_add_u32 s38, s38, 1
  s_cmp_eq_u32 s38, 3
  s_cselect_b32 s38, 0, s38
  s_add_u32 s34, s40, s38
  s_lshl_b32 s34, s34, 12
  s_mul_i32 s38, s16, 30720
  s_add_u32 s25, s38, 1245184
  s_add_u32 s26, s25, 10240
  s_add_u32 s27, s25, 20480
  s_mov_b32 s30, 16384
  s_mov_b32 s31, 49152
  s_cmp_lt_u32 s17, 20
  s_cselect_b32 s36, 1, 0
  s_lshr_b32 s38, s17, 1
  s_lshl_b32 s38, s38, 14
  s_and_b32 s39, s17, 1
  s_lshl_b32 s39, s39, 12
  s_add_u32 s38, s38, s39
  s_sub_u32 s39, 0, s4
  s_and_b32 s39, s39, 0x1fffff
  s_add_u32 s38, s38, s39
  s_add_u32 s97, s38, 121634816
  s_mul_i32 s98, s16, 81920
  s_add_u32 s98, s98, 393216
  s_load_dwordx4 s[80:83], s[0:1], 16
  s_load_dwordx4 s[84:87], s[0:1], 32
  s_load_dwordx2 s[88:89], s[0:1], 8
  s_waitcnt lgkmcnt(0)
  s_cmp_lt_u32 s20, 4
  s_cselect_b32 s8, s80, s84
  s_cselect_b32 s9, s81, s85
  s_cselect_b32 s12, s82, s86
  s_cselect_b32 s13, s83, s87
  s_mov_b32 s10, 7864320
  s_mov_b32 s11, 0x20000
  s_mov_b32 s14, 7864320
  s_mov_b32 s15, 0x20000
  s_mov_b32 s90, 10240
  s_mov_b32 s91, 0x20000
  s_load_dwordx2 s[80:81], s[0:1], 96
  s_mov_b32 s82, 256
  s_mov_b32 s83, 0x20000
  s_mov_b32 s38, 12288
  s_mov_b32 s39, 1280
  v_lshrrev_b32 v2, 3, v1
  v_lshl_add_u32 v2, s21, 4, v2
  v_add_u32 v2, 0, v2
  v_bfe_u32 v10, v2, 1, 1
  v_bfe_u32 v9, v2, 3, 1
  v_lshl_add_u32 v10, v9, 1, v10
  v_bfe_u32 v9, v1, 1, 2
  v_xor_b32 v10, v10, v9
  v_lshlrev_b32 v10, 5, v10
  v_and_b32 v9, 1, v1
  v_lshl_add_u32 v10, v9, 4, v10
  v_bfe_u32 v11, v2, 1, 1
  v_lshlrev_b32 v11, 5, v11
  v_bfe_u32 v9, v2, 3, 1
  v_lshl_add_u32 v11, v9, 4, v11
  v_bfe_u32 v9, v2, 5, 1
  v_lshl_add_u32 v11, v9, 3, v11
  v_bfe_u32 v9, v2, 4, 1
  v_lshl_add_u32 v11, v9, 2, v11
  v_bfe_u32 v9, v2, 2, 1
  v_lshl_add_u32 v11, v9, 1, v11
  v_bfe_u32 v9, v2, 0, 1
  v_lshl_add_u32 v11, v9, 0, v11
  v_mad_u32_u24 v3, v11, s38, v10
  v_mad_u32_u24 v7, v11, s39, v10
  v_lshrrev_b32 v2, 3, v1
  v_lshl_add_u32 v2, s21, 4, v2
  v_add_u32 v2, 8, v2
  v_bfe_u32 v10, v2, 1, 1
  v_bfe_u32 v9, v2, 3, 1
  v_lshl_add_u32 v10, v9, 1, v10
  v_bfe_u32 v9, v1, 1, 2
  v_xor_b32 v10, v10, v9
  v_lshlrev_b32 v10, 5, v10
  v_and_b32 v9, 1, v1
  v_lshl_add_u32 v10, v9, 4, v10
  v_bfe_u32 v11, v2, 1, 1
  v_lshlrev_b32 v11, 5, v11
  v_bfe_u32 v9, v2, 3, 1
  v_lshl_add_u32 v11, v9, 4, v11
  v_bfe_u32 v9, v2, 5, 1
  v_lshl_add_u32 v11, v9, 3, v11
  v_bfe_u32 v9, v2, 4, 1
  v_lshl_add_u32 v11, v9, 2, v11
  v_bfe_u32 v9, v2, 2, 1
  v_lshl_add_u32 v11, v9, 1, v11
  v_bfe_u32 v9, v2, 0, 1
  v_lshl_add_u32 v11, v9, 0, v11
  v_mad_u32_u24 v4, v11, s38, v10
  v_mad_u32_u24 v8, v11, s39, v10
  s_mul_i32 s92, s18, 384
  s_lshl_b32 s38, s19, 7
  s_add_u32 s92, s92, s38
  s_mul_i32 s93, s19, 3
  s_cmp_lg_u32 s19, 0
  s_addc_u32 s93, s93, 0
  s_lshr_b32 s38, s20, 2
  s_lshl_b32 s38, s38, 16
  s_add_u32 s95, s38, 32768
  s_lshl_b32 s39, s21, 11
  s_add_u32 s94, s95, s39
  v_bfe_u32 v12, v1, 4, 2
  v_lshlrev_b32 v12, 10, v12
  v_bfe_u32 v9, v1, 2, 2
  v_lshl_add_u32 v12, v9, 7, v12
  v_bfe_u32 v9, v1, 0, 2
  v_lshl_add_u32 v12, v9, 3, v12
  v_bfe_u32 v9, v1, 3, 2
  v_lshl_add_u32 v12, v9, 5, v12
  v_add_u32 v12, s95, v12
  s_lshl_b32 s38, s21, 5
  v_xor_b32 v16, s38, v12
  s_lshl_b32 s38, s21, 13
  v_add_u32 v12, s38, v12
  v_xor_b32 v13, 32, v12
  v_xor_b32 v14, 64, v12
  v_xor_b32 v15, 96, v12
  v_bfe_u32 v17, v0, 2, 2
  v_lshlrev_b32 v17, 1, v17
  v_bfe_u32 v9, v0, 0, 1
  v_lshl_add_u32 v17, v9, 0, v17
  v_mul_u32_u24 v17, 1280, v17
  v_bfe_u32 v9, v0, 6, 3
  v_lshl_add_u32 v17, v9, 7, v17
  v_bfe_u32 v9, v0, 1, 1
  v_lshl_add_u32 v17, v9, 6, v17
  v_bfe_u32 v9, v0, 4, 2
  v_lshl_add_u32 v17, v9, 3, v17
  v_lshlrev_b32 v18, 4, v0
  s_cmp_lt_u32 s20, 4
  s_cbranch_scc0 Lrec_sv
  s_add_u32 s38, s92, 0
  s_add_u32 m0, s94, 0
  s_nop 0
  buffer_load_dwordx4 v3, s[12:15], s38 offen lds
  s_add_u32 m0, s94, 1024
  s_nop 0
  buffer_load_dwordx4 v4, s[12:15], s38 offen lds
  s_add_u32 s38, s92, 786432
  s_add_u32 m0, s94, 8192
  s_nop 0
  buffer_load_dwordx4 v3, s[12:15], s38 offen lds
  s_add_u32 m0, s94, 9216
  s_nop 0
  buffer_load_dwordx4 v4, s[12:15], s38 offen lds
  s_add_u32 s38, s92, 1572864
  s_add_u32 m0, s94, 16384
  s_nop 0
  buffer_load_dwordx4 v3, s[12:15], s38 offen lds
  s_add_u32 m0, s94, 17408
  s_nop 0
  buffer_load_dwordx4 v4, s[12:15], s38 offen lds
  s_add_u32 s38, s92, 2359296
  s_add_u32 m0, s94, 24576
  s_nop 0
  buffer_load_dwordx4 v3, s[12:15], s38 offen lds
  s_add_u32 m0, s94, 25600
  s_nop 0
  buffer_load_dwordx4 v4, s[12:15], s38 offen lds
  s_add_u32 s38, s92, 3145728
  s_add_u32 m0, s94, 32768
  s_nop 0
  buffer_load_dwordx4 v3, s[12:15], s38 offen lds
  s_add_u32 m0, s94, 33792
  s_nop 0
  buffer_load_dwordx4 v4, s[12:15], s38 offen lds
  s_add_u32 s38, s92, 3932160
  s_add_u32 m0, s94, 40960
  s_nop 0
  buffer_load_dwordx4 v3, s[12:15], s38 offen lds
  s_add_u32 m0, s94, 41984
  s_nop 0
  buffer_load_dwordx4 v4, s[12:15], s38 offen lds
  s_add_u32 s38, s92, 4718592
  s_add_u32 m0, s94, 49152
  s_nop 0
  buffer_load_dwordx4 v3, s[12:15], s38 offen lds
  s_add_u32 m0, s94, 50176
  s_nop 0
  buffer_load_dwordx4 v4, s[12:15], s38 offen lds
  s_add_u32 s38, s92, 5505024
  s_add_u32 m0, s94, 57344
  s_nop 0
  buffer_load_dwordx4 v3, s[12:15], s38 offen lds
  s_add_u32 m0, s94, 58368
  s_nop 0
  buffer_load_dwordx4 v4, s[12:15], s38 offen lds
  buffer_load_dwordx2 v[20:21], v17, s[88:91], 0 offen
  buffer_load_dwordx2 v[22:23], v17, s[88:91], 0 offen offset:32
  buffer_load_dwordx2 v[24:25], v17, s[88:91], 0 offen offset:1024
  buffer_load_dwordx2 v[26:27], v17, s[88:91], 0 offen offset:1056
  s_waitcnt vmcnt(0)
  ds_write_b128 v18, v[20:23] offset:0
  s_cmp_lt_u32 s20, 2
  s_cbranch_scc0 Lm0_116
  ds_write_b128 v18, v[24:27] offset:8192
Lm0_116:
  s_barrier
  ds_read_b64_tr_b16 v[176:177], v16 offset:0
  ds_read_b64_tr_b16 v[178:179], v16 offset:512
  ds_read_b64_tr_b16 v[180:181], v16 offset:4096
  ds_read_b64_tr_b16 v[182:183], v16 offset:4608
  ds_read_b64_tr_b16 v[184:185], v16 offset:8192
  ds_read_b64_tr_b16 v[186:187], v16 offset:8704
  ds_read_b64_tr_b16 v[188:189], v16 offset:12288
  ds_read_b64_tr_b16 v[190:191], v16 offset:12800
  ds_read_b64_tr_b16 v[192:193], v16 offset:16384
  ds_read_b64_tr_b16 v[194:195], v16 offset:16896
  ds_read_b64_tr_b16 v[196:197], v16 offset:20480
  ds_read_b64_tr_b16 v[198:199], v16 offset:20992
  ds_read_b64_tr_b16 v[200:201], v16 offset:24576
  ds_read_b64_tr_b16 v[202:203], v16 offset:25088
  ds_read_b64_tr_b16 v[204:205], v16 offset:28672
  ds_read_b64_tr_b16 v[206:207], v16 offset:29184
  s_waitcnt lgkmcnt(0)
  s_barrier
  s_cmp_eq_u32 s20, 0
  s_cbranch_scc0 Lrec_nr
  s_waitcnt lgkmcnt(0)
  buffer_load_dword v28, off, s[80:83], 0 sc1
Lrec_nr:
  s_add_u32 s38, s92, 6291456
  s_add_u32 m0, s94, 0
  s_nop 0
  buffer_load_dwordx4 v3, s[12:15], s38 offen lds
  s_add_u32 m0, s94, 1024
  s_nop 0
  buffer_load_dwordx4 v4, s[12:15], s38 offen lds
  s_add_u32 s38, s92, 7077888
  s_add_u32 m0, s94, 8192
  s_nop 0
  buffer_load_dwordx4 v3, s[12:15], s38 offen lds
  s_add_u32 m0, s94, 9216
  s_nop 0
  buffer_load_dwordx4 v4, s[12:15], s38 offen lds
  s_add_u32 s38, s92, 0
  s_add_u32 m0, s94, 16384
  s_nop 0
  buffer_load_dwordx4 v3, s[8:11], s38 offen lds
  s_add_u32 m0, s94, 17408
  s_nop 0
  buffer_load_dwordx4 v4, s[8:11], s38 offen lds
  s_add_u32 s38, s92, 786432
  s_add_u32 m0, s94, 24576
  s_nop 0
  buffer_load_dwordx4 v3, s[8:11], s38 offen lds
  s_add_u32 m0, s94, 25600
  s_nop 0
  buffer_load_dwordx4 v4, s[8:11], s38 offen lds
  s_waitcnt vmcnt(8)
  v_mov_b32 v29, 15872
  s_cmp_eq_u32 s20, 0
  s_cbranch_scc0 Lcx_119
  s_mov_b32 s39, 200000
  s_branch Lcq_118
Lcr_117:
  buffer_load_dword v28, off, s[80:83], 0 sc1
  s_waitcnt vmcnt(0)
Lcq_118:
  s_sub_u32 s39, s39, 1
  s_cbranch_scc1 Lcd_120
  v_cmp_eq_u32 vcc, 0, v28
  s_cbranch_vccnz Lcr_117
Lcd_120:
  ds_write_b32 v29, v28
  s_waitcnt lgkmcnt(0)
Lcx_119:
  s_barrier
  ds_read_b32 v28, v29
  s_waitcnt lgkmcnt(0)
  v_readfirstlane_b32 s38, v28
  s_sub_u32 s38, s38, 1
  s_cmp_eq_u32 s38, s46
  s_cbranch_scc0 Lrestart
  v_mov_b32 v28, 0
  v_mov_b32 v29, 0
  v_mov_b32 v30, 0
  v_mov_b32 v31, 0
  v_lshlrev_b32 v2, 4, v1
  s_lshl_b32 s38, s17, 12
  s_add_u32 s38, s38, s98
  s_cmp_lt_u32 s20, 4
  s_cselect_b32 s38, s35, s38
  s_cselect_b32 s39, 1, s36
  s_lshl_b32 s40, s21, 10
  s_add_u32 s38, s38, s40
  s_cmp_eq_u32 s39, 0
  s_cbranch_scc1 Lrec_z1q
  buffer_store_dwordx4 v[28:31], v2, s[4:7], s38 offen sc1
  s_cmp_eq_u32 s36, 0
  s_cbranch_scc1 Lrec_z1q
  s_cmp_lt_u32 s20, 6
  s_cbranch_scc0 Lrec_z0q
  s_mul_i32 s38, s20, 163840
  s_add_u32 s38, s38, s97
  s_lshl_b32 s39, s16, 10
  s_add_u32 s38, s38, s39
  s_add_u32 s39, s38, 8192
  s_sub_u32 s40, s20, 2
  s_cmp_lt_u32 s40, 2
  s_cselect_b32 s40, 1, 0
  v_mov_b32 v32, s40
  v_mov_b32 v33, 0
  v_mov_b32 v34, 0
  v_mov_b32 v35, 0
  buffer_store_dwordx4 v[32:35], v2, s[4:7], s38 offen sc1
  buffer_store_dwordx4 v[32:35], v2, s[4:7], s39 offen sc1
  s_branch Lrec_z1q
Lrec_z0q:
  v_mov_b32 v32, -1
  v_mov_b32 v33, -1
  v_lshlrev_b32 v2, 3, v1
  s_lshl_b32 s38, s17, 9
  s_add_u32 s38, s38, s26
  buffer_store_dwordx2 v[32:33], v2, s[4:7], s38 offen sc1
Lrec_z1q:
  s_cmp_lt_u32 s20, 5
  s_cbranch_scc0 Lrec_z2q
  v_mov_b32 v36, -1
  v_mov_b32 v37, -1
  v_mov_b32 v38, -1
  v_mov_b32 v39, -1
  v_lshlrev_b32 v2, 4, v1
  s_add_u32 s38, s20, 59
  s_mul_i32 s38, s38, 196608
  s_add_u32 s38, s38, s29
  buffer_store_dwordx4 v[36:39], v2, s[4:7], s38 offen sc1
  buffer_store_dwordx4 v[36:39], v2, s[4:7], s38 offen offset:1024 sc1
Lrec_z2q:
  ds_read_b64_tr_b16 v[208:209], v16 offset:32768
  ds_read_b64_tr_b16 v[210:211], v16 offset:33280
  ds_read_b64_tr_b16 v[212:213], v16 offset:36864
  ds_read_b64_tr_b16 v[214:215], v16 offset:37376
  ds_read_b64_tr_b16 v[216:217], v16 offset:40960
  ds_read_b64_tr_b16 v[218:219], v16 offset:41472
  ds_read_b64_tr_b16 v[220:221], v16 offset:45056
  ds_read_b64_tr_b16 v[222:223], v16 offset:45568
  ds_read_b64_tr_b16 v[224:225], v16 offset:49152
  ds_read_b64_tr_b16 v[226:227], v16 offset:49664
  ds_read_b64_tr_b16 v[228:229], v16 offset:53248
  ds_read_b64_tr_b16 v[230:231], v16 offset:53760
  ds_read_b64_tr_b16 v[232:233], v16 offset:57344
  ds_read_b64_tr_b16 v[234:235], v16 offset:57856
  ds_read_b64_tr_b16 v[236:237], v16 offset:61440
  ds_read_b64_tr_b16 v[238:239], v16 offset:61952
  s_waitcnt lgkmcnt(0)
  s_barrier
  s_add_u32 s38, s92, 1572864
  s_add_u32 m0, s94, 32768
  s_nop 0
  buffer_load_dwordx4 v3, s[8:11], s38 offen lds
  s_add_u32 m0, s94, 33792
  s_nop 0
  buffer_load_dwordx4 v4, s[8:11], s38 offen lds
  s_add_u32 s38, s92, 2359296
  s_add_u32 m0, s94, 40960
  s_nop 0
  buffer_load_dwordx4 v3, s[8:11], s38 offen lds
  s_add_u32 m0, s94, 41984
  s_nop 0
  buffer_load_dwordx4 v4, s[8:11], s38 offen lds
  s_add_u32 s38, s92, 3145728
  s_add_u32 m0, s94, 49152
  s_nop 0
  buffer_load_dwordx4 v3, s[8:11], s38 offen lds
  s_add_u32 m0, s94, 50176
  s_nop 0
  buffer_load_dwordx4 v4, s[8:11], s38 offen lds
  s_add_u32 s38, s92, 3932160
  s_add_u32 m0, s94, 57344
  s_nop 0
  buffer_load_dwordx4 v3, s[8:11], s38 offen lds
  s_add_u32 m0, s94, 58368
  s_nop 0
  buffer_load_dwordx4 v4, s[8:11], s38 offen lds
  s_waitcnt vmcnt(8)
  s_barrier
  s_cmp_eq_u32 s20, 0
  s_cbranch_scc0 Lrec_na
  s_lshl_b32 s38, s47, 16
  s_add_u32 s38, s38, 1
  v_mov_b32 v28, s38
  s_mov_b64 exec, 1
  s_waitcnt lgkmcnt(0)
  buffer_atomic_add v28, off, s[80:83], 0 offset:64
  s_mov_b64 exec, -1
Lrec_na:
  ds_read_b64_tr_b16 v[240:241], v16 offset:0
  ds_read_b64_tr_b16 v[242:243], v16 offset:512
  ds_read_b64_tr_b16 v[244:245], v16 offset:4096
  ds_read_b64_tr_b16 v[246:247], v16 offset:4608
  ds_read_b64_tr_b16 v[248:249], v16 offset:8192
  ds_read_b64_tr_b16 v[250:251], v16 offset:8704
  ds_read_b64_tr_b16 v[252:253], v16 offset:12288
  ds_read_b64_tr_b16 v[254:255], v16 offset:12800
  ds_read_b64_tr_b16 v[96:97], v16 offset:16384
  ds_read_b64_tr_b16 v[98:99], v16 offset:16896
  ds_read_b64_tr_b16 v[100:101], v16 offset:20480
  ds_read_b64_tr_b16 v[102:103], v16 offset:20992
  ds_read_b64_tr_b16 v[104:105], v16 offset:24576
  ds_read_b64_tr_b16 v[106:107], v16 offset:25088
  ds_read_b64_tr_b16 v[108:109], v16 offset:28672
  ds_read_b64_tr_b16 v[110:111], v16 offset:29184
  s_waitcnt lgkmcnt(0)
  s_barrier
  s_add_u32 s38, s92, 4718592
  s_add_u32 m0, s94, 0
  s_nop 0
  buffer_load_dwordx4 v3, s[8:11], s38 offen lds
  s_add_u32 m0, s94, 1024
  s_nop 0
  buffer_load_dwordx4 v4, s[8:11], s38 offen lds
  s_add_u32 s38, s92, 5505024
  s_add_u32 m0, s94, 8192
  s_nop 0
  buffer_load_dwordx4 v3, s[8:11], s38 offen lds
  s_add_u32 m0, s94, 9216
  s_nop 0
  buffer_load_dwordx4 v4, s[8:11], s38 offen lds
  s_add_u32 s38, s92, 6291456
  s_add_u32 m0, s94, 16384
  s_nop 0
  buffer_load_dwordx4 v3, s[8:11], s38 offen lds
  s_add_u32 m0, s94, 17408
  s_nop 0
  buffer_load_dwordx4 v4, s[8:11], s38 offen lds
  s_add_u32 s38, s92, 7077888
  s_add_u32 m0, s94, 24576
  s_nop 0
  buffer_load_dwordx4 v3, s[8:11], s38 offen lds
  s_add_u32 m0, s94, 25600
  s_nop 0
  buffer_load_dwordx4 v4, s[8:11], s38 offen lds
  s_waitcnt vmcnt(8)
  s_barrier
  ds_read_b64_tr_b16 v[112:113], v16 offset:32768
  ds_read_b64_tr_b16 v[114:115], v16 offset:33280
  ds_read_b64_tr_b16 v[116:117], v16 offset:36864
  ds_read_b64_tr_b16 v[118:119], v16 offset:37376
  ds_read_b64_tr_b16 v[120:121], v16 offset:40960
  ds_read_b64_tr_b16 v[122:123], v16 offset:41472
  ds_read_b64_tr_b16 v[124:125], v16 offset:45056
  ds_read_b64_tr_b16 v[126:127], v16 offset:45568
  ds_read_b64_tr_b16 v[128:129], v16 offset:49152
  ds_read_b64_tr_b16 v[130:131], v16 offset:49664
  ds_read_b64_tr_b16 v[132:133], v16 offset:53248
  ds_read_b64_tr_b16 v[134:135], v16 offset:53760
  ds_read_b64_tr_b16 v[136:137], v16 offset:57344
  ds_read_b64_tr_b16 v[138:139], v16 offset:57856
  ds_read_b64_tr_b16 v[140:141], v16 offset:61440
  ds_read_b64_tr_b16 v[142:143], v16 offset:61952
  s_waitcnt lgkmcnt(0)
  s_barrier
  s_waitcnt vmcnt(0)
  s_barrier
  ds_read_b64_tr_b16 v[144:145], v16 offset:0
  ds_read_b64_tr_b16 v[146:147], v16 offset:512
  ds_read_b64_tr_b16 v[148:149], v16 offset:4096
  ds_read_b64_tr_b16 v[150:151], v16 offset:4608
  ds_read_b64_tr_b16 v[152:153], v16 offset:8192
  ds_read_b64_tr_b16 v[154:155], v16 offset:8704
  ds_read_b64_tr_b16 v[156:157], v16 offset:12288
  ds_read_b64_tr_b16 v[158:159], v16 offset:12800
  ds_read_b64_tr_b16 v[160:161], v16 offset:16384
  ds_read_b64_tr_b16 v[162:163], v16 offset:16896
  ds_read_b64_tr_b16 v[164:165], v16 offset:20480
  ds_read_b64_tr_b16 v[166:167], v16 offset:20992
  ds_read_b64_tr_b16 v[168:169], v16 offset:24576
  ds_read_b64_tr_b16 v[170:171], v16 offset:25088
  ds_read_b64_tr_b16 v[172:173], v16 offset:28672
  ds_read_b64_tr_b16 v[174:175], v16 offset:29184
  s_waitcnt lgkmcnt(0)
  s_waitcnt vmcnt(0)
  s_barrier
  s_waitcnt lgkmcnt(0)
  s_branch Lrec_sd
Lrec_sv:
  s_add_u32 s38, s92, 0
  s_add_u32 m0, s94, 0
  s_nop 0
  buffer_load_dwordx4 v3, s[8:11], s38 offen lds
  s_add_u32 m0, s94, 1024
  s_nop 0
  buffer_load_dwordx4 v4, s[8:11], s38 offen lds
  s_add_u32 s38, s92, 786432
  s_add_u32 m0, s94, 8192
  s_nop 0
  buffer_load_dwordx4 v3, s[8:11], s38 offen lds
  s_add_u32 m0, s94, 9216
  s_nop 0
  buffer_load_dwordx4 v4, s[8:11], s38 offen lds
  s_add_u32 s38, s92, 1572864
  s_add_u32 m0, s94, 16384
  s_nop 0
  buffer_load_dwordx4 v3, s[8:11], s38 offen lds
  s_add_u32 m0, s94, 17408
  s_nop 0
  buffer_load_dwordx4 v4, s[8:11], s38 offen lds
  s_add_u32 s38, s92, 2359296
  s_add_u32 m0, s94, 24576
  s_nop 0
  buffer_load_dwordx4 v3, s[8:11], s38 offen lds
  s_add_u32 m0, s94, 25600
  s_nop 0
  buffer_load_dwordx4 v4, s[8:11], s38 offen lds
  s_add_u32 s38, s92, 3145728
  s_add_u32 m0, s94, 32768
  s_nop 0
  buffer_load_dwordx4 v3, s[8:11], s38 offen lds
  s_add_u32 m0, s94, 33792
  s_nop 0
  buffer_load_dwordx4 v4, s[8:11], s38 offen lds
  s_add_u32 s38, s92, 3932160
  s_add_u32 m0, s94, 40960
  s_nop 0
  buffer_load_dwordx4 v3, s[8:11], s38 offen lds
  s_add_u32 m0, s94, 41984
  s_nop 0
  buffer_load_dwordx4 v4, s[8:11], s38 offen lds
  s_add_u32 s38, s92, 4718592
  s_add_u32 m0, s94, 49152
  s_nop 0
  buffer_load_dwordx4 v3, s[8:11], s38 offen lds
  s_add_u32 m0, s94, 50176
  s_nop 0
  buffer_load_dwordx4 v4, s[8:11], s38 offen lds
  s_add_u32 s38, s92, 5505024
  s_add_u32 m0, s94, 57344
  s_nop 0
  buffer_load_dwordx4 v3, s[8:11], s38 offen lds
  s_add_u32 m0, s94, 58368
  s_nop 0
  buffer_load_dwordx4 v4, s[8:11], s38 offen lds
  buffer_load_dwordx2 v[20:21], v17, s[88:91], 0 offen
  buffer_load_dwordx2 v[22:23], v17, s[88:91], 0 offen offset:32
  s_waitcnt vmcnt(0)
  ds_write_b128 v18, v[20:23] offset:0
  s_barrier
  ds_read_b64_tr_b16 v[80:81], v16 offset:0
  ds_read_b64_tr_b16 v[82:83], v16 offset:512
  ds_read_b64_tr_b16 v[84:85], v16 offset:4096
  ds_read_b64_tr_b16 v[86:87], v16 offset:4608
  ds_read_b64_tr_b16 v[88:89], v16 offset:8192
  ds_read_b64_tr_b16 v[90:91], v16 offset:8704
  ds_read_b64_tr_b16 v[92:93], v16 offset:12288
  ds_read_b64_tr_b16 v[94:95], v16 offset:12800
  ds_read_b64_tr_b16 v[96:97], v16 offset:16384
  ds_read_b64_tr_b16 v[98:99], v16 offset:16896
  ds_read_b64_tr_b16 v[100:101], v16 offset:20480
  ds_read_b64_tr_b16 v[102:103], v16 offset:20992
  ds_read_b64_tr_b16 v[104:105], v16 offset:24576
  ds_read_b64_tr_b16 v[106:107], v16 offset:25088
  ds_read_b64_tr_b16 v[108:109], v16 offset:28672
  ds_read_b64_tr_b16 v[110:111], v16 offset:29184
  s_waitcnt lgkmcnt(0)
  s_barrier
  s_mul_i32 s38, s35, 20
  s_lshl_b32 s39, s93, 7
  s_add_u32 s38, s38, s39
  s_add_u32 s38, s38, 0
  s_add_u32 m0, s94, 0
  s_nop 0
  buffer_load_dwordx4 v7, s[12:15], s38 offen lds
  s_add_u32 m0, s94, 1024
  s_nop 0
  buffer_load_dwordx4 v8, s[12:15], s38 offen lds
  s_mul_i32 s38, s35, 20
  s_lshl_b32 s39, s93, 7
  s_add_u32 s38, s38, s39
  s_add_u32 s38, s38, 128
  s_add_u32 m0, s94, 8192
  s_nop 0
  buffer_load_dwordx4 v7, s[12:15], s38 offen lds
  s_add_u32 m0, s94, 9216
  s_nop 0
  buffer_load_dwordx4 v8, s[12:15], s38 offen lds
  s_mul_i32 s38, s35, 20
  s_lshl_b32 s39, s93, 7
  s_add_u32 s38, s38, s39
  s_add_u32 s38, s38, 256
  s_add_u32 m0, s94, 16384
  s_nop 0
  buffer_load_dwordx4 v7, s[12:15], s38 offen lds
  s_add_u32 m0, s94, 17408
  s_nop 0
  buffer_load_dwordx4 v8, s[12:15], s38 offen lds
  s_mul_i32 s38, s35, 20
  s_lshl_b32 s39, s93, 7
  s_add_u32 s38, s38, s39
  s_add_u32 s38, s38, 384
  s_add_u32 m0, s94, 24576
  s_nop 0
  buffer_load_dwordx4 v7, s[12:15], s38 offen lds
  s_add_u32 m0, s94, 25600
  s_nop 0
  buffer_load_dwordx4 v8, s[12:15], s38 offen lds
  s_waitcnt vmcnt(8)
  v_mov_b32 v29, 15872
  s_cmp_eq_u32 s20, 0
  s_cbranch_scc0 Lcx_124
  s_mov_b32 s39, 200000
  s_branch Lcq_123
Lcr_122:
  buffer_load_dword v28, off, s[80:83], 0 sc1
  s_waitcnt vmcnt(0)
Lcq_123:
  s_sub_u32 s39, s39, 1
  s_cbranch_scc1 Lcd_125
  v_cmp_eq_u32 vcc, 0, v28
  s_cbranch_vccnz Lcr_122
Lcd_125:
  ds_write_b32 v29, v28
  s_waitcnt lgkmcnt(0)
Lcx_124:
  s_barrier
  ds_read_b32 v28, v29
  s_waitcnt lgkmcnt(0)
  v_readfirstlane_b32 s38, v28
  s_sub_u32 s38, s38, 1
  s_cmp_eq_u32 s38, s46
  s_cbranch_scc0 Lrestart
  v_mov_b32 v28, 0
  v_mov_b32 v29, 0
  v_mov_b32 v30, 0
  v_mov_b32 v31, 0
  v_lshlrev_b32 v2, 4, v1
  s_lshl_b32 s38, s17, 12
  s_add_u32 s38, s38, s98
  s_cmp_lt_u32 s20, 4
  s_cselect_b32 s38, s35, s38
  s_cselect_b32 s39, 1, s36
  s_lshl_b32 s40, s21, 10
  s_add_u32 s38, s38, s40
  s_cmp_eq_u32 s39, 0
  s_cbranch_scc1 Lrec_z1v
  buffer_store_dwordx4 v[28:31], v2, s[4:7], s38 offen sc1
  s_cmp_eq_u32 s36, 0
  s_cbranch_scc1 Lrec_z1v
  s_cmp_lt_u32 s20, 6
  s_cbranch_scc0 Lrec_z0v
  s_mul_i32 s38, s20, 163840
  s_add_u32 s38, s38, s97
  s_lshl_b32 s39, s16, 10
  s_add_u32 s38, s38, s39
  s_add_u32 s39, s38, 8192
  s_sub_u32 s40, s20, 2
  s_cmp_lt_u32 s40, 2
  s_cselect_b32 s40, 1, 0
  v_mov_b32 v32, s40
  v_mov_b32 v33, 0
  v_mov_b32 v34, 0
  v_mov_b32 v35, 0
  buffer_store_dwordx4 v[32:35], v2, s[4:7], s38 offen sc1
  buffer_store_dwordx4 v[32:35], v2, s[4:7], s39 offen sc1
  s_branch Lrec_z1v
Lrec_z0v:
  v_mov_b32 v32, -1
  v_mov_b32 v33, -1
  v_lshlrev_b32 v2, 3, v1
  s_lshl_b32 s38, s17, 9
  s_add_u32 s38, s38, s26
  buffer_store_dwordx2 v[32:33], v2, s[4:7], s38 offen sc1
Lrec_z1v:
  s_cmp_lt_u32 s20, 5
  s_cbranch_scc0 Lrec_z2v
  v_mov_b32 v36, -1
  v_mov_b32 v37, -1
  v_mov_b32 v38, -1
  v_mov_b32 v39, -1
  v_lshlrev_b32 v2, 4, v1
  s_add_u32 s38, s20, 59
  s_mul_i32 s38, s38, 196608
  s_add_u32 s38, s38, s29
  buffer_store_dwordx4 v[36:39], v2, s[4:7], s38 offen sc1
  buffer_store_dwordx4 v[36:39], v2, s[4:7], s38 offen offset:1024 sc1
Lrec_z2v:
  ds_read_b64_tr_b16 v[112:113], v16 offset:32768
  ds_read_b64_tr_b16 v[114:115], v16 offset:33280
  ds_read_b64_tr_b16 v[116:117], v16 offset:36864
  ds_read_b64_tr_b16 v[118:119], v16 offset:37376
  ds_read_b64_tr_b16 v[120:121], v16 offset:40960
  ds_read_b64_tr_b16 v[122:123], v16 offset:41472
  ds_read_b64_tr_b16 v[124:125], v16 offset:45056
  ds_read_b64_tr_b16 v[126:127], v16 offset:45568
  ds_read_b64_tr_b16 v[128:129], v16 offset:49152
  ds_read_b64_tr_b16 v[130:131], v16 offset:49664
  ds_read_b64_tr_b16 v[132:133], v16 offset:53248
  ds_read_b64_tr_b16 v[134:135], v16 offset:53760
  ds_read_b64_tr_b16 v[136:137], v16 offset:57344
  ds_read_b64_tr_b16 v[138:139], v16 offset:57856
  ds_read_b64_tr_b16 v[140:141], v16 offset:61440
  ds_read_b64_tr_b16 v[142:143], v16 offset:61952
  s_waitcnt lgkmcnt(0)
  s_barrier
  s_mul_i32 s38, s33, 20
  s_lshl_b32 s39, s93, 7
  s_add_u32 s38, s38, s39
  s_add_u32 s38, s38, 0
  s_add_u32 m0, s94, 32768
  s_nop 0
  buffer_load_dwordx4 v7, s[12:15], s38 offen lds
  s_add_u32 m0, s94, 33792
  s_nop 0
  buffer_load_dwordx4 v8, s[12:15], s38 offen lds
  s_mul_i32 s38, s33, 20
  s_lshl_b32 s39, s93, 7
  s_add_u32 s38, s38, s39
  s_add_u32 s38, s38, 128
  s_add_u32 m0, s94, 40960
  s_nop 0
  buffer_load_dwordx4 v7, s[12:15], s38 offen lds
  s_add_u32 m0, s94, 41984
  s_nop 0
  buffer_load_dwordx4 v8, s[12:15], s38 offen lds
  s_mul_i32 s38, s33, 20
  s_lshl_b32 s39, s93, 7
  s_add_u32 s38, s38, s39
  s_add_u32 s38, s38, 256
  s_add_u32 m0, s94, 49152
  s_nop 0
  buffer_load_dwordx4 v7, s[12:15], s38 offen lds
  s_add_u32 m0, s94, 50176
  s_nop 0
  buffer_load_dwordx4 v8, s[12:15], s38 offen lds
  s_mul_i32 s38, s33, 20
  s_lshl_b32 s39, s93, 7
  s_add_u32 s38, s38, s39
  s_add_u32 s38, s38, 384
  s_add_u32 m0, s94, 57344
  s_nop 0
  buffer_load_dwordx4 v7, s[12:15], s38 offen lds
  s_add_u32 m0, s94, 58368
  s_nop 0
  buffer_load_dwordx4 v8, s[12:15], s38 offen lds
  s_waitcnt vmcnt(8)
  s_barrier
  ds_read_b64_tr_b16 v[160:161], v12 offset:0
  ds_read_b64_tr_b16 v[162:163], v12 offset:512
  ds_read_b64_tr_b16 v[164:165], v12 offset:4096
  ds_read_b64_tr_b16 v[166:167], v12 offset:4608
  ds_read_b64_tr_b16 v[168:169], v13 offset:0
  ds_read_b64_tr_b16 v[170:171], v13 offset:512
  ds_read_b64_tr_b16 v[172:173], v13 offset:4096
  ds_read_b64_tr_b16 v[174:175], v13 offset:4608
  ds_read_b64_tr_b16 v[176:177], v14 offset:0
  ds_read_b64_tr_b16 v[178:179], v14 offset:512
  ds_read_b64_tr_b16 v[180:181], v14 offset:4096
  ds_read_b64_tr_b16 v[182:183], v14 offset:4608
  ds_read_b64_tr_b16 v[184:185], v15 offset:0
  ds_read_b64_tr_b16 v[186:187], v15 offset:512
  ds_read_b64_tr_b16 v[188:189], v15 offset:4096
  ds_read_b64_tr_b16 v[190:191], v15 offset:4608
  s_waitcnt lgkmcnt(0)
  s_barrier
  s_mul_i32 s38, s34, 20
  s_lshl_b32 s39, s93, 7
  s_add_u32 s38, s38, s39
  s_add_u32 s38, s38, 0
  s_add_u32 m0, s94, 0
  s_nop 0
  buffer_load_dwordx4 v7, s[12:15], s38 offen lds
  s_add_u32 m0, s94, 1024
  s_nop 0
  buffer_load_dwordx4 v8, s[12:15], s38 offen lds
  s_mul_i32 s38, s34, 20
  s_lshl_b32 s39, s93, 7
  s_add_u32 s38, s38, s39
  s_add_u32 s38, s38, 128
  s_add_u32 m0, s94, 8192
  s_nop 0
  buffer_load_dwordx4 v7, s[12:15], s38 offen lds
  s_add_u32 m0, s94, 9216
  s_nop 0
  buffer_load_dwordx4 v8, s[12:15], s38 offen lds
  s_mul_i32 s38, s34, 20
  s_lshl_b32 s39, s93, 7
  s_add_u32 s38, s38, s39
  s_add_u32 s38, s38, 256
  s_add_u32 m0, s94, 16384
  s_nop 0
  buffer_load_dwordx4 v7, s[12:15], s38 offen lds
  s_add_u32 m0, s94, 17408
  s_nop 0
  buffer_load_dwordx4 v8, s[12:15], s38 offen lds
  s_mul_i32 s38, s34, 20
  s_lshl_b32 s39, s93, 7
  s_add_u32 s38, s38, s39
  s_add_u32 s38, s38, 384
  s_add_u32 m0, s94, 24576
  s_nop 0
  buffer_load_dwordx4 v7, s[12:15], s38 offen lds
  s_add_u32 m0, s94, 25600
  s_nop 0
  buffer_load_dwordx4 v8, s[12:15], s38 offen lds
  s_waitcnt vmcnt(8)
  s_barrier
  ds_read_b64_tr_b16 v[192:193], v12 offset:32768
  ds_read_b64_tr_b16 v[194:195], v12 offset:33280
  ds_read_b64_tr_b16 v[196:197], v12 offset:36864
  ds_read_b64_tr_b16 v[198:199], v12 offset:37376
  ds_read_b64_tr_b16 v[200:201], v13 offset:32768
  ds_read_b64_tr_b16 v[202:203], v13 offset:33280
  ds_read_b64_tr_b16 v[204:205], v13 offset:36864
  ds_read_b64_tr_b16 v[206:207], v13 offset:37376
  ds_read_b64_tr_b16 v[208:209], v14 offset:32768
  ds_read_b64_tr_b16 v[210:211], v14 offset:33280
  ds_read_b64_tr_b16 v[212:213], v14 offset:36864
  ds_read_b64_tr_b16 v[214:215], v14 offset:37376
  ds_read_b64_tr_b16 v[216:217], v15 offset:32768
  ds_read_b64_tr_b16 v[218:219], v15 offset:33280
  ds_read_b64_tr_b16 v[220:221], v15 offset:36864
  ds_read_b64_tr_b16 v[222:223], v15 offset:37376
  s_waitcnt lgkmcnt(0)
  s_barrier
  s_add_u32 s38, s92, 6291456
  s_add_u32 m0, s94, 32768
  s_nop 0
  buffer_load_dwordx4 v3, s[8:11], s38 offen lds
  s_add_u32 m0, s94, 33792
  s_nop 0
  buffer_load_dwordx4 v4, s[8:11], s38 offen lds
  s_add_u32 s38, s92, 7077888
  s_add_u32 m0, s94, 40960
  s_nop 0
  buffer_load_dwordx4 v3, s[8:11], s38 offen lds
  s_add_u32 m0, s94, 41984
  s_nop 0
  buffer_load_dwordx4 v4, s[8:11], s38 offen lds
  s_waitcnt vmcnt(4)
  s_barrier
  ds_read_b64_tr_b16 v[224:225], v12 offset:0
  ds_read_b64_tr_b16 v[226:227], v12 offset:512
  ds_read_b64_tr_b16 v[228:229], v12 offset:4096
  ds_read_b64_tr_b16 v[230:231], v12 offset:4608
  ds_read_b64_tr_b16 v[232:233], v13 offset:0
  ds_read_b64_tr_b16 v[234:235], v13 offset:512
  ds_read_b64_tr_b16 v[236:237], v13 offset:4096
  ds_read_b64_tr_b16 v[238:239], v13 offset:4608
  ds_read_b64_tr_b16 v[240:241], v14 offset:0
  ds_read_b64_tr_b16 v[242:243], v14 offset:512
  ds_read_b64_tr_b16 v[244:245], v14 offset:4096
  ds_read_b64_tr_b16 v[246:247], v14 offset:4608
  ds_read_b64_tr_b16 v[248:249], v15 offset:0
  ds_read_b64_tr_b16 v[250:251], v15 offset:512
  ds_read_b64_tr_b16 v[252:253], v15 offset:4096
  ds_read_b64_tr_b16 v[254:255], v15 offset:4608
  s_waitcnt lgkmcnt(0)
  s_waitcnt vmcnt(0)
  s_barrier
  ds_read_b64_tr_b16 v[144:145], v16 offset:32768
  ds_read_b64_tr_b16 v[146:147], v16 offset:33280
  ds_read_b64_tr_b16 v[148:149], v16 offset:36864
  ds_read_b64_tr_b16 v[150:151], v16 offset:37376
  ds_read_b64_tr_b16 v[152:153], v16 offset:40960
  ds_read_b64_tr_b16 v[154:155], v16 offset:41472
  ds_read_b64_tr_b16 v[156:157], v16 offset:45056
  ds_read_b64_tr_b16 v[158:159], v16 offset:45568
  s_waitcnt lgkmcnt(0)
Lrec_sd:
  v_lshlrev_b32 v2, 4, v1
  v_mov_b32 v3, 0x4444
  v_mov_b32 v9, 0xeeee
  v_cndmask_b32 v3, v3, v9, s[44:45]
  s_cmp_lt_u32 s20, 4
  s_cselect_b32 s38, 4, s21
  s_lshl_b32 s38, s38, 11
  v_add_u32 v6, s38, v2
  s_mov_b32 s84, 0
  s_mov_b32 s85, 327680
  s_mov_b32 s86, 655360
  s_mov_b32 s22, 0
  s_mov_b32 s23, 1
  v_bfe_u32 v7, v1, 2, 2
  v_lshlrev_b32 v7, 6, v7
  v_bfe_u32 v9, v1, 4, 2
  v_lshl_add_u32 v7, v9, 4, v7
  v_bfe_u32 v9, v1, 0, 1
  v_lshl_add_u32 v7, v9, 3, v7
  v_bfe_u32 v9, v1, 1, 1
  v_lshl_add_u32 v7, v9, 2, v7
  s_lshl_b32 s38, s21, 8
  v_add_u32 v7, s38, v7
  s_cmp_lt_u32 s20, 4
  s_cbranch_scc0 Lrec_v
  v_bfe_u32 v8, v1, 0, 4
  v_lshlrev_b32 v8, 3, v8
  v_bfe_u32 v12, v1, 4, 2
  v_lshl_add_u32 v8, v12, 7, v8
  v_bfe_u32 v12, v1, 5, 1
  v_lshlrev_b32 v12, 6, v12
  v_xor_b32 v8, v8, v12
  s_lshl_b32 s38, s21, 9
  v_add_u32 v8, s38, v8
  v_bfe_u32 v9, v1, 2, 4
  v_lshlrev_b32 v9, 3, v9
  v_bfe_u32 v12, v1, 0, 2
  v_lshl_add_u32 v9, v12, 7, v9
  v_bfe_u32 v12, v1, 1, 1
  v_lshlrev_b32 v12, 6, v12
  v_xor_b32 v9, v9, v12
  v_bfe_u32 v13, v1, 2, 4
  v_lshlrev_b32 v13, 1, v13
  v_bfe_u32 v12, v1, 0, 1
  v_lshl_add_u32 v13, v12, 0, v13
  s_and_b32 s38, s21, 1
  s_lshl_b32 s38, s38, 9
  s_cmp_eq_u32 s21, 3
  s_cselect_b32 s38, 0, s38
  v_lshl_add_u32 v4, v13, 4, s38
  s_and_b32 s38, s21, 1
  s_lshl_b32 s38, s38, 5
  v_and_b32 v12, 0x3d0, v2
  v_add_u32 v12, s38, v12
  s_cmp_ge_u32 s21, 2
  s_cselect_b64 vcc, -1, 0
  v_cndmask_b32 v4, v12, v4, vcc
  v_lshlrev_b32 v5, 3, v13
  v_add_u32 v5, 1024, v5
  s_lshl_b32 s38, s21, 11
  v_add_u32 v11, s38, v2
  v_mov_b32 v48, 0
  v_mov_b32 v49, 0
  v_mov_b32 v50, 0
  v_mov_b32 v51, 0
  v_mov_b32 v52, 0
  v_mov_b32 v53, 0
  v_mov_b32 v54, 0
  v_mov_b32 v55, 0
  s_lshl_b32 s99, s17, 12
  s_add_u32 s99, s99, s98
  s_lshl_b32 s40, s16, 10
  s_cmp_eq_u32 s21, 3
  s_cbranch_scc1 Lq_126
  s_cmp_eq_u32 s21, 1
  s_cbranch_scc1 Lq_128
  s_cmp_eq_u32 s21, 2
  s_cbranch_scc1 Lq_129
  v_add_u32 v10, s40, v2
  v_and_b32 v12, 15, v1
  v_and_b32 v13, 1, v12
  v_lshlrev_b32 v13, 4, v13
  v_mov_b32 v14, 0x3f80
  v_lshlrev_b32 v13, v13, v14
  v_lshrrev_b32 v12, 1, v12
  v_cmp_eq_u32 vcc, 0, v12
  s_nop 1
  v_cndmask_b32 v20, 0, v13, vcc
  v_cmp_eq_u32 vcc, 1, v12
  s_nop 1
  v_cndmask_b32 v21, 0, v13, vcc
  v_cmp_eq_u32 vcc, 2, v12
  s_nop 1
  v_cndmask_b32 v22, 0, v13, vcc
  v_cmp_eq_u32 vcc, 3, v12
  s_nop 1
  v_cndmask_b32 v23, 0, v13, vcc
  v_cmp_eq_u32 vcc, 4, v12
  s_nop 1
  v_cndmask_b32 v24, 0, v13, vcc
  v_cmp_eq_u32 vcc, 5, v12
  s_nop 1
  v_cndmask_b32 v25, 0, v13, vcc
  v_cmp_eq_u32 vcc, 6, v12
  s_nop 1
  v_cndmask_b32 v26, 0, v13, vcc
  v_cmp_eq_u32 vcc, 7, v12
  s_nop 1
  v_cndmask_b32 v27, 0, v13, vcc
  s_branch Lq_127
Lq_128:
  s_add_u32 s38, s40, 1024
  s_and_b32 s38, s38, 3072
  v_add_u32 v20, s38, v2
  s_add_u32 s38, s40, 2048
  s_and_b32 s38, s38, 3072
  v_add_u32 v21, s38, v2
  s_add_u32 s38, s40, 3072
  s_and_b32 s38, s38, 3072
  v_add_u32 v22, s38, v2
  v_bfe_u32 v23, v1, 0, 4
  v_lshlrev_b32 v23, 4, v23
  v_bfe_u32 v12, v1, 5, 1
  v_lshl_add_u32 v23, v12, 8, v23
  v_bfe_u32 v12, v1, 4, 1
  v_lshl_add_u32 v23, v12, 3, v23
  s_lshl_b32 s38, s17, 9
  v_add_u32 v23, s38, v23
  v_mov_b32 v24, -1
  v_mov_b32 v25, -1
  s_branch Lq_127
Lq_129:
  v_lshrrev_b32 v12, 3, v1
  v_min_u32 v12, 1, v12
  v_mul_u32_u24 v12, 163840, v12
  v_and_b32 v13, 7, v1
  v_lshl_add_u32 v12, v13, 7, v12
  v_add_u32 v10, s40, v12
  s_branch Lq_127
Lq_126:
  v_lshrrev_b32 v12, 4, v1
  v_lshlrev_b32 v12, 5, v12
  v_xor_b32 v6, v2, v12
  v_xor_b32 v11, 128, v6
  s_sub_u32 s100, s33, s35
  s_lshl_b32 s100, s100, 1
  s_add_u32 s100, s100, 4096
  s_sub_u32 s101, s34, s35
  s_lshl_b32 s101, s101, 1
  s_add_u32 s101, s101, 4096
  s_mul_i32 s38, s16, 24
  s_add_u32 s38, s38, s17
  s_lshl_b32 s39, s38, 7
  s_add_u32 s39, s39, 1841152
  v_mov_b32 v17, 0x40000000
  v_writelane_b32 v17, s39, 0
  s_mul_i32 s38, s16, 12
  s_lshr_b32 s39, s17, 2
  s_add_u32 s38, s38, s39
  s_lshl_b32 s38, s38, 7
  s_add_u32 s38, s38, 1835008
  v_mov_b32 v16, s38
  s_mul_i32 s38, s16, 12
  s_sub_u32 s39, s17, s19
  s_lshr_b32 s40, s39, 2
  s_add_u32 s40, s40, s38
  s_lshl_b32 s40, s40, 7
  s_add_u32 s40, s40, 1835776
  v_writelane_b32 v16, s40, 1
  s_add_u32 s39, s39, 2
  s_lshr_b32 s40, s39, 2
  s_add_u32 s40, s40, s38
  s_lshl_b32 s40, s40, 7
  s_add_u32 s40, s40, 1835776
  v_writelane_b32 v16, s40, 2
  v_mov_b32 v19, 128
  s_waitcnt lgkmcnt(0)
Lln_130:
  buffer_load_ubyte v18, v19, s[80:83], 0 offen sc1
  s_waitcnt vmcnt(0)
  v_cmp_gt_u32 vcc, 36, v18
  s_cbranch_vccz Llnd_131
  s_sub_u32 s24, s24, 1
  s_cbranch_scc0 Lln_130
  s_branch Lrec_fail
Llnd_131:
Lkp_132:
  buffer_load_dword v18, v16, s[4:7], 0 offen sc1
  s_waitcnt vmcnt(0)
  v_cmp_gt_u32 vcc, 1, v18
  s_cbranch_vccz Lkpd_133
  s_sub_u32 s24, s24, 1
  s_cbranch_scc0 Lkp_132
  s_branch Lrec_fail
Lkpd_133:
  s_add_u32 m0, s30, 0
  s_add_u32 s38, s28, 0
  buffer_load_dwordx4 v2, s[4:7], s38 offen offset:0 sc1 lds
  buffer_load_dwordx4 v2, s[4:7], s38 offen offset:1024 sc1 lds
  buffer_load_dwordx4 v2, s[4:7], s38 offen offset:2048 sc1 lds
  buffer_load_dwordx4 v2, s[4:7], s38 offen offset:3072 sc1 lds
  s_add_u32 m0, s30, 4096
  s_add_u32 s38, s28, 4096
  buffer_load_dwordx4 v6, s[4:7], s38 offen offset:0 sc1 lds
  buffer_load_dwordx4 v6, s[4:7], s38 offen offset:1024 sc1 lds
  buffer_load_dwordx4 v11, s[4:7], s38 offen offset:2048 sc1 lds
  buffer_load_dwordx4 v11, s[4:7], s38 offen offset:3072 sc1 lds
  s_add_u32 m0, s30, 8192
  s_add_u32 s38, s28, s100
  buffer_load_dwordx4 v6, s[4:7], s38 offen offset:0 sc1 lds
  buffer_load_dwordx4 v6, s[4:7], s38 offen offset:1024 sc1 lds
  buffer_load_dwordx4 v11, s[4:7], s38 offen offset:2048 sc1 lds
  buffer_load_dwordx4 v11, s[4:7], s38 offen offset:3072 sc1 lds
  s_add_u32 m0, s30, 12288
  s_add_u32 s38, s28, s101
  buffer_load_dwordx4 v6, s[4:7], s38 offen offset:0 sc1 lds
  buffer_load_dwordx4 v6, s[4:7], s38 offen offset:1024 sc1 lds
  buffer_load_dwordx4 v11, s[4:7], s38 offen offset:2048 sc1 lds
  buffer_load_dwordx4 v11, s[4:7], s38 offen offset:3072 sc1 lds
  s_add_u32 s28, s28, 786432
  v_mov_b32 v16, v5
  v_bfe_u32 v5, v1, 2, 4
  v_lshlrev_b32 v5, 4, v5
  v_bfe_u32 v12, v1, 0, 1
  v_lshl_add_u32 v5, v12, 3, v5
  v_bfe_u32 v12, v1, 1, 1
  v_lshl_add_u32 v5, v12, 2, v5
  v_add_u32 v5, 1024, v5
  v_bfe_u32 v14, v1, 2, 4
  v_lshlrev_b32 v14, 5, v14
  v_bfe_u32 v12, v1, 0, 1
  v_lshl_add_u32 v14, v12, 4, v14
  v_bfe_u32 v12, v1, 1, 1
  v_lshl_add_u32 v14, v12, 3, v14
  v_lshrrev_b32 v15, 2, v14
Lq_127:
  s_lshl_b32 s38, s21, 10
  v_add_u32 v7, s38, v2
  s_cmp_eq_u32 s21, 0
  s_cselect_b32 s90, s33, s34
  s_mov_b32 s91, 0
  v_mov_b32 v58, 15872
  s_cmp_eq_u32 s20, 0
  s_cbranch_scc0 Lsbx_136
Lsb_134:
  buffer_load_dword v56, off, s[80:83], 0 offset:64 sc1
  s_waitcnt vmcnt(0)
  v_and_b32 v59, 255, v56
  v_cmp_gt_u32 vcc, 97, v59
  s_cbranch_vccz Lsbd_135
  s_sub_u32 s24, s24, 1
  s_cbranch_scc0 Lsb_134
  s_branch Lrec_fail
Lsbd_135:
  ds_write_b32 v58, v56
Lsbx_136:
  s_waitcnt vmcnt(0) lgkmcnt(0)
  s_barrier
  ds_read_b32 v56, v58
  s_waitcnt lgkmcnt(0)
  v_readfirstlane_b32 s38, v56
  s_bfe_u32 s39, s38, 0x10008
  s_lshl_b32 s39, s39, 13
  s_add_u32 s97, s97, s39
  s_cmp_ge_u32 s38, 65536
  v_add_u32 v10, s97, v10
  v_cmp_eq_u32 vcc, 1, s21
  v_mov_b32 v12, s97
  s_nop 0
  v_cndmask_b32 v12, 0, v12, vcc
  v_add_u32 v20, v20, v12
  v_add_u32 v21, v21, v12
  v_add_u32 v22, v22, v12
  ds_read_b128 v[40:43], v11 offset:16384
  ds_read_b128 v[44:47], v11 offset:17408
  s_setprio 2
  s_cbranch_scc1 Lq_b1S
  s_branch Lq_b1F
.p2align 8
.p2align 5
Lq_loopF:
  s_cmp_eq_u32 s21, 2
  s_cbranch_scc0 Lq_b1F
  s_sleep 2
Lg_137:
  buffer_load_dwordx4 v[56:59], v6, s[4:7], s25 offen sc1
  buffer_load_dwordx4 v[60:63], v6, s[4:7], s25 offen offset:1024 sc1
  s_waitcnt vmcnt(1)
  ds_write_b128 v6, v[56:59] offset:0
  v_max_u32 v64, v56, v58
  s_waitcnt vmcnt(0)
  ds_write_b128 v6, v[60:63] offset:1024
  v_max3_u32 v64, v64, v60, v62
  v_cmp_eq_u32 vcc, -1, v64
  s_cbranch_vccz Lgd_138
  s_mov_b64 exec, vcc
  s_sub_u32 s24, s24, 1
  s_cbranch_scc0 Lg_137
  s_branch Lrec_fail
.p2align 5
  s_nop 0
  s_nop 0
Lgd_138:
  s_mov_b64 exec, -1
  s_waitcnt lgkmcnt(0)
Lq_b1F:
  s_waitcnt lgkmcnt(0)
  s_barrier
  ds_read_b128 v[56:59], v2 offset:0
  ds_read_b128 v[60:63], v2 offset:1024
  ds_read_b128 v[64:67], v2 offset:2048
  ds_read_b128 v[68:71], v2 offset:3072
  ds_read_b128 v[72:75], v2 offset:4096
  ds_read_b128 v[76:79], v2 offset:5120
  ds_read_b128 v[80:83], v2 offset:6144
  ds_read_b128 v[84:87], v2 offset:7168
  ds_read_b128 v[88:91], v2 offset:8192
  ds_read_b128 v[92:95], v2 offset:9216
  s_waitcnt lgkmcnt(9)
  v_smfmac_f32_16x16x64_bf16 v[48:51], v[56:59], v[96:103], v3
  v_smfmac_f32_16x16x64_bf16 v[52:55], v[56:59], v[176:183], v3
  s_waitcnt lgkmcnt(8)
  v_smfmac_f32_16x16x64_bf16 v[48:51], v[60:63], v[104:111], v3
  v_smfmac_f32_16x16x64_bf16 v[52:55], v[60:63], v[184:191], v3
  s_cmp_eq_u32 s91, 0
  s_cbranch_scc1 Lq_nkmF
  buffer_store_dword v13, v17, s[4:7], 0 offen sc1
  buffer_store_dword v13, v17, s[4:7], s96 offen
Lq_nkmF:
  s_waitcnt lgkmcnt(7)
  v_smfmac_f32_16x16x64_bf16 v[48:51], v[64:67], v[112:119], v3
  v_smfmac_f32_16x16x64_bf16 v[52:55], v[64:67], v[192:199], v3
  s_waitcnt lgkmcnt(6)
  v_smfmac_f32_16x16x64_bf16 v[48:51], v[68:71], v[120:127], v3
  v_smfmac_f32_16x16x64_bf16 v[52:55], v[68:71], v[200:207], v3
  s_waitcnt lgkmcnt(5)
  v_smfmac_f32_16x16x64_bf16 v[48:51], v[72:75], v[128:135], v3
  v_smfmac_f32_16x16x64_bf16 v[52:55], v[72:75], v[208:215], v3
  s_waitcnt lgkmcnt(4)
  v_smfmac_f32_16x16x64_bf16 v[48:51], v[76:79], v[136:143], v3
  v_smfmac_f32_16x16x64_bf16 v[52:55], v[76:79], v[216:223], v3
  s_waitcnt lgkmcnt(3)
  v_smfmac_f32_16x16x64_bf16 v[48:51], v[80:83], v[144:151], v3
  v_smfmac_f32_16x16x64_bf16 v[52:55], v[80:83], v[224:231], v3
  s_waitcnt lgkmcnt(2)
  v_smfmac_f32_16x16x64_bf16 v[48:51], v[84:87], v[152:159], v3
  v_smfmac_f32_16x16x64_bf16 v[52:55], v[84:87], v[232:239], v3
  s_waitcnt lgkmcnt(1)
  v_smfmac_f32_16x16x64_bf16 v[48:51], v[88:91], v[160:167], v3
  v_smfmac_f32_16x16x64_bf16 v[52:55], v[88:91], v[240:247], v3
  s_waitcnt lgkmcnt(0)
  v_smfmac_f32_16x16x64_bf16 v[48:51], v[92:95], v[168:175], v3
  v_smfmac_f32_16x16x64_bf16 v[52:55], v[92:95], v[248:255], v3
  s_nop 6
  v_add_f32 v28, v48, v50
  v_add_f32 v29, v49, v51
  v_add_f32 v30, v52, v54
  v_add_f32 v31, v53, v55
  v_cvt_pk_bf16_f32 v28, v28, v29
  v_cvt_pk_bf16_f32 v29, v30, v31
  ds_write_b64 v8, v[28:29] offset:10240
  s_waitcnt lgkmcnt(0)
  s_barrier
  ds_read_b64_tr_b16 v[32:33], v9 offset:10240
  ds_read_b64_tr_b16 v[34:35], v9 offset:10752
  ds_read_b64_tr_b16 v[36:37], v9 offset:11264
  ds_read_b64_tr_b16 v[38:39], v9 offset:11776
  s_cmp_lt_u32 s21, 2
  s_cbranch_scc0 Lq_w23F
  s_waitcnt lgkmcnt(2)
  v_mfma_f32_16x16x32_bf16 v[28:31], v[40:43], v[32:35], 0
  s_waitcnt lgkmcnt(0)
  v_mfma_f32_16x16x32_bf16 v[28:31], v[44:47], v[36:39], v[28:31]
  s_mov_b64 exec, s[42:43]
  s_nop 6
  v_and_or_b32 v28, v28, -2, s23
  buffer_store_dwordx4 v[28:31], v4, s[4:7], s35 offen
  ds_write_b128 v4, v[28:31] offset:12288
  s_mov_b64 exec, -1
  s_branch Lq_b3F
.p2align 5
  s_nop 0
  s_nop 0
  s_nop 0
  s_nop 0
  s_nop 0
  s_nop 0
Lq_w23F:
  s_cmp_eq_u32 s21, 3
  s_cbranch_scc0 Lq_b3F
Lq_w3F:
  s_cmp_eq_u32 s22, 63
  s_cbranch_scc0 Lq_smF
  v_mov_b32 v19, 63
  s_waitcnt vmcnt(0)
  buffer_store_dword v19, v17, s[4:7], 0 offen sc1
  s_barrier
  ds_read_b128 v[28:31], v2 offset:13824
  v_mov_b32 v18, 64
  s_waitcnt lgkmcnt(0)
  s_mov_b64 exec, s[44:45]
  buffer_store_dwordx4 v[32:35], v4, s[4:7], s29 offen sc1
  buffer_store_dwordx4 v[36:39], v4, s[4:7], s29 offen offset:512 sc1
  s_mov_b64 exec, -1
  buffer_store_dwordx4 v[28:31], v2, s[4:7], s29 offen offset:1024 sc1
  s_add_u32 s29, s29, 196608
  s_waitcnt vmcnt(0)
  buffer_store_dword v18, v17, s[4:7], 0 offen sc1
  s_branch Lrec_done
.p2align 5
  s_nop 0
  s_nop 0
  s_nop 0
  s_nop 0
Lq_smF:
  s_waitcnt lgkmcnt(2)
  v_mfma_f32_16x16x32_bf16 v[28:31], v[32:35], v[32:35], 0
  s_waitcnt lgkmcnt(0)
  v_mfma_f32_16x16x32_bf16 v[28:31], v[36:39], v[36:39], v[28:31]
  v_mov_b32 v48, 0
  v_mov_b32 v49, 0
  v_mov_b32 v50, 0
  v_mov_b32 v51, 0
  v_mov_b32 v52, 0
  v_mov_b32 v53, 0
  s_mov_b64 exec, s[42:43]
  s_nop 0
  v_and_or_b32 v30, v30, -2, s23
  v_and_or_b32 v31, v31, -2, s23
  buffer_store_dwordx2 v[30:31], v16, s[4:7], s35 offen
  ds_write_b64 v16, v[30:31] offset:12288
  s_mov_b64 exec, -1
  v_mov_b32 v54, 0
  v_mov_b32 v55, 0
  ds_read_b32 v60, v5 offset:12288
  s_barrier
  buffer_load_dwordx4 v[64:67], v2, s[4:7], s33 offen sc1
  buffer_load_dwordx4 v[68:71], v2, s[4:7], s34 offen sc1
  buffer_load_dword v72, v5, s[4:7], s33 offen sc1
  buffer_load_dword v73, v5, s[4:7], s34 offen sc1
  ds_read_b128 v[56:59], v2 offset:12288
  s_sleep 2
  buffer_load_dwordx4 v[74:77], v2, s[4:7], s33 offen sc1
  buffer_load_dwordx4 v[78:81], v2, s[4:7], s34 offen sc1
  buffer_load_dword v82, v5, s[4:7], s33 offen sc1
  buffer_load_dword v83, v5, s[4:7], s34 offen sc1
  s_branch Lh1f_141
.p2align 5
Lh1_139:
  buffer_load_dwordx4 v[74:77], v2, s[4:7], s33 offen sc1
  buffer_load_dwordx4 v[78:81], v2, s[4:7], s34 offen sc1
  buffer_load_dword v82, v5, s[4:7], s33 offen sc1
  buffer_load_dword v83, v5, s[4:7], s34 offen sc1
Lh1f_141:
  s_waitcnt vmcnt(7) lgkmcnt(0)
  v_pk_add_f32 v[20:21], v[56:57], v[64:65]
  v_pk_add_f32 v[22:23], v[58:59], v[66:67]
  s_waitcnt vmcnt(6)
  v_bitop3_b32 v12, v64, v68, s23 bitop3:0x7e
  v_pk_add_f32 v[20:21], v[20:21], v[68:69]
  v_pk_add_f32 v[22:23], v[22:23], v[70:71]
  s_waitcnt vmcnt(4)
  v_bitop3_b32 v13, v72, v73, s23 bitop3:0x7e
  v_add_f32 v24, v60, v72
  v_bitop3_b32 v12, v12, v13, 1 bitop3:0xa8
  v_add_f32 v24, v24, v73
  v_cmp_ne_u32 vcc, 0, v12
  v_max3_f32 v25, v20, v21, v22
  v_max3_f32 v25, v25, v23, v24
  s_cbranch_vccz Lh1d_140
  buffer_load_dwordx4 v[64:67], v2, s[4:7], s33 offen sc1
  buffer_load_dwordx4 v[68:71], v2, s[4:7], s34 offen sc1
  buffer_load_dword v72, v5, s[4:7], s33 offen sc1
  buffer_load_dword v73, v5, s[4:7], s34 offen sc1
  s_waitcnt vmcnt(7) lgkmcnt(0)
  v_pk_add_f32 v[20:21], v[56:57], v[74:75]
  v_pk_add_f32 v[22:23], v[58:59], v[76:77]
  s_waitcnt vmcnt(6)
  v_bitop3_b32 v12, v74, v78, s23 bitop3:0x7e
  v_pk_add_f32 v[20:21], v[20:21], v[78:79]
  v_pk_add_f32 v[22:23], v[22:23], v[80:81]
  s_waitcnt vmcnt(4)
  v_bitop3_b32 v13, v82, v83, s23 bitop3:0x7e
  v_add_f32 v24, v60, v82
  v_bitop3_b32 v12, v12, v13, 1 bitop3:0xa8
  v_add_f32 v24, v24, v83
  v_cmp_ne_u32 vcc, 0, v12
  v_max3_f32 v25, v20, v21, v22
  v_max3_f32 v25, v25, v23, v24
  s_cbranch_vccz Lh1d_140
  s_sub_u32 s24, s24, 1
  s_cbranch_scc0 Lh1_139
  s_branch Lrec_fail
.p2align 5
  s_nop 0
  s_nop 0
Lh1d_140:
  s_nop 0
  v_max_f32_dpp v26, v25, v25 quad_perm:[2,3,0,1] row_mask:0xf bank_mask:0xf
  v_max_f32_dpp v27, v25, v25 quad_perm:[2,3,0,1] row_mask:0xf bank_mask:0xf
  s_nop 1
  v_permlane16_swap_b32 v26, v27
  v_max_f32 v25, v26, v27
  v_max_f32 v27, v26, v27
  s_nop 1
  v_permlane32_swap_b32 v25, v27
  v_max_f32 v25, v25, v27
  v_mul_f32 v25, s37, v25
  v_fma_f32 v20, v20, s37, -v25
  v_fma_f32 v21, v21, s37, -v25
  v_exp_f32 v20, v20
  v_fma_f32 v22, v22, s37, -v25
  v_exp_f32 v21, v21
  v_fma_f32 v23, v23, s37, -v25
  v_exp_f32 v22, v22
  v_fma_f32 v24, v24, s37, -v25
  v_exp_f32 v23, v23
  v_add_f32 v26, v20, v21
  v_exp_f32 v24, v24
  v_add_f32 v26, v26, v22
  v_add_f32 v26, v26, v23
  v_add_f32 v26, v26, v24
  s_nop 1
  v_add_f32_dpp v27, v26, v26 quad_perm:[2,3,0,1] row_mask:0xf bank_mask:0xf
  v_add_f32_dpp v26, v26, v26 quad_perm:[2,3,0,1] row_mask:0xf bank_mask:0xf
  s_nop 1
  v_permlane16_swap_b32 v26, v27
  v_add_f32 v25, v26, v27
  v_add_f32 v27, v26, v27
  s_nop 1
  v_permlane32_swap_b32 v25, v27
  v_add_f32 v25, v25, v27
  v_rcp_f32 v26, v25
  s_barrier
  ds_read_b128 v[28:31], v2 offset:13824
  s_mov_b64 exec, s[44:45]
  buffer_store_dwordx4 v[32:35], v4, s[4:7], s29 offen sc1
  buffer_store_dwordx4 v[36:39], v4, s[4:7], s29 offen offset:512 sc1
  s_mov_b64 exec, -1
  v_pk_mul_f32 v[20:21], v[20:21], v[26:27] op_sel_hi:[1,0]
  v_pk_mul_f32 v[22:23], v[22:23], v[26:27] op_sel_hi:[1,0]
  v_mul_f32 v24, v24, v26
  v_cvt_pk_bf16_f32 v20, v20, v21
  v_cvt_pk_bf16_f32 v21, v22, v23
  v_cvt_pk_bf16_f32 v24, v24, v24
  ds_write_b64 v14, v[20:21] offset:35840
  ds_write_b16 v15, v24 offset:36352
  s_waitcnt lgkmcnt(2)
  buffer_store_dwordx4 v[28:31], v2, s[4:7], s29 offen offset:1024 sc1
  s_add_u32 s29, s29, 196608
  s_waitcnt lgkmcnt(0)
  s_barrier
  s_branch Lq_ldF
.p2align 5
  s_nop 0
  s_nop 0
  s_nop 0
  s_nop 0
  s_nop 0
  s_nop 0
Lq_b3F:
  s_cmp_eq_u32 s22, 63
  s_waitcnt lgkmcnt(0)
  s_barrier
  s_cbranch_scc1 Lrec_done
  s_cmp_eq_u32 s21, 2
  s_cbranch_scc1 Lq_x2F
  s_sleep 1
  buffer_load_dwordx4 v[84:87], v2, s[4:7], s90 offen offset:2048 sc1
  s_sleep 2
Lvm_142:
  buffer_load_dwordx4 v[88:91], v2, s[4:7], s90 offen offset:2048 sc1
  s_waitcnt vmcnt(1)
  ds_write_b128 v7, v[84:87] offset:33792
  v_bitop3_b32 v12, v84, s23, 1 bitop3:0x28
  v_cmp_ne_u32 vcc, 0, v12
  s_cbranch_vccz Lvmd_143
  buffer_load_dwordx4 v[84:87], v2, s[4:7], s90 offen offset:2048 sc1
  s_waitcnt vmcnt(1)
  ds_write_b128 v7, v[88:91] offset:33792
  v_bitop3_b32 v12, v88, s23, 1 bitop3:0x28
  v_cmp_ne_u32 vcc, 0, v12
  s_cbranch_vccz Lvmd_143
  s_sub_u32 s24, s24, 1
  s_cbranch_scc0 Lvm_142
  s_branch Lrec_fail
.p2align 5
  s_nop 0
  s_nop 0
  s_nop 0
Lvmd_143:
  s_waitcnt lgkmcnt(0)
Lq_x2F:
  s_barrier
  s_setprio 0
  v_mov_b32 v48, 0
  v_mov_b32 v49, 0
  v_mov_b32 v50, 0
  v_mov_b32 v51, 0
  v_mov_b32 v52, 0
  v_mov_b32 v53, 0
  v_mov_b32 v54, 0
  v_mov_b32 v55, 0
  s_cmp_eq_u32 s36, 0
  s_cbranch_scc1 Lq_b4F
  s_cmp_eq_u32 s21, 0
  s_cbranch_scc1 Lq_b4F
  s_cmp_eq_u32 s21, 1
  s_cbranch_scc0 Lq_rsF
  buffer_store_dwordx2 v[24:25], v23, s[4:7], s27 offen
  s_branch Lq_b4F
.p2align 5
  s_nop 0
  s_nop 0
  s_nop 0
Lq_rsF:
  s_branch Lq_b4F
.p2align 5
Lq_ldF:
  s_setprio 0
  s_mov_b32 s91, 1
  v_mov_b32 v19, s22
  v_add_u32 v13, 1, v19
  s_mov_b32 s96, 38912
  s_barrier
  s_setprio 2
  s_barrier
Lq_lk2F:
  s_waitcnt vmcnt(0)
  s_add_u32 s22, s22, 1
  s_xor_b32 s23, s23, 1
  s_mov_b32 s38, s25
  s_mov_b32 s25, s26
  s_mov_b32 s26, s27
  s_mov_b32 s27, s38
  s_mov_b32 s38, s84
  s_mov_b32 s84, s85
  s_mov_b32 s85, s86
  s_mov_b32 s86, s38
  s_branch Lq_b1F
.p2align 5
  s_nop 0
  s_nop 0
  s_nop 0
  s_nop 0
  s_nop 0
  s_nop 0
  s_nop 0
Lq_b4F:
  s_waitcnt lgkmcnt(0)
  s_barrier
  s_setprio 2
  ds_read_b128 v[40:43], v11 offset:16384
  ds_read_b128 v[44:47], v11 offset:17408
  s_cmp_eq_u32 s36, 0
  s_cbranch_scc1 Lq_noredF
  s_cmp_lt_u32 s21, 2
  s_cbranch_scc0 Lq_noredF
  s_cmp_eq_u32 s21, 1
  s_cbranch_scc1 Lq_rdF
  s_sleep 7
  buffer_load_dwordx4 v[56:59], v2, s[4:7], s99 offen offset:0 sc1
  buffer_load_dwordx4 v[60:63], v2, s[4:7], s99 offen offset:1024 sc1
  buffer_load_dwordx4 v[64:67], v2, s[4:7], s99 offen offset:2048 sc1
  buffer_load_dwordx4 v[68:71], v2, s[4:7], s99 offen offset:3072 sc1
  s_sleep 2
  s_add_u32 s88, s84, 163840
Lr_144:
  buffer_load_dwordx4 v[72:75], v2, s[4:7], s99 offen offset:0 sc1
  buffer_load_dwordx4 v[76:79], v2, s[4:7], s99 offen offset:1024 sc1
  buffer_load_dwordx4 v[80:83], v2, s[4:7], s99 offen offset:2048 sc1
  buffer_load_dwordx4 v[84:87], v2, s[4:7], s99 offen offset:3072 sc1
  s_waitcnt vmcnt(7)
  v_mfma_f32_16x16x32_bf16 v[28:31], v[20:23], v[56:59], 0
  s_waitcnt vmcnt(6)
  v_mfma_f32_16x16x32_bf16 v[28:31], v[20:23], v[60:63], v[28:31]
  v_bitop3_b32 v12, v56, v60, s23 bitop3:0x7e
  s_waitcnt vmcnt(5)
  v_mfma_f32_16x16x32_bf16 v[28:31], v[24:27], v[64:67], v[28:31]
  s_waitcnt vmcnt(4)
  v_mfma_f32_16x16x32_bf16 v[28:31], v[24:27], v[68:71], v[28:31]
  v_bitop3_b32 v13, v64, v68, s23 bitop3:0x7e
  v_bitop3_b32 v12, v12, v13, 1 bitop3:0xa8
  v_cmp_ne_u32 vcc, 0, v12
  s_cbranch_vccnz Lx2_146
  s_nop 3
  v_and_or_b32 v28, v28, -2, s23
  buffer_store_dwordx4 v[28:31], v10, s[4:7], s84 offen sc1
  s_branch Lrd_145
Lx2_146:
  buffer_load_dwordx4 v[56:59], v2, s[4:7], s99 offen offset:0 sc1
  buffer_load_dwordx4 v[60:63], v2, s[4:7], s99 offen offset:1024 sc1
  buffer_load_dwordx4 v[64:67], v2, s[4:7], s99 offen offset:2048 sc1
  buffer_load_dwordx4 v[68:71], v2, s[4:7], s99 offen offset:3072 sc1
  s_waitcnt vmcnt(7)
  v_mfma_f32_16x16x32_bf16 v[28:31], v[20:23], v[72:75], 0
  s_waitcnt vmcnt(6)
  v_mfma_f32_16x16x32_bf16 v[28:31], v[20:23], v[76:79], v[28:31]
  v_bitop3_b32 v12, v72, v76, s23 bitop3:0x7e
  s_waitcnt vmcnt(5)
  v_mfma_f32_16x16x32_bf16 v[28:31], v[24:27], v[80:83], v[28:31]
  s_waitcnt vmcnt(4)
  v_mfma_f32_16x16x32_bf16 v[28:31], v[24:27], v[84:87], v[28:31]
  v_bitop3_b32 v13, v80, v84, s23 bitop3:0x7e
  v_bitop3_b32 v12, v12, v13, 1 bitop3:0xa8
  v_cmp_ne_u32 vcc, 0, v12
  s_cbranch_vccnz Lx2_147
  s_nop 3
  v_and_or_b32 v28, v28, -2, s23
  buffer_store_dwordx4 v[28:31], v10, s[4:7], s84 offen sc1
  s_branch Lrd_145
Lx2_147:
  s_sub_u32 s24, s24, 1
  s_cbranch_scc0 Lr_144
  s_branch Lrec_fail
.p2align 5
  s_nop 0
  s_nop 0
  s_nop 0
  s_nop 0
  s_nop 0
  s_nop 0
Lrd_145:
  ds_write_b128 v2, v[28:31] offset:14848
  buffer_store_dwordx4 v[28:31], v10, s[4:7], s88 offen sc1
  s_waitcnt lgkmcnt(0)
  s_barrier
  s_waitcnt vmcnt(2)
  s_branch Lq_advF
.p2align 5
  s_nop 0
  s_nop 0
  s_nop 0
  s_nop 0
  s_nop 0
  s_nop 0
  s_nop 0
Lq_rdF:
  s_add_u32 s88, s84, 163840
  s_barrier
  s_sleep 3
  buffer_load_dwordx4 v[56:59], v20, s[4:7], s84 offen sc1
  buffer_load_dwordx4 v[60:63], v21, s[4:7], s84 offen sc1
  buffer_load_dwordx4 v[64:67], v22, s[4:7], s84 offen sc1
  ds_read_b128 v[28:31], v2 offset:14848
  s_sleep 4
Lh3_148:
  buffer_load_dwordx4 v[68:71], v20, s[4:7], s88 offen sc1
  buffer_load_dwordx4 v[72:75], v21, s[4:7], s88 offen sc1
  buffer_load_dwordx4 v[76:79], v22, s[4:7], s88 offen sc1
  s_waitcnt vmcnt(5) lgkmcnt(0)
  v_pk_add_f32 v[32:33], v[28:29], v[56:57]
  v_pk_add_f32 v[34:35], v[30:31], v[58:59]
  s_waitcnt vmcnt(4)
  v_bitop3_b32 v12, v56, v60, s23 bitop3:0x7e
  v_pk_add_f32 v[32:33], v[32:33], v[60:61]
  v_pk_add_f32 v[34:35], v[34:35], v[62:63]
  s_waitcnt vmcnt(3)
  v_bitop3_b32 v12, v12, v64, s23 bitop3:0xf6
  v_and_b32 v12, 1, v12
  v_cmp_ne_u32 vcc, 0, v12
  v_pk_add_f32 v[32:33], v[32:33], v[64:65]
  v_pk_add_f32 v[34:35], v[34:35], v[66:67]
  v_cvt_pk_bf16_f32 v32, v32, v33
  v_cvt_pk_bf16_f32 v33, v34, v35
  v_min_u32 v32, -2, v32
  s_cbranch_vccnz Lx3_150
  buffer_store_dwordx2 v[32:33], v23, s[4:7], s26 offen
  s_branch Lh3d_149
.p2align 5
Lx3_150:
  buffer_load_dwordx4 v[56:59], v20, s[4:7], s84 offen sc1
  buffer_load_dwordx4 v[60:63], v21, s[4:7], s84 offen sc1
  buffer_load_dwordx4 v[64:67], v22, s[4:7], s84 offen sc1
  s_waitcnt vmcnt(5) lgkmcnt(0)
  v_pk_add_f32 v[32:33], v[28:29], v[68:69]
  v_pk_add_f32 v[34:35], v[30:31], v[70:71]
  s_waitcnt vmcnt(4)
  v_bitop3_b32 v12, v68, v72, s23 bitop3:0x7e
  v_pk_add_f32 v[32:33], v[32:33], v[72:73]
  v_pk_add_f32 v[34:35], v[34:35], v[74:75]
  s_waitcnt vmcnt(3)
  v_bitop3_b32 v12, v12, v76, s23 bitop3:0xf6
  v_and_b32 v12, 1, v12
  v_cmp_ne_u32 vcc, 0, v12
  v_pk_add_f32 v[32:33], v[32:33], v[76:77]
  v_pk_add_f32 v[34:35], v[34:35], v[78:79]
  v_cvt_pk_bf16_f32 v32, v32, v33
  v_cvt_pk_bf16_f32 v33, v34, v35
  v_min_u32 v32, -2, v32
  s_cbranch_vccnz Lx3_151
  buffer_store_dwordx2 v[32:33], v23, s[4:7], s26 offen
  s_branch Lh3d_149
.p2align 5
Lx3_151:
  s_sub_u32 s24, s24, 1
  s_cbranch_scc0 Lh3_148
  s_branch Lrec_fail
.p2align 5
  s_nop 0
  s_nop 0
  s_nop 0
  s_nop 0
  s_nop 0
Lh3d_149:
  s_add_u32 s22, s22, 1
  s_xor_b32 s23, s23, 1
  s_mov_b32 s38, s25
  s_mov_b32 s25, s26
  s_mov_b32 s26, s27
  s_mov_b32 s27, s38
  s_mov_b32 s38, s84
  s_mov_b32 s84, s85
  s_mov_b32 s85, s86
  s_mov_b32 s86, s38
  s_barrier
  s_waitcnt vmcnt(1)
  s_branch Lq_b1F
.p2align 5
  s_nop 0
Lq_noredF:
  s_barrier
  s_waitcnt vmcnt(0)
Lq_advF:
  s_add_u32 s22, s22, 1
  s_xor_b32 s23, s23, 1
  s_mov_b32 s38, s25
  s_mov_b32 s25, s26
  s_mov_b32 s26, s27
  s_mov_b32 s27, s38
  s_mov_b32 s38, s84
  s_mov_b32 s84, s85
  s_mov_b32 s85, s86
  s_mov_b32 s86, s38
  s_barrier
  s_branch Lq_loopF
Lq_loopS:
  s_cmp_eq_u32 s21, 2
  s_cbranch_scc0 Lq_b1S
  s_sleep 2
Lg_152:
  buffer_load_dwordx4 v[56:59], v6, s[4:7], s25 offen sc1
  buffer_load_dwordx4 v[60:63], v6, s[4:7], s25 offen offset:1024 sc1
  s_waitcnt vmcnt(1)
  ds_write_b128 v6, v[56:59] offset:0
  v_max_u32 v64, v56, v58
  s_waitcnt vmcnt(0)
  ds_write_b128 v6, v[60:63] offset:1024
  v_max3_u32 v64, v64, v60, v62
  v_cmp_eq_u32 vcc, -1, v64
  s_cbranch_vccz Lgd_153
  s_mov_b64 exec, vcc
  s_sub_u32 s24, s24, 1
  s_cbranch_scc0 Lg_152
  s_branch Lrec_fail
Lgd_153:
  s_mov_b64 exec, -1
  s_waitcnt lgkmcnt(0)
Lq_b1S:
  s_waitcnt lgkmcnt(0)
  s_barrier
  ds_read_b128 v[56:59], v2 offset:0
  ds_read_b128 v[60:63], v2 offset:1024
  ds_read_b128 v[64:67], v2 offset:2048
  ds_read_b128 v[68:71], v2 offset:3072
  ds_read_b128 v[72:75], v2 offset:4096
  ds_read_b128 v[76:79], v2 offset:5120
  ds_read_b128 v[80:83], v2 offset:6144
  ds_read_b128 v[84:87], v2 offset:7168
  ds_read_b128 v[88:91], v2 offset:8192
  ds_read_b128 v[92:95], v2 offset:9216
  s_waitcnt lgkmcnt(9)
  v_smfmac_f32_16x16x64_bf16 v[48:51], v[56:59], v[96:103], v3
  v_smfmac_f32_16x16x64_bf16 v[52:55], v[56:59], v[176:183], v3
  s_waitcnt lgkmcnt(8)
  v_smfmac_f32_16x16x64_bf16 v[48:51], v[60:63], v[104:111], v3
  v_smfmac_f32_16x16x64_bf16 v[52:55], v[60:63], v[184:191], v3
  s_cmp_eq_u32 s91, 0
  s_cbranch_scc1 Lq_nkmS
  buffer_store_dword v13, v17, s[4:7], 0 offen sc1
  buffer_store_dword v13, v17, s[4:7], s96 offen sc1
Lq_nkmS:
  s_waitcnt lgkmcnt(7)
  v_smfmac_f32_16x16x64_bf16 v[48:51], v[64:67], v[112:119], v3
  v_smfmac_f32_16x16x64_bf16 v[52:55], v[64:67], v[192:199], v3
  s_waitcnt lgkmcnt(6)
  v_smfmac_f32_16x16x64_bf16 v[48:51], v[68:71], v[120:127], v3
  v_smfmac_f32_16x16x64_bf16 v[52:55], v[68:71], v[200:207], v3
  s_waitcnt lgkmcnt(5)
  v_smfmac_f32_16x16x64_bf16 v[48:51], v[72:75], v[128:135], v3
  v_smfmac_f32_16x16x64_bf16 v[52:55], v[72:75], v[208:215], v3
  s_waitcnt lgkmcnt(4)
  v_smfmac_f32_16x16x64_bf16 v[48:51], v[76:79], v[136:143], v3
  v_smfmac_f32_16x16x64_bf16 v[52:55], v[76:79], v[216:223], v3
  s_waitcnt lgkmcnt(3)
  v_smfmac_f32_16x16x64_bf16 v[48:51], v[80:83], v[144:151], v3
  v_smfmac_f32_16x16x64_bf16 v[52:55], v[80:83], v[224:231], v3
  s_waitcnt lgkmcnt(2)
  v_smfmac_f32_16x16x64_bf16 v[48:51], v[84:87], v[152:159], v3
  v_smfmac_f32_16x16x64_bf16 v[52:55], v[84:87], v[232:239], v3
  s_waitcnt lgkmcnt(1)
  v_smfmac_f32_16x16x64_bf16 v[48:51], v[88:91], v[160:167], v3
  v_smfmac_f32_16x16x64_bf16 v[52:55], v[88:91], v[240:247], v3
  s_waitcnt lgkmcnt(0)
  v_smfmac_f32_16x16x64_bf16 v[48:51], v[92:95], v[168:175], v3
  v_smfmac_f32_16x16x64_bf16 v[52:55], v[92:95], v[248:255], v3
  s_nop 6
  v_add_f32 v28, v48, v50
  v_add_f32 v29, v49, v51
  v_add_f32 v30, v52, v54
  v_add_f32 v31, v53, v55
  v_cvt_pk_bf16_f32 v28, v28, v29
  v_cvt_pk_bf16_f32 v29, v30, v31
  ds_write_b64 v8, v[28:29] offset:10240
  s_waitcnt lgkmcnt(0)
  s_barrier
  ds_read_b64_tr_b16 v[32:33], v9 offset:10240
  ds_read_b64_tr_b16 v[34:35], v9 offset:10752
  ds_read_b64_tr_b16 v[36:37], v9 offset:11264
  ds_read_b64_tr_b16 v[38:39], v9 offset:11776
  s_cmp_lt_u32 s21, 2
  s_cbranch_scc0 Lq_w23S
  s_waitcnt lgkmcnt(2)
  v_mfma_f32_16x16x32_bf16 v[28:31], v[40:43], v[32:35], 0
  s_waitcnt lgkmcnt(0)
  v_mfma_f32_16x16x32_bf16 v[28:31], v[44:47], v[36:39], v[28:31]
  s_mov_b64 exec, s[42:43]
  s_nop 6
  v_and_or_b32 v28, v28, -2, s23
  buffer_store_dwordx4 v[28:31], v4, s[4:7], s35 offen sc1
  ds_write_b128 v4, v[28:31] offset:12288
  s_mov_b64 exec, -1
  s_branch Lq_b3S
Lq_w23S:
  s_cmp_eq_u32 s21, 3
  s_cbranch_scc0 Lq_b3S
Lq_w3S:
  s_cmp_eq_u32 s22, 63
  s_cbranch_scc0 Lq_smS
  v_mov_b32 v19, 63
  s_waitcnt vmcnt(0)
  buffer_store_dword v19, v17, s[4:7], 0 offen sc1
  s_barrier
  ds_read_b128 v[28:31], v2 offset:13824
  v_mov_b32 v18, 64
  s_waitcnt lgkmcnt(0)
  s_mov_b64 exec, s[44:45]
  buffer_store_dwordx4 v[32:35], v4, s[4:7], s29 offen sc1
  buffer_store_dwordx4 v[36:39], v4, s[4:7], s29 offen offset:512 sc1
  s_mov_b64 exec, -1
  buffer_store_dwordx4 v[28:31], v2, s[4:7], s29 offen offset:1024 sc1
  s_add_u32 s29, s29, 196608
  s_waitcnt vmcnt(0)
  buffer_store_dword v18, v17, s[4:7], 0 offen sc1
  s_branch Lrec_done
Lq_smS:
  s_waitcnt lgkmcnt(2)
  v_mfma_f32_16x16x32_bf16 v[28:31], v[32:35], v[32:35], 0
  s_waitcnt lgkmcnt(0)
  v_mfma_f32_16x16x32_bf16 v[28:31], v[36:39], v[36:39], v[28:31]
  v_mov_b32 v48, 0
  v_mov_b32 v49, 0
  v_mov_b32 v50, 0
  v_mov_b32 v51, 0
  v_mov_b32 v52, 0
  v_mov_b32 v53, 0
  s_mov_b64 exec, s[42:43]
  s_nop 0
  v_and_or_b32 v30, v30, -2, s23
  v_and_or_b32 v31, v31, -2, s23
  buffer_store_dwordx2 v[30:31], v16, s[4:7], s35 offen sc1
  ds_write_b64 v16, v[30:31] offset:12288
  s_mov_b64 exec, -1
  v_mov_b32 v54, 0
  v_mov_b32 v55, 0
  ds_read_b32 v60, v5 offset:12288
  s_barrier
  buffer_load_dwordx4 v[64:67], v2, s[4:7], s33 offen sc1
  buffer_load_dwordx4 v[68:71], v2, s[4:7], s34 offen sc1
  buffer_load_dword v72, v5, s[4:7], s33 offen sc1
  buffer_load_dword v73, v5, s[4:7], s34 offen sc1
  ds_read_b128 v[56:59], v2 offset:12288
  s_sleep 2
  buffer_load_dwordx4 v[74:77], v2, s[4:7], s33 offen sc1
  buffer_load_dwordx4 v[78:81], v2, s[4:7], s34 offen sc1
  buffer_load_dword v82, v5, s[4:7], s33 offen sc1
  buffer_load_dword v83, v5, s[4:7], s34 offen sc1
  s_branch Lh1f_156
Lh1_154:
  buffer_load_dwordx4 v[74:77], v2, s[4:7], s33 offen sc1
  buffer_load_dwordx4 v[78:81], v2, s[4:7], s34 offen sc1
  buffer_load_dword v82, v5, s[4:7], s33 offen sc1
  buffer_load_dword v83, v5, s[4:7], s34 offen sc1
Lh1f_156:
  s_waitcnt vmcnt(7) lgkmcnt(0)
  v_pk_add_f32 v[20:21], v[56:57], v[64:65]
  v_pk_add_f32 v[22:23], v[58:59], v[66:67]
  s_waitcnt vmcnt(6)
  v_bitop3_b32 v12, v64, v68, s23 bitop3:0x7e
  v_pk_add_f32 v[20:21], v[20:21], v[68:69]
  v_pk_add_f32 v[22:23], v[22:23], v[70:71]
  s_waitcnt vmcnt(4)
  v_bitop3_b32 v13, v72, v73, s23 bitop3:0x7e
  v_add_f32 v24, v60, v72
  v_bitop3_b32 v12, v12, v13, 1 bitop3:0xa8
  v_add_f32 v24, v24, v73
  v_cmp_ne_u32 vcc, 0, v12
  v_max3_f32 v25, v20, v21, v22
  v_max3_f32 v25, v25, v23, v24
  s_cbranch_vccz Lh1d_155
  buffer_load_dwordx4 v[64:67], v2, s[4:7], s33 offen sc1
  buffer_load_dwordx4 v[68:71], v2, s[4:7], s34 offen sc1
  buffer_load_dword v72, v5, s[4:7], s33 offen sc1
  buffer_load_dword v73, v5, s[4:7], s34 offen sc1
  s_waitcnt vmcnt(7) lgkmcnt(0)
  v_pk_add_f32 v[20:21], v[56:57], v[74:75]
  v_pk_add_f32 v[22:23], v[58:59], v[76:77]
  s_waitcnt vmcnt(6)
  v_bitop3_b32 v12, v74, v78, s23 bitop3:0x7e
  v_pk_add_f32 v[20:21], v[20:21], v[78:79]
  v_pk_add_f32 v[22:23], v[22:23], v[80:81]
  s_waitcnt vmcnt(4)
  v_bitop3_b32 v13, v82, v83, s23 bitop3:0x7e
  v_add_f32 v24, v60, v82
  v_bitop3_b32 v12, v12, v13, 1 bitop3:0xa8
  v_add_f32 v24, v24, v83
  v_cmp_ne_u32 vcc, 0, v12
  v_max3_f32 v25, v20, v21, v22
  v_max3_f32 v25, v25, v23, v24
  s_cbranch_vccz Lh1d_155
  s_sub_u32 s24, s24, 1
  s_cbranch_scc0 Lh1_154
  s_branch Lrec_fail
Lh1d_155:
  s_nop 0
  v_max_f32_dpp v26, v25, v25 quad_perm:[2,3,0,1] row_mask:0xf bank_mask:0xf
  v_max_f32_dpp v27, v25, v25 quad_perm:[2,3,0,1] row_mask:0xf bank_mask:0xf
  s_nop 1
  v_permlane16_swap_b32 v26, v27
  v_max_f32 v25, v26, v27
  v_max_f32 v27, v26, v27
  s_nop 1
  v_permlane32_swap_b32 v25, v27
  v_max_f32 v25, v25, v27
  v_mul_f32 v25, s37, v25
  v_fma_f32 v20, v20, s37, -v25
  v_fma_f32 v21, v21, s37, -v25
  v_exp_f32 v20, v20
  v_fma_f32 v22, v22, s37, -v25
  v_exp_f32 v21, v21
  v_fma_f32 v23, v23, s37, -v25
  v_exp_f32 v22, v22
  v_fma_f32 v24, v24, s37, -v25
  v_exp_f32 v23, v23
  v_add_f32 v26, v20, v21
  v_exp_f32 v24, v24
  v_add_f32 v26, v26, v22
  v_add_f32 v26, v26, v23
  v_add_f32 v26, v26, v24
  s_nop 1
  v_add_f32_dpp v27, v26, v26 quad_perm:[2,3,0,1] row_mask:0xf bank_mask:0xf
  v_add_f32_dpp v26, v26, v26 quad_perm:[2,3,0,1] row_mask:0xf bank_mask:0xf
  s_nop 1
  v_permlane16_swap_b32 v26, v27
  v_add_f32 v25, v26, v27
  v_add_f32 v27, v26, v27
  s_nop 1
  v_permlane32_swap_b32 v25, v27
  v_add_f32 v25, v25, v27
  v_rcp_f32 v26, v25
  s_barrier
  ds_read_b128 v[28:31], v2 offset:13824
  s_mov_b64 exec, s[44:45]
  buffer_store_dwordx4 v[32:35], v4, s[4:7], s29 offen sc1
  buffer_store_dwordx4 v[36:39], v4, s[4:7], s29 offen offset:512 sc1
  s_mov_b64 exec, -1
  v_pk_mul_f32 v[20:21], v[20:21], v[26:27] op_sel_hi:[1,0]
  v_pk_mul_f32 v[22:23], v[22:23], v[26:27] op_sel_hi:[1,0]
  v_mul_f32 v24, v24, v26
  v_cvt_pk_bf16_f32 v20, v20, v21
  v_cvt_pk_bf16_f32 v21, v22, v23
  v_cvt_pk_bf16_f32 v24, v24, v24
  ds_write_b64 v14, v[20:21] offset:35840
  ds_write_b16 v15, v24 offset:36352
  s_waitcnt lgkmcnt(2)
  buffer_store_dwordx4 v[28:31], v2, s[4:7], s29 offen offset:1024 sc1
  s_add_u32 s29, s29, 196608
  s_waitcnt lgkmcnt(0)
  s_barrier
  s_branch Lq_ldS
Lq_b3S:
  s_cmp_eq_u32 s22, 63
  s_waitcnt lgkmcnt(0)
  s_barrier
  s_cbranch_scc1 Lrec_done
  s_cmp_eq_u32 s21, 2
  s_cbranch_scc1 Lq_x2S
  s_sleep 1
  buffer_load_dwordx4 v[84:87], v2, s[4:7], s90 offen offset:2048 sc1
  s_sleep 2
Lvm_157:
  buffer_load_dwordx4 v[88:91], v2, s[4:7], s90 offen offset:2048 sc1
  s_waitcnt vmcnt(1)
  ds_write_b128 v7, v[84:87] offset:33792
  v_bitop3_b32 v12, v84, s23, 1 bitop3:0x28
  v_cmp_ne_u32 vcc, 0, v12
  s_cbranch_vccz Lvmd_158
  buffer_load_dwordx4 v[84:87], v2, s[4:7], s90 offen offset:2048 sc1
  s_waitcnt vmcnt(1)
  ds_write_b128 v7, v[88:91] offset:33792
  v_bitop3_b32 v12, v88, s23, 1 bitop3:0x28
  v_cmp_ne_u32 vcc, 0, v12
  s_cbranch_vccz Lvmd_158
  s_sub_u32 s24, s24, 1
  s_cbranch_scc0 Lvm_157
  s_branch Lrec_fail
Lvmd_158:
  s_waitcnt lgkmcnt(0)
Lq_x2S:
  s_barrier
  s_setprio 0
  v_mov_b32 v48, 0
  v_mov_b32 v49, 0
  v_mov_b32 v50, 0
  v_mov_b32 v51, 0
  v_mov_b32 v52, 0
  v_mov_b32 v53, 0
  v_mov_b32 v54, 0
  v_mov_b32 v55, 0
  s_cmp_eq_u32 s36, 0
  s_cbranch_scc1 Lq_b4S
  s_cmp_eq_u32 s21, 0
  s_cbranch_scc1 Lq_b4S
  s_cmp_eq_u32 s21, 1
  s_cbranch_scc0 Lq_rsS
  buffer_store_dwordx2 v[24:25], v23, s[4:7], s27 offen sc1
  s_branch Lq_b4S
Lq_rsS:
  s_branch Lq_b4S
Lq_ldS:
  s_setprio 0
  s_mov_b32 s91, 1
  v_mov_b32 v19, s22
  v_add_u32 v13, 1, v19
  s_mov_b32 s96, 38912
  s_barrier
  s_setprio 2
  s_barrier
Lq_lk2S:
  s_waitcnt vmcnt(0)
  s_add_u32 s22, s22, 1
  s_xor_b32 s23, s23, 1
  s_mov_b32 s38, s25
  s_mov_b32 s25, s26
  s_mov_b32 s26, s27
  s_mov_b32 s27, s38
  s_mov_b32 s38, s84
  s_mov_b32 s84, s85
  s_mov_b32 s85, s86
  s_mov_b32 s86, s38
  s_branch Lq_b1S
Lq_b4S:
  s_waitcnt lgkmcnt(0)
  s_barrier
  s_setprio 2
  ds_read_b128 v[40:43], v11 offset:16384
  ds_read_b128 v[44:47], v11 offset:17408
  s_cmp_eq_u32 s36, 0
  s_cbranch_scc1 Lq_noredS
  s_cmp_lt_u32 s21, 2
  s_cbranch_scc0 Lq_noredS
  s_cmp_eq_u32 s21, 1
  s_cbranch_scc1 Lq_rdS
  s_sleep 7
  buffer_load_dwordx4 v[56:59], v2, s[4:7], s99 offen offset:0 sc1
  buffer_load_dwordx4 v[60:63], v2, s[4:7], s99 offen offset:1024 sc1
  buffer_load_dwordx4 v[64:67], v2, s[4:7], s99 offen offset:2048 sc1
  buffer_load_dwordx4 v[68:71], v2, s[4:7], s99 offen offset:3072 sc1
  s_sleep 2
  s_add_u32 s88, s84, 163840
Lr_159:
  buffer_load_dwordx4 v[72:75], v2, s[4:7], s99 offen offset:0 sc1
  buffer_load_dwordx4 v[76:79], v2, s[4:7], s99 offen offset:1024 sc1
  buffer_load_dwordx4 v[80:83], v2, s[4:7], s99 offen offset:2048 sc1
  buffer_load_dwordx4 v[84:87], v2, s[4:7], s99 offen offset:3072 sc1
  s_waitcnt vmcnt(7)
  v_mfma_f32_16x16x32_bf16 v[28:31], v[20:23], v[56:59], 0
  s_waitcnt vmcnt(6)
  v_mfma_f32_16x16x32_bf16 v[28:31], v[20:23], v[60:63], v[28:31]
  v_bitop3_b32 v12, v56, v60, s23 bitop3:0x7e
  s_waitcnt vmcnt(5)
  v_mfma_f32_16x16x32_bf16 v[28:31], v[24:27], v[64:67], v[28:31]
  s_waitcnt vmcnt(4)
  v_mfma_f32_16x16x32_bf16 v[28:31], v[24:27], v[68:71], v[28:31]
  v_bitop3_b32 v13, v64, v68, s23 bitop3:0x7e
  v_bitop3_b32 v12, v12, v13, 1 bitop3:0xa8
  v_cmp_ne_u32 vcc, 0, v12
  s_cbranch_vccnz Lx2_161
  s_nop 3
  v_and_or_b32 v28, v28, -2, s23
  buffer_store_dwordx4 v[28:31], v10, s[4:7], s84 offen sc1
  s_branch Lrd_160
Lx2_161:
  buffer_load_dwordx4 v[56:59], v2, s[4:7], s99 offen offset:0 sc1
  buffer_load_dwordx4 v[60:63], v2, s[4:7], s99 offen offset:1024 sc1
  buffer_load_dwordx4 v[64:67], v2, s[4:7], s99 offen offset:2048 sc1
  buffer_load_dwordx4 v[68:71], v2, s[4:7], s99 offen offset:3072 sc1
  s_waitcnt vmcnt(7)
  v_mfma_f32_16x16x32_bf16 v[28:31], v[20:23], v[72:75], 0
  s_waitcnt vmcnt(6)
  v_mfma_f32_16x16x32_bf16 v[28:31], v[20:23], v[76:79], v[28:31]
  v_bitop3_b32 v12, v72, v76, s23 bitop3:0x7e
  s_waitcnt vmcnt(5)
  v_mfma_f32_16x16x32_bf16 v[28:31], v[24:27], v[80:83], v[28:31]
  s_waitcnt vmcnt(4)
  v_mfma_f32_16x16x32_bf16 v[28:31], v[24:27], v[84:87], v[28:31]
  v_bitop3_b32 v13, v80, v84, s23 bitop3:0x7e
  v_bitop3_b32 v12, v12, v13, 1 bitop3:0xa8
  v_cmp_ne_u32 vcc, 0, v12
  s_cbranch_vccnz Lx2_162
  s_nop 3
  v_and_or_b32 v28, v28, -2, s23
  buffer_store_dwordx4 v[28:31], v10, s[4:7], s84 offen sc1
  s_branch Lrd_160
Lx2_162:
  s_sub_u32 s24, s24, 1
  s_cbranch_scc0 Lr_159
  s_branch Lrec_fail
Lrd_160:
  ds_write_b128 v2, v[28:31] offset:14848
  buffer_store_dwordx4 v[28:31], v10, s[4:7], s88 offen sc1
  s_waitcnt lgkmcnt(0)
  s_barrier
  s_waitcnt vmcnt(2)
  s_branch Lq_advS
Lq_rdS:
  s_add_u32 s88, s84, 163840
  s_barrier
  s_sleep 3
  buffer_load_dwordx4 v[56:59], v20, s[4:7], s84 offen sc1
  buffer_load_dwordx4 v[60:63], v21, s[4:7], s84 offen sc1
  buffer_load_dwordx4 v[64:67], v22, s[4:7], s84 offen sc1
  ds_read_b128 v[28:31], v2 offset:14848
  s_sleep 4
Lh3_163:
  buffer_load_dwordx4 v[68:71], v20, s[4:7], s88 offen sc1
  buffer_load_dwordx4 v[72:75], v21, s[4:7], s88 offen sc1
  buffer_load_dwordx4 v[76:79], v22, s[4:7], s88 offen sc1
  s_waitcnt vmcnt(5) lgkmcnt(0)
  v_pk_add_f32 v[32:33], v[28:29], v[56:57]
  v_pk_add_f32 v[34:35], v[30:31], v[58:59]
  s_waitcnt vmcnt(4)
  v_bitop3_b32 v12, v56, v60, s23 bitop3:0x7e
  v_pk_add_f32 v[32:33], v[32:33], v[60:61]
  v_pk_add_f32 v[34:35], v[34:35], v[62:63]
  s_waitcnt vmcnt(3)
  v_bitop3_b32 v12, v12, v64, s23 bitop3:0xf6
  v_and_b32 v12, 1, v12
  v_cmp_ne_u32 vcc, 0, v12
  v_pk_add_f32 v[32:33], v[32:33], v[64:65]
  v_pk_add_f32 v[34:35], v[34:35], v[66:67]
  v_cvt_pk_bf16_f32 v32, v32, v33
  v_cvt_pk_bf16_f32 v33, v34, v35
  v_min_u32 v32, -2, v32
  s_cbranch_vccnz Lx3_165
  buffer_store_dwordx2 v[32:33], v23, s[4:7], s26 offen sc1
  s_branch Lh3d_164
Lx3_165:
  buffer_load_dwordx4 v[56:59], v20, s[4:7], s84 offen sc1
  buffer_load_dwordx4 v[60:63], v21, s[4:7], s84 offen sc1
  buffer_load_dwordx4 v[64:67], v22, s[4:7], s84 offen sc1
  s_waitcnt vmcnt(5) lgkmcnt(0)
  v_pk_add_f32 v[32:33], v[28:29], v[68:69]
  v_pk_add_f32 v[34:35], v[30:31], v[70:71]
  s_waitcnt vmcnt(4)
  v_bitop3_b32 v12, v68, v72, s23 bitop3:0x7e
  v_pk_add_f32 v[32:33], v[32:33], v[72:73]
  v_pk_add_f32 v[34:35], v[34:35], v[74:75]
  s_waitcnt vmcnt(3)
  v_bitop3_b32 v12, v12, v76, s23 bitop3:0xf6
  v_and_b32 v12, 1, v12
  v_cmp_ne_u32 vcc, 0, v12
  v_pk_add_f32 v[32:33], v[32:33], v[76:77]
  v_pk_add_f32 v[34:35], v[34:35], v[78:79]
  v_cvt_pk_bf16_f32 v32, v32, v33
  v_cvt_pk_bf16_f32 v33, v34, v35
  v_min_u32 v32, -2, v32
  s_cbranch_vccnz Lx3_166
  buffer_store_dwordx2 v[32:33], v23, s[4:7], s26 offen sc1
  s_branch Lh3d_164
Lx3_166:
  s_sub_u32 s24, s24, 1
  s_cbranch_scc0 Lh3_163
  s_branch Lrec_fail
Lh3d_164:
  s_add_u32 s22, s22, 1
  s_xor_b32 s23, s23, 1
  s_mov_b32 s38, s25
  s_mov_b32 s25, s26
  s_mov_b32 s26, s27
  s_mov_b32 s27, s38
  s_mov_b32 s38, s84
  s_mov_b32 s84, s85
  s_mov_b32 s85, s86
  s_mov_b32 s86, s38
  s_barrier
  s_waitcnt vmcnt(1)
  s_branch Lq_b1S
Lq_noredS:
  s_barrier
  s_waitcnt vmcnt(0)
Lq_advS:
  s_add_u32 s22, s22, 1
  s_xor_b32 s23, s23, 1
  s_mov_b32 s38, s25
  s_mov_b32 s25, s26
  s_mov_b32 s26, s27
  s_mov_b32 s27, s38
  s_mov_b32 s38, s84
  s_mov_b32 s84, s85
  s_mov_b32 s85, s86
  s_mov_b32 s86, s38
  s_barrier
  s_branch Lq_loopS
Lrec_v:
  v_bfe_u32 v8, v1, 0, 4
  v_lshlrev_b32 v8, 4, v8
  v_bfe_u32 v15, v1, 4, 2
  v_lshl_add_u32 v8, v15, 11, v8
  v_bfe_u32 v5, v1, 1, 1
  v_lshlrev_b32 v5, 9, v5
  v_bfe_u32 v15, v1, 2, 4
  v_lshl_add_u32 v5, v15, 4, v5
  v_bfe_u32 v15, v1, 0, 1
  v_lshl_add_u32 v5, v15, 3, v5
  v_bfe_u32 v13, v1, 2, 4
  v_lshlrev_b32 v13, 5, v13
  v_bfe_u32 v15, v1, 0, 1
  v_lshl_add_u32 v13, v15, 4, v13
  v_lshrrev_b32 v14, 2, v13
  v_bfe_u32 v9, v1, 3, 1
  v_lshlrev_b32 v9, 11, v9
  v_bfe_u32 v15, v1, 4, 1
  v_lshl_add_u32 v9, v15, 10, v9
  v_bfe_u32 v15, v1, 0, 2
  v_lshl_add_u32 v9, v15, 8, v9
  v_bfe_u32 v15, v1, 3, 1
  v_lshl_add_u32 v9, v15, 7, v9
  v_bfe_u32 v15, v1, 0, 2
  v_lshl_add_u32 v9, v15, 5, v9
  v_bfe_u32 v15, v1, 2, 1
  v_lshl_add_u32 v9, v15, 4, v9
  v_bfe_u32 v15, v1, 5, 1
  v_lshlrev_b32 v15, 6, v15
  v_xor_b32 v9, v9, v15
  v_add_u32 v9, 20480, v9
  s_add_u32 s38, s93, s21
  s_lshl_b32 s38, s38, 13
  s_add_u32 s98, s98, s38
  s_and_b32 s38, s18, 7
  s_lshl_b32 s38, s38, 8
  s_add_u32 s98, s98, s38
  s_cmp_lt_u32 s21, 3
  s_cselect_b32 s36, 1, 0
  s_cmp_eq_u32 s19, 0
  s_cselect_b32 s36, 1, s36
  s_and_b32 s38, s21, 1
  s_lshl_b32 s38, s38, 3
  s_lshr_b32 s39, s21, 1
  s_lshl_b32 s39, s39, 2
  s_add_u32 s38, s38, s39
  v_add_u32 v12, s38, v2
  v_lshrrev_b32 v15, 4, v1
  v_lshlrev_b32 v15, 5, v15
  v_xor_b32 v4, v2, v15
  v_and_b32 v15, 1, v1
  v_cmp_eq_u32 vcc, 0, v15
  v_mov_b32 v1, 0x03020706
  v_mov_b32 v15, 0x05040100
  v_cndmask_b32 v1, v1, v15, vcc
  s_cmp_eq_u32 s21, 0
  s_cselect_b64 vcc, -1, 0
  v_cndmask_b32 v4, v4, v2, vcc
  s_cselect_b32 s101, 0, 128
  s_cselect_b32 s39, 0, 4096
  s_cselect_b32 s40, 0, 768
  s_cmp_eq_u32 s21, 2
  s_cselect_b32 s38, s33, s35
  s_cmp_eq_u32 s21, 3
  s_cselect_b32 s38, s34, s38
  s_lshl_b32 s28, s38, 1
  s_add_u32 s28, s28, s39
  s_add_u32 s28, s28, 18612224
  s_lshr_b32 s38, s38, 14
  s_mul_i32 s39, s16, 6
  s_add_u32 s38, s38, s39
  s_lshl_b32 s38, s38, 7
  s_add_u32 s38, s38, s40
  s_add_u32 s100, s38, 1835008
  s_lshl_b32 s38, s21, 12
  s_add_u32 m0, s38, 16384
  v_mov_b32 v0, 0
  v_mov_b32 v36, 0
  v_mov_b32 v37, 0
  v_mov_b32 v38, 0
  v_mov_b32 v39, 0
  v_mov_b32 v58, 15872
  s_cmp_eq_u32 s20, 0
  s_cbranch_scc0 Lsbx_169
Lsb_167:
  buffer_load_dword v56, off, s[80:83], 0 offset:64 sc1
  s_waitcnt vmcnt(0)
  v_and_b32 v59, 255, v56
  v_cmp_gt_u32 vcc, 97, v59
  s_cbranch_vccz Lsbd_168
  s_sub_u32 s24, s24, 1
  s_cbranch_scc0 Lsb_167
  s_branch Lrec_fail
Lsbd_168:
  ds_write_b32 v58, v56
Lsbx_169:
  s_waitcnt vmcnt(0) lgkmcnt(0)
  s_barrier
  ds_read_b32 v56, v58
  s_waitcnt lgkmcnt(0)
  v_readfirstlane_b32 s38, v56
  s_bfe_u32 s39, s38, 0x10008
  s_lshl_b32 s39, s39, 13
  s_add_u32 s97, s97, s39
  s_cmp_ge_u32 s38, 65536
  v_xor_b32 v10, 32, v9
  v_xor_b32 v11, 128, v9
  v_xor_b32 v15, 160, v9
  ds_read_b64_tr_b16 v[72:73], v9 offset:0
  ds_read_b64_tr_b16 v[74:75], v10 offset:0
  ds_read_b64_tr_b16 v[76:77], v11 offset:0
  ds_read_b64_tr_b16 v[78:79], v15 offset:0
  s_waitcnt lgkmcnt(2)
  v_mfma_f32_16x16x32_bf16 v[56:59], v[72:75], v[160:163], 0
  ds_read_b64_tr_b16 v[36:37], v9 offset:4096
  ds_read_b64_tr_b16 v[38:39], v10 offset:4096
  v_mfma_f32_16x16x32_bf16 v[60:63], v[72:75], v[168:171], 0
  v_mfma_f32_16x16x32_bf16 v[64:67], v[72:75], v[176:179], 0
  v_mfma_f32_16x16x32_bf16 v[68:71], v[72:75], v[184:187], 0
  s_waitcnt lgkmcnt(2)
  v_mfma_f32_16x16x32_bf16 v[56:59], v[76:79], v[164:167], v[56:59]
  ds_read_b64_tr_b16 v[72:73], v11 offset:4096
  ds_read_b64_tr_b16 v[74:75], v15 offset:4096
  v_mfma_f32_16x16x32_bf16 v[60:63], v[76:79], v[172:175], v[60:63]
  v_mfma_f32_16x16x32_bf16 v[64:67], v[76:79], v[180:183], v[64:67]
  v_mfma_f32_16x16x32_bf16 v[68:71], v[76:79], v[188:191], v[68:71]
  s_waitcnt lgkmcnt(2)
  v_mfma_f32_16x16x32_bf16 v[56:59], v[36:39], v[192:195], v[56:59]
  ds_read_b64_tr_b16 v[76:77], v9 offset:8192
  ds_read_b64_tr_b16 v[78:79], v10 offset:8192
  v_mfma_f32_16x16x32_bf16 v[60:63], v[36:39], v[200:203], v[60:63]
  v_mfma_f32_16x16x32_bf16 v[64:67], v[36:39], v[208:211], v[64:67]
  v_mfma_f32_16x16x32_bf16 v[68:71], v[36:39], v[216:219], v[68:71]
  s_waitcnt lgkmcnt(2)
  v_mfma_f32_16x16x32_bf16 v[56:59], v[72:75], v[196:199], v[56:59]
  ds_read_b64_tr_b16 v[36:37], v11 offset:8192
  ds_read_b64_tr_b16 v[38:39], v15 offset:8192
  v_mfma_f32_16x16x32_bf16 v[60:63], v[72:75], v[204:207], v[60:63]
  v_mfma_f32_16x16x32_bf16 v[64:67], v[72:75], v[212:215], v[64:67]
  v_mfma_f32_16x16x32_bf16 v[68:71], v[72:75], v[220:223], v[68:71]
  s_waitcnt lgkmcnt(2)
  v_mfma_f32_16x16x32_bf16 v[56:59], v[76:79], v[224:227], v[56:59]
  ds_read_b64_tr_b16 v[72:73], v9 offset:8
  ds_read_b64_tr_b16 v[74:75], v10 offset:8
  v_mfma_f32_16x16x32_bf16 v[60:63], v[76:79], v[232:235], v[60:63]
  v_mfma_f32_16x16x32_bf16 v[64:67], v[76:79], v[240:243], v[64:67]
  v_mfma_f32_16x16x32_bf16 v[68:71], v[76:79], v[248:251], v[68:71]
  s_waitcnt lgkmcnt(2)
  v_mfma_f32_16x16x32_bf16 v[56:59], v[36:39], v[228:231], v[56:59]
  ds_read_b64_tr_b16 v[76:77], v11 offset:8
  ds_read_b64_tr_b16 v[78:79], v15 offset:8
  v_mfma_f32_16x16x32_bf16 v[60:63], v[36:39], v[236:239], v[60:63]
  v_mfma_f32_16x16x32_bf16 v[64:67], v[36:39], v[244:247], v[64:67]
  v_mfma_f32_16x16x32_bf16 v[68:71], v[36:39], v[252:255], v[68:71]
  s_waitcnt lgkmcnt(2)
  v_mfma_f32_16x16x32_bf16 v[16:19], v[72:75], v[160:163], 0
  ds_read_b64_tr_b16 v[36:37], v9 offset:4104
  ds_read_b64_tr_b16 v[38:39], v10 offset:4104
  v_mfma_f32_16x16x32_bf16 v[20:23], v[72:75], v[168:171], 0
  v_mfma_f32_16x16x32_bf16 v[24:27], v[72:75], v[176:179], 0
  v_mfma_f32_16x16x32_bf16 v[28:31], v[72:75], v[184:187], 0
  s_waitcnt lgkmcnt(2)
  v_mfma_f32_16x16x32_bf16 v[16:19], v[76:79], v[164:167], v[16:19]
  ds_read_b64_tr_b16 v[72:73], v11 offset:4104
  ds_read_b64_tr_b16 v[74:75], v15 offset:4104
  v_cvt_pk_bf16_f32 v40, v56, v57
  v_cvt_pk_bf16_f32 v41, v58, v59
  v_mfma_f32_16x16x32_bf16 v[20:23], v[76:79], v[172:175], v[20:23]
  v_cvt_pk_bf16_f32 v44, v60, v61
  v_cvt_pk_bf16_f32 v45, v62, v63
  v_mfma_f32_16x16x32_bf16 v[24:27], v[76:79], v[180:183], v[24:27]
  v_cvt_pk_bf16_f32 v48, v64, v65
  v_cvt_pk_bf16_f32 v49, v66, v67
  v_mfma_f32_16x16x32_bf16 v[28:31], v[76:79], v[188:191], v[28:31]
  v_cvt_pk_bf16_f32 v52, v68, v69
  v_cvt_pk_bf16_f32 v53, v70, v71
  s_waitcnt lgkmcnt(2)
  v_mfma_f32_16x16x32_bf16 v[16:19], v[36:39], v[192:195], v[16:19]
  ds_read_b64_tr_b16 v[76:77], v9 offset:8200
  ds_read_b64_tr_b16 v[78:79], v10 offset:8200
  v_mfma_f32_16x16x32_bf16 v[20:23], v[36:39], v[200:203], v[20:23]
  v_mfma_f32_16x16x32_bf16 v[24:27], v[36:39], v[208:211], v[24:27]
  v_mfma_f32_16x16x32_bf16 v[28:31], v[36:39], v[216:219], v[28:31]
  s_waitcnt lgkmcnt(2)
  v_mfma_f32_16x16x32_bf16 v[16:19], v[72:75], v[196:199], v[16:19]
  ds_read_b64_tr_b16 v[36:37], v11 offset:8200
  ds_read_b64_tr_b16 v[38:39], v15 offset:8200
  v_mfma_f32_16x16x32_bf16 v[20:23], v[72:75], v[204:207], v[20:23]
  v_mfma_f32_16x16x32_bf16 v[24:27], v[72:75], v[212:215], v[24:27]
  v_mfma_f32_16x16x32_bf16 v[28:31], v[72:75], v[220:223], v[28:31]
  s_waitcnt lgkmcnt(2)
  v_mfma_f32_16x16x32_bf16 v[16:19], v[76:79], v[224:227], v[16:19]
  v_mfma_f32_16x16x32_bf16 v[20:23], v[76:79], v[232:235], v[20:23]
  v_mfma_f32_16x16x32_bf16 v[24:27], v[76:79], v[240:243], v[24:27]
  v_mfma_f32_16x16x32_bf16 v[28:31], v[76:79], v[248:251], v[28:31]
  s_waitcnt lgkmcnt(0)
  v_mfma_f32_16x16x32_bf16 v[16:19], v[36:39], v[228:231], v[16:19]
  v_mfma_f32_16x16x32_bf16 v[20:23], v[36:39], v[236:239], v[20:23]
  v_mfma_f32_16x16x32_bf16 v[24:27], v[36:39], v[244:247], v[24:27]
  v_mfma_f32_16x16x32_bf16 v[28:31], v[36:39], v[252:255], v[28:31]
  s_nop 4
  v_cvt_pk_bf16_f32 v42, v16, v17
  v_cvt_pk_bf16_f32 v43, v18, v19
  v_cvt_pk_bf16_f32 v46, v20, v21
  v_cvt_pk_bf16_f32 v47, v22, v23
  v_cvt_pk_bf16_f32 v50, v24, v25
  v_cvt_pk_bf16_f32 v51, v26, v27
  v_cvt_pk_bf16_f32 v54, v28, v29
  v_cvt_pk_bf16_f32 v55, v30, v31
  v_mov_b32 v32, 0
  v_mov_b32 v33, 0
  v_mov_b32 v34, 0
  v_mov_b32 v35, 0
  v_mov_b32 v36, 0
  v_mov_b32 v37, 0
  v_mov_b32 v38, 0
  v_mov_b32 v39, 0
  s_cbranch_scc1 Lv_b1S
  s_branch Lv_b1F
.p2align 8
.p2align 5
  s_nop 0
  s_nop 0
  s_nop 0
  s_nop 0
  s_nop 0
Lv_loopF:
  s_sleep 2
Lg_170:
  buffer_load_dwordx4 v[56:59], v6, s[4:7], s25 offen sc1
  buffer_load_dwordx4 v[60:63], v6, s[4:7], s25 offen offset:1024 sc1
  s_waitcnt vmcnt(1)
  ds_write_b128 v6, v[56:59] offset:0
  v_max_u32 v64, v56, v58
  s_waitcnt vmcnt(0)
  ds_write_b128 v6, v[60:63] offset:1024
  v_max3_u32 v64, v64, v60, v62
  v_cmp_eq_u32 vcc, -1, v64
  s_cbranch_vccz Lgd_171
  s_mov_b64 exec, vcc
  s_sub_u32 s24, s24, 1
  s_cbranch_scc0 Lg_170
  s_branch Lrec_fail
.p2align 5
  s_nop 0
  s_nop 0
  s_nop 0
Lgd_171:
  s_mov_b64 exec, -1
  s_waitcnt lgkmcnt(0)
Lv_b1F:
  s_setprio 0
  s_barrier
  ds_read_b128 v[56:59], v2 offset:0
  ds_read_b128 v[60:63], v2 offset:1024
  ds_read_b128 v[64:67], v2 offset:2048
  ds_read_b128 v[68:71], v2 offset:3072
  ds_read_b128 v[72:75], v2 offset:4096
  ds_read_b128 v[76:79], v2 offset:5120
  ds_read_b128 v[16:19], v2 offset:6144
  ds_read_b128 v[20:23], v2 offset:7168
  ds_read_b128 v[24:27], v2 offset:8192
  ds_read_b128 v[28:31], v2 offset:9216
  s_add_u32 s39, s22, 2
  s_min_u32 s39, s39, 63
  v_cmp_gt_u32 vcc, s39, v0
  s_cbranch_vccz Lv_ldF
Lkp_172:
  buffer_load_dword v0, off, s[4:7], s100 sc1
  s_waitcnt vmcnt(0)
  v_cmp_gt_u32 vcc, s39, v0
  s_cbranch_vccz Lv_ldF
  s_sub_u32 s24, s24, 1
  s_cbranch_scc0 Lkp_172
  s_branch Lrec_fail
.p2align 5
  s_nop 0
  s_nop 0
  s_nop 0
  s_nop 0
  s_nop 0
  s_nop 0
  s_nop 0
Lv_ldF:
  v_xor_b32 v10, s101, v4
  buffer_load_dwordx4 v4, s[4:7], s28 offen offset:0 sc1 lds
  buffer_load_dwordx4 v4, s[4:7], s28 offen offset:1024 sc1 lds
  buffer_load_dwordx4 v10, s[4:7], s28 offen offset:2048 sc1 lds
  buffer_load_dwordx4 v10, s[4:7], s28 offen offset:3072 sc1 lds
  buffer_load_dword v0, off, s[4:7], s100 sc1
  s_cmp_lt_u32 s22, 61
  s_cselect_b32 s38, 786432, 0
  s_add_u32 s28, s28, s38
  s_waitcnt lgkmcnt(9)
  v_smfmac_f32_16x16x64_bf16 v[36:39], v[56:59], v[80:87], v3
  s_waitcnt lgkmcnt(8)
  v_smfmac_f32_16x16x64_bf16 v[32:35], v[60:63], v[88:95], v3
  s_waitcnt lgkmcnt(7)
  v_smfmac_f32_16x16x64_bf16 v[36:39], v[64:67], v[96:103], v3
  v_mov_b32 v56, 0
  v_mov_b32 v57, 0
  s_waitcnt lgkmcnt(6)
  v_smfmac_f32_16x16x64_bf16 v[32:35], v[68:71], v[104:111], v3
  v_mov_b32 v58, 0
  v_mov_b32 v59, 0
  s_waitcnt lgkmcnt(5)
  v_smfmac_f32_16x16x64_bf16 v[36:39], v[72:75], v[112:119], v3
  v_mov_b32 v60, 0
  v_mov_b32 v61, 0
  s_barrier
  s_waitcnt lgkmcnt(4)
  v_smfmac_f32_16x16x64_bf16 v[32:35], v[76:79], v[120:127], v3
  v_mov_b32 v62, 0
  v_mov_b32 v63, 0
  s_waitcnt lgkmcnt(3)
  v_smfmac_f32_16x16x64_bf16 v[36:39], v[16:19], v[128:135], v3
  v_mov_b32 v64, 0
  v_mov_b32 v65, 0
  s_waitcnt lgkmcnt(2)
  v_smfmac_f32_16x16x64_bf16 v[32:35], v[20:23], v[136:143], v3
  v_mov_b32 v66, 0
  v_mov_b32 v67, 0
  s_waitcnt lgkmcnt(1)
  v_smfmac_f32_16x16x64_bf16 v[36:39], v[24:27], v[144:151], v3
  v_mov_b32 v68, 0
  v_mov_b32 v69, 0
  s_waitcnt lgkmcnt(0)
  v_smfmac_f32_16x16x64_bf16 v[32:35], v[28:31], v[152:159], v3
  v_mov_b32 v70, 0
  v_mov_b32 v71, 0
  s_setprio 2
  s_nop 0
  v_add_f32 v16, v36, v38
  v_add_f32 v17, v37, v39
  s_nop 1
  v_add_f32 v16, v16, v32
  v_add_f32 v17, v17, v33
  v_add_f32 v16, v16, v34
  v_add_f32 v17, v17, v35
  v_cvt_pk_bf16_f32 v16, v16, v17
  ds_write_b32 v12, v16 offset:13824
  s_nop 0
  v_mov_b32_dpp v17, v16 quad_perm:[1,0,3,2] row_mask:0xf bank_mask:0xf
  v_perm_b32 v17, v17, v16, v1
  ds_write_b32 v7, v17 offset:32768
  v_and_or_b32 v17, v17, -2, s23
  buffer_store_dword v17, v7, s[4:7], s35 offen offset:2048
  s_cmp_eq_u32 s22, 63
  s_cselect_b32 s38, 0, s36
  s_cmp_eq_u32 s38, 0
  s_waitcnt lgkmcnt(0)
  s_barrier
  s_cbranch_scc1 Lv_idleF
  s_setprio 1
  ds_read_b64 v[32:33], v5 offset:32768
  ds_read_b64 v[34:35], v5 offset:33024
  v_mov_b32 v22, 0
  v_mov_b32 v23, 0
  v_mov_b32 v24, 0
  v_mov_b32 v25, 0
  v_mov_b32 v26, 0
  v_mov_b32 v27, 0
  v_mov_b32 v28, 0
  v_mov_b32 v29, 0
  v_mov_b32 v30, 0
  v_mov_b32 v31, 0
  s_waitcnt lgkmcnt(0)
  v_smfmac_f32_16x16x64_bf16 v[56:59], v[32:35], v[160:167], v3
  v_smfmac_f32_16x16x64_bf16 v[60:63], v[32:35], v[168:175], v3
  v_smfmac_f32_16x16x64_bf16 v[64:67], v[32:35], v[176:183], v3
  v_smfmac_f32_16x16x64_bf16 v[68:71], v[32:35], v[184:191], v3
  s_barrier
  ds_read_b64 v[72:73], v5 offset:33792
  ds_read_b64 v[74:75], v5 offset:34048
  ds_read_b64 v[76:77], v5 offset:34816
  ds_read_b64 v[78:79], v5 offset:35072
  s_waitcnt lgkmcnt(2)
  v_smfmac_f32_16x16x64_bf16 v[56:59], v[72:75], v[192:199], v3
  v_smfmac_f32_16x16x64_bf16 v[64:67], v[72:75], v[208:215], v3
  v_smfmac_f32_16x16x64_bf16 v[60:63], v[72:75], v[200:207], v3
  v_smfmac_f32_16x16x64_bf16 v[68:71], v[72:75], v[216:223], v3
  s_waitcnt lgkmcnt(0)
  v_smfmac_f32_16x16x64_bf16 v[56:59], v[76:79], v[224:231], v3
  v_smfmac_f32_16x16x64_bf16 v[64:67], v[76:79], v[240:247], v3
  v_smfmac_f32_16x16x64_bf16 v[60:63], v[76:79], v[232:239], v3
  v_smfmac_f32_16x16x64_bf16 v[68:71], v[76:79], v[248:255], v3
  s_mov_b64 exec, s[42:43]
  s_waitcnt vmcnt(0)
  s_barrier
  ds_read_b128 v[22:25], v13 offset:35840
  ds_read_b32 v30, v14 offset:36352
  s_mov_b64 exec, s[44:45]
  ds_read_b128 v[26:29], v13 offset:35840
  ds_read_b32 v31, v14 offset:36352
  s_mov_b64 exec, -1
  s_setprio 3
  v_add_f32 v56, v56, v58
  v_add_f32 v57, v57, v59
  v_cvt_pk_bf16_f32 v36, v56, v57
  v_add_f32 v64, v64, v66
  v_add_f32 v65, v65, v67
  v_cvt_pk_bf16_f32 v37, v64, v65
  v_add_f32 v60, v60, v62
  v_add_f32 v61, v61, v63
  v_cvt_pk_bf16_f32 v38, v60, v61
  v_add_f32 v68, v68, v70
  v_add_f32 v69, v69, v71
  v_cvt_pk_bf16_f32 v39, v68, v69
  s_waitcnt lgkmcnt(3)
  v_mfma_f32_16x16x32_bf16 v[40:43], v[40:43], v[22:25], 0
  v_mfma_f32_16x16x32_bf16 v[44:47], v[44:47], v[22:25], 0
  s_waitcnt lgkmcnt(0)
  v_mfma_f32_16x16x32_bf16 v[40:43], v[48:51], v[26:29], v[40:43]
  v_mfma_f32_16x16x32_bf16 v[44:47], v[52:55], v[26:29], v[44:47]
  v_mfma_f32_16x16x16_bf16 v[40:43], v[36:37], v[30:31], v[40:43]
  v_mfma_f32_16x16x16_bf16 v[44:47], v[38:39], v[30:31], v[44:47]
  s_nop 6
  v_cvt_pk_bf16_f32 v32, v40, v41
  v_cvt_pk_bf16_f32 v33, v42, v43
  v_and_or_b32 v32, v32, -2, s23
  v_cvt_pk_bf16_f32 v34, v44, v45
  v_cvt_pk_bf16_f32 v35, v46, v47
  buffer_store_dwordx4 v[32:35], v8, s[4:7], s98 offen
  s_setprio 0
  v_xor_b32 v10, 32, v9
  v_xor_b32 v11, 128, v9
  v_xor_b32 v15, 160, v9
  ds_read_b64_tr_b16 v[72:73], v9 offset:0
  ds_read_b64_tr_b16 v[74:75], v10 offset:0
  ds_read_b64_tr_b16 v[76:77], v11 offset:0
  ds_read_b64_tr_b16 v[78:79], v15 offset:0
  s_waitcnt lgkmcnt(2)
  v_mfma_f32_16x16x32_bf16 v[56:59], v[72:75], v[160:163], 0
  ds_read_b64_tr_b16 v[36:37], v9 offset:4096
  ds_read_b64_tr_b16 v[38:39], v10 offset:4096
  v_mfma_f32_16x16x32_bf16 v[60:63], v[72:75], v[168:171], 0
  v_mfma_f32_16x16x32_bf16 v[64:67], v[72:75], v[176:179], 0
  v_mfma_f32_16x16x32_bf16 v[68:71], v[72:75], v[184:187], 0
  s_waitcnt lgkmcnt(2)
  v_mfma_f32_16x16x32_bf16 v[56:59], v[76:79], v[164:167], v[56:59]
  ds_read_b64_tr_b16 v[72:73], v11 offset:4096
  ds_read_b64_tr_b16 v[74:75], v15 offset:4096
  v_mfma_f32_16x16x32_bf16 v[60:63], v[76:79], v[172:175], v[60:63]
  v_mfma_f32_16x16x32_bf16 v[64:67], v[76:79], v[180:183], v[64:67]
  v_mfma_f32_16x16x32_bf16 v[68:71], v[76:79], v[188:191], v[68:71]
  s_waitcnt lgkmcnt(2)
  v_mfma_f32_16x16x32_bf16 v[56:59], v[36:39], v[192:195], v[56:59]
  ds_read_b64_tr_b16 v[76:77], v9 offset:8192
  ds_read_b64_tr_b16 v[78:79], v10 offset:8192
  v_mfma_f32_16x16x32_bf16 v[60:63], v[36:39], v[200:203], v[60:63]
  v_mfma_f32_16x16x32_bf16 v[64:67], v[36:39], v[208:211], v[64:67]
  v_mfma_f32_16x16x32_bf16 v[68:71], v[36:39], v[216:219], v[68:71]
  s_waitcnt lgkmcnt(2)
  v_mfma_f32_16x16x32_bf16 v[56:59], v[72:75], v[196:199], v[56:59]
  ds_read_b64_tr_b16 v[36:37], v11 offset:8192
  ds_read_b64_tr_b16 v[38:39], v15 offset:8192
  v_mfma_f32_16x16x32_bf16 v[60:63], v[72:75], v[204:207], v[60:63]
  v_mfma_f32_16x16x32_bf16 v[64:67], v[72:75], v[212:215], v[64:67]
  v_mfma_f32_16x16x32_bf16 v[68:71], v[72:75], v[220:223], v[68:71]
  s_barrier
  s_waitcnt lgkmcnt(2)
  v_mfma_f32_16x16x32_bf16 v[56:59], v[76:79], v[224:227], v[56:59]
  ds_read_b64_tr_b16 v[72:73], v9 offset:8
  ds_read_b64_tr_b16 v[74:75], v10 offset:8
  v_mfma_f32_16x16x32_bf16 v[60:63], v[76:79], v[232:235], v[60:63]
  v_mfma_f32_16x16x32_bf16 v[64:67], v[76:79], v[240:243], v[64:67]
  v_mfma_f32_16x16x32_bf16 v[68:71], v[76:79], v[248:251], v[68:71]
  s_waitcnt lgkmcnt(2)
  v_mfma_f32_16x16x32_bf16 v[56:59], v[36:39], v[228:231], v[56:59]
  ds_read_b64_tr_b16 v[76:77], v11 offset:8
  ds_read_b64_tr_b16 v[78:79], v15 offset:8
  v_mfma_f32_16x16x32_bf16 v[60:63], v[36:39], v[236:239], v[60:63]
  v_mfma_f32_16x16x32_bf16 v[64:67], v[36:39], v[244:247], v[64:67]
  v_mfma_f32_16x16x32_bf16 v[68:71], v[36:39], v[252:255], v[68:71]
  s_waitcnt lgkmcnt(2)
  v_mfma_f32_16x16x32_bf16 v[16:19], v[72:75], v[160:163], 0
  ds_read_b64_tr_b16 v[36:37], v9 offset:4104
  ds_read_b64_tr_b16 v[38:39], v10 offset:4104
  v_mfma_f32_16x16x32_bf16 v[20:23], v[72:75], v[168:171], 0
  v_mfma_f32_16x16x32_bf16 v[24:27], v[72:75], v[176:179], 0
  v_mfma_f32_16x16x32_bf16 v[28:31], v[72:75], v[184:187], 0
  s_waitcnt lgkmcnt(2)
  v_mfma_f32_16x16x32_bf16 v[16:19], v[76:79], v[164:167], v[16:19]
  ds_read_b64_tr_b16 v[72:73], v11 offset:4104
  ds_read_b64_tr_b16 v[74:75], v15 offset:4104
  v_cvt_pk_bf16_f32 v40, v56, v57
  v_cvt_pk_bf16_f32 v41, v58, v59
  v_mfma_f32_16x16x32_bf16 v[20:23], v[76:79], v[172:175], v[20:23]
  v_cvt_pk_bf16_f32 v44, v60, v61
  v_cvt_pk_bf16_f32 v45, v62, v63
  v_mfma_f32_16x16x32_bf16 v[24:27], v[76:79], v[180:183], v[24:27]
  v_cvt_pk_bf16_f32 v48, v64, v65
  v_cvt_pk_bf16_f32 v49, v66, v67
  v_mfma_f32_16x16x32_bf16 v[28:31], v[76:79], v[188:191], v[28:31]
  v_cvt_pk_bf16_f32 v52, v68, v69
  v_cvt_pk_bf16_f32 v53, v70, v71
  s_waitcnt lgkmcnt(2)
  v_mfma_f32_16x16x32_bf16 v[16:19], v[36:39], v[192:195], v[16:19]
  ds_read_b64_tr_b16 v[76:77], v9 offset:8200
  ds_read_b64_tr_b16 v[78:79], v10 offset:8200
  v_mfma_f32_16x16x32_bf16 v[20:23], v[36:39], v[200:203], v[20:23]
  v_mfma_f32_16x16x32_bf16 v[24:27], v[36:39], v[208:211], v[24:27]
  v_mfma_f32_16x16x32_bf16 v[28:31], v[36:39], v[216:219], v[28:31]
  s_waitcnt lgkmcnt(2)
  v_mfma_f32_16x16x32_bf16 v[16:19], v[72:75], v[196:199], v[16:19]
  ds_read_b64_tr_b16 v[36:37], v11 offset:8200
  ds_read_b64_tr_b16 v[38:39], v15 offset:8200
  v_mfma_f32_16x16x32_bf16 v[20:23], v[72:75], v[204:207], v[20:23]
  v_mfma_f32_16x16x32_bf16 v[24:27], v[72:75], v[212:215], v[24:27]
  v_mfma_f32_16x16x32_bf16 v[28:31], v[72:75], v[220:223], v[28:31]
  s_waitcnt lgkmcnt(2)
  v_mfma_f32_16x16x32_bf16 v[16:19], v[76:79], v[224:227], v[16:19]
  v_mfma_f32_16x16x32_bf16 v[20:23], v[76:79], v[232:235], v[20:23]
  v_mfma_f32_16x16x32_bf16 v[24:27], v[76:79], v[240:243], v[24:27]
  v_mfma_f32_16x16x32_bf16 v[28:31], v[76:79], v[248:251], v[28:31]
  s_waitcnt lgkmcnt(0)
  v_mfma_f32_16x16x32_bf16 v[16:19], v[36:39], v[228:231], v[16:19]
  v_mfma_f32_16x16x32_bf16 v[20:23], v[36:39], v[236:239], v[20:23]
  v_mfma_f32_16x16x32_bf16 v[24:27], v[36:39], v[244:247], v[24:27]
  v_mfma_f32_16x16x32_bf16 v[28:31], v[36:39], v[252:255], v[28:31]
  s_nop 4
  v_cvt_pk_bf16_f32 v42, v16, v17
  v_cvt_pk_bf16_f32 v43, v18, v19
  v_cvt_pk_bf16_f32 v46, v20, v21
  v_cvt_pk_bf16_f32 v47, v22, v23
  v_cvt_pk_bf16_f32 v50, v24, v25
  v_cvt_pk_bf16_f32 v51, v26, v27
  v_cvt_pk_bf16_f32 v54, v28, v29
  v_cvt_pk_bf16_f32 v55, v30, v31
  v_mov_b32 v32, 0
  v_mov_b32 v33, 0
  v_mov_b32 v34, 0
  v_mov_b32 v35, 0
  v_mov_b32 v36, 0
  v_mov_b32 v37, 0
  v_mov_b32 v38, 0
  v_mov_b32 v39, 0
  s_branch Lv_advF
.p2align 5
  s_nop 0
  s_nop 0
  s_nop 0
  s_nop 0
Lv_idleF:
  s_cmp_eq_u32 s22, 63
  s_cbranch_scc1 Lrec_done
  s_barrier
  s_waitcnt vmcnt(0)
  s_barrier
  v_mov_b32 v32, 0
  v_mov_b32 v33, 0
  v_mov_b32 v34, 0
  v_mov_b32 v35, 0
  v_mov_b32 v36, 0
  v_mov_b32 v37, 0
  v_mov_b32 v38, 0
  v_mov_b32 v39, 0
  s_barrier
Lv_advF:
  s_setprio 2
  s_add_u32 s22, s22, 1
  s_xor_b32 s23, s23, 1
  s_mov_b32 s38, s25
  s_mov_b32 s25, s26
  s_mov_b32 s26, s27
  s_mov_b32 s27, s38
  s_mov_b32 s38, s84
  s_mov_b32 s84, s85
  s_mov_b32 s85, s86
  s_mov_b32 s86, s38
  s_barrier
  s_branch Lv_loopF
Lv_loopS:
  s_sleep 2
Lg_173:
  buffer_load_dwordx4 v[56:59], v6, s[4:7], s25 offen sc1
  buffer_load_dwordx4 v[60:63], v6, s[4:7], s25 offen offset:1024 sc1
  s_waitcnt vmcnt(1)
  ds_write_b128 v6, v[56:59] offset:0
  v_max_u32 v64, v56, v58
  s_waitcnt vmcnt(0)
  ds_write_b128 v6, v[60:63] offset:1024
  v_max3_u32 v64, v64, v60, v62
  v_cmp_eq_u32 vcc, -1, v64
  s_cbranch_vccz Lgd_174
  s_mov_b64 exec, vcc
  s_sub_u32 s24, s24, 1
  s_cbranch_scc0 Lg_173
  s_branch Lrec_fail
Lgd_174:
  s_mov_b64 exec, -1
  s_waitcnt lgkmcnt(0)
Lv_b1S:
  s_setprio 0
  s_barrier
  ds_read_b128 v[56:59], v2 offset:0
  ds_read_b128 v[60:63], v2 offset:1024
  ds_read_b128 v[64:67], v2 offset:2048
  ds_read_b128 v[68:71], v2 offset:3072
  ds_read_b128 v[72:75], v2 offset:4096
  ds_read_b128 v[76:79], v2 offset:5120
  ds_read_b128 v[16:19], v2 offset:6144
  ds_read_b128 v[20:23], v2 offset:7168
  ds_read_b128 v[24:27], v2 offset:8192
  ds_read_b128 v[28:31], v2 offset:9216
  s_add_u32 s39, s22, 2
  s_min_u32 s39, s39, 63
  v_cmp_gt_u32 vcc, s39, v0
  s_cbranch_vccz Lv_ldS
Lkp_175:
  buffer_load_dword v0, off, s[4:7], s100 sc1
  s_waitcnt vmcnt(0)
  v_cmp_gt_u32 vcc, s39, v0
  s_cbranch_vccz Lv_ldS
  s_sub_u32 s24, s24, 1
  s_cbranch_scc0 Lkp_175
  s_branch Lrec_fail
Lv_ldS:
  v_xor_b32 v10, s101, v4
  buffer_load_dwordx4 v4, s[4:7], s28 offen offset:0 sc1 lds
  buffer_load_dwordx4 v4, s[4:7], s28 offen offset:1024 sc1 lds
  buffer_load_dwordx4 v10, s[4:7], s28 offen offset:2048 sc1 lds
  buffer_load_dwordx4 v10, s[4:7], s28 offen offset:3072 sc1 lds
  buffer_load_dword v0, off, s[4:7], s100 sc1
  s_cmp_lt_u32 s22, 61
  s_cselect_b32 s38, 786432, 0
  s_add_u32 s28, s28, s38
  s_waitcnt lgkmcnt(9)
  v_smfmac_f32_16x16x64_bf16 v[36:39], v[56:59], v[80:87], v3
  s_waitcnt lgkmcnt(8)
  v_smfmac_f32_16x16x64_bf16 v[32:35], v[60:63], v[88:95], v3
  s_waitcnt lgkmcnt(7)
  v_smfmac_f32_16x16x64_bf16 v[36:39], v[64:67], v[96:103], v3
  v_mov_b32 v56, 0
  v_mov_b32 v57, 0
  s_waitcnt lgkmcnt(6)
  v_smfmac_f32_16x16x64_bf16 v[32:35], v[68:71], v[104:111], v3
  v_mov_b32 v58, 0
  v_mov_b32 v59, 0
  s_waitcnt lgkmcnt(5)
  v_smfmac_f32_16x16x64_bf16 v[36:39], v[72:75], v[112:119], v3
  v_mov_b32 v60, 0
  v_mov_b32 v61, 0
  s_barrier
  s_waitcnt lgkmcnt(4)
  v_smfmac_f32_16x16x64_bf16 v[32:35], v[76:79], v[120:127], v3
  v_mov_b32 v62, 0
  v_mov_b32 v63, 0
  s_waitcnt lgkmcnt(3)
  v_smfmac_f32_16x16x64_bf16 v[36:39], v[16:19], v[128:135], v3
  v_mov_b32 v64, 0
  v_mov_b32 v65, 0
  s_waitcnt lgkmcnt(2)
  v_smfmac_f32_16x16x64_bf16 v[32:35], v[20:23], v[136:143], v3
  v_mov_b32 v66, 0
  v_mov_b32 v67, 0
  s_waitcnt lgkmcnt(1)
  v_smfmac_f32_16x16x64_bf16 v[36:39], v[24:27], v[144:151], v3
  v_mov_b32 v68, 0
  v_mov_b32 v69, 0
  s_waitcnt lgkmcnt(0)
  v_smfmac_f32_16x16x64_bf16 v[32:35], v[28:31], v[152:159], v3
  v_mov_b32 v70, 0
  v_mov_b32 v71, 0
  s_setprio 2
  s_nop 0
  v_add_f32 v16, v36, v38
  v_add_f32 v17, v37, v39
  s_nop 1
  v_add_f32 v16, v16, v32
  v_add_f32 v17, v17, v33
  v_add_f32 v16, v16, v34
  v_add_f32 v17, v17, v35
  v_cvt_pk_bf16_f32 v16, v16, v17
  ds_write_b32 v12, v16 offset:13824
  s_nop 0
  v_mov_b32_dpp v17, v16 quad_perm:[1,0,3,2] row_mask:0xf bank_mask:0xf
  v_perm_b32 v17, v17, v16, v1
  ds_write_b32 v7, v17 offset:32768
  v_and_or_b32 v17, v17, -2, s23
  buffer_store_dword v17, v7, s[4:7], s35 offen offset:2048 sc1
  s_cmp_eq_u32 s22, 63
  s_cselect_b32 s38, 0, s36
  s_cmp_eq_u32 s38, 0
  s_waitcnt lgkmcnt(0)
  s_barrier
  s_cbranch_scc1 Lv_idleS
  s_setprio 1
  ds_read_b64 v[32:33], v5 offset:32768
  ds_read_b64 v[34:35], v5 offset:33024
  v_mov_b32 v22, 0
  v_mov_b32 v23, 0
  v_mov_b32 v24, 0
  v_mov_b32 v25, 0
  v_mov_b32 v26, 0
  v_mov_b32 v27, 0
  v_mov_b32 v28, 0
  v_mov_b32 v29, 0
  v_mov_b32 v30, 0
  v_mov_b32 v31, 0
  s_waitcnt lgkmcnt(0)
  v_smfmac_f32_16x16x64_bf16 v[56:59], v[32:35], v[160:167], v3
  v_smfmac_f32_16x16x64_bf16 v[60:63], v[32:35], v[168:175], v3
  v_smfmac_f32_16x16x64_bf16 v[64:67], v[32:35], v[176:183], v3
  v_smfmac_f32_16x16x64_bf16 v[68:71], v[32:35], v[184:191], v3
  s_barrier
  ds_read_b64 v[72:73], v5 offset:33792
  ds_read_b64 v[74:75], v5 offset:34048
  ds_read_b64 v[76:77], v5 offset:34816
  ds_read_b64 v[78:79], v5 offset:35072
  s_waitcnt lgkmcnt(2)
  v_smfmac_f32_16x16x64_bf16 v[56:59], v[72:75], v[192:199], v3
  v_smfmac_f32_16x16x64_bf16 v[64:67], v[72:75], v[208:215], v3
  v_smfmac_f32_16x16x64_bf16 v[60:63], v[72:75], v[200:207], v3
  v_smfmac_f32_16x16x64_bf16 v[68:71], v[72:75], v[216:223], v3
  s_waitcnt lgkmcnt(0)
  v_smfmac_f32_16x16x64_bf16 v[56:59], v[76:79], v[224:231], v3
  v_smfmac_f32_16x16x64_bf16 v[64:67], v[76:79], v[240:247], v3
  v_smfmac_f32_16x16x64_bf16 v[60:63], v[76:79], v[232:239], v3
  v_smfmac_f32_16x16x64_bf16 v[68:71], v[76:79], v[248:255], v3
  s_mov_b64 exec, s[42:43]
  s_waitcnt vmcnt(0)
  s_barrier
  ds_read_b128 v[22:25], v13 offset:35840
  ds_read_b32 v30, v14 offset:36352
  s_mov_b64 exec, s[44:45]
  ds_read_b128 v[26:29], v13 offset:35840
  ds_read_b32 v31, v14 offset:36352
  s_mov_b64 exec, -1
  s_setprio 3
  v_add_f32 v56, v56, v58
  v_add_f32 v57, v57, v59
  v_cvt_pk_bf16_f32 v36, v56, v57
  v_add_f32 v64, v64, v66
  v_add_f32 v65, v65, v67
  v_cvt_pk_bf16_f32 v37, v64, v65
  v_add_f32 v60, v60, v62
  v_add_f32 v61, v61, v63
  v_cvt_pk_bf16_f32 v38, v60, v61
  v_add_f32 v68, v68, v70
  v_add_f32 v69, v69, v71
  v_cvt_pk_bf16_f32 v39, v68, v69
  s_waitcnt lgkmcnt(3)
  v_mfma_f32_16x16x32_bf16 v[40:43], v[40:43], v[22:25], 0
  v_mfma_f32_16x16x32_bf16 v[44:47], v[44:47], v[22:25], 0
  s_waitcnt lgkmcnt(0)
  v_mfma_f32_16x16x32_bf16 v[40:43], v[48:51], v[26:29], v[40:43]
  v_mfma_f32_16x16x32_bf16 v[44:47], v[52:55], v[26:29], v[44:47]
  v_mfma_f32_16x16x16_bf16 v[40:43], v[36:37], v[30:31], v[40:43]
  v_mfma_f32_16x16x16_bf16 v[44:47], v[38:39], v[30:31], v[44:47]
  s_nop 6
  v_cvt_pk_bf16_f32 v32, v40, v41
  v_cvt_pk_bf16_f32 v33, v42, v43
  v_and_or_b32 v32, v32, -2, s23
  v_cvt_pk_bf16_f32 v34, v44, v45
  v_cvt_pk_bf16_f32 v35, v46, v47
  buffer_store_dwordx4 v[32:35], v8, s[4:7], s98 offen sc1
  s_setprio 0
  v_xor_b32 v10, 32, v9
  v_xor_b32 v11, 128, v9
  v_xor_b32 v15, 160, v9
  ds_read_b64_tr_b16 v[72:73], v9 offset:0
  ds_read_b64_tr_b16 v[74:75], v10 offset:0
  ds_read_b64_tr_b16 v[76:77], v11 offset:0
  ds_read_b64_tr_b16 v[78:79], v15 offset:0
  s_waitcnt lgkmcnt(2)
  v_mfma_f32_16x16x32_bf16 v[56:59], v[72:75], v[160:163], 0
  ds_read_b64_tr_b16 v[36:37], v9 offset:4096
  ds_read_b64_tr_b16 v[38:39], v10 offset:4096
  v_mfma_f32_16x16x32_bf16 v[60:63], v[72:75], v[168:171], 0
  v_mfma_f32_16x16x32_bf16 v[64:67], v[72:75], v[176:179], 0
  v_mfma_f32_16x16x32_bf16 v[68:71], v[72:75], v[184:187], 0
  s_waitcnt lgkmcnt(2)
  v_mfma_f32_16x16x32_bf16 v[56:59], v[76:79], v[164:167], v[56:59]
  ds_read_b64_tr_b16 v[72:73], v11 offset:4096
  ds_read_b64_tr_b16 v[74:75], v15 offset:4096
  v_mfma_f32_16x16x32_bf16 v[60:63], v[76:79], v[172:175], v[60:63]
  v_mfma_f32_16x16x32_bf16 v[64:67], v[76:79], v[180:183], v[64:67]
  v_mfma_f32_16x16x32_bf16 v[68:71], v[76:79], v[188:191], v[68:71]
  s_waitcnt lgkmcnt(2)
  v_mfma_f32_16x16x32_bf16 v[56:59], v[36:39], v[192:195], v[56:59]
  ds_read_b64_tr_b16 v[76:77], v9 offset:8192
  ds_read_b64_tr_b16 v[78:79], v10 offset:8192
  v_mfma_f32_16x16x32_bf16 v[60:63], v[36:39], v[200:203], v[60:63]
  v_mfma_f32_16x16x32_bf16 v[64:67], v[36:39], v[208:211], v[64:67]
  v_mfma_f32_16x16x32_bf16 v[68:71], v[36:39], v[216:219], v[68:71]
  s_waitcnt lgkmcnt(2)
  v_mfma_f32_16x16x32_bf16 v[56:59], v[72:75], v[196:199], v[56:59]
  ds_read_b64_tr_b16 v[36:37], v11 offset:8192
  ds_read_b64_tr_b16 v[38:39], v15 offset:8192
  v_mfma_f32_16x16x32_bf16 v[60:63], v[72:75], v[204:207], v[60:63]
  v_mfma_f32_16x16x32_bf16 v[64:67], v[72:75], v[212:215], v[64:67]
  v_mfma_f32_16x16x32_bf16 v[68:71], v[72:75], v[220:223], v[68:71]
  s_barrier
  s_waitcnt lgkmcnt(2)
  v_mfma_f32_16x16x32_bf16 v[56:59], v[76:79], v[224:227], v[56:59]
  ds_read_b64_tr_b16 v[72:73], v9 offset:8
  ds_read_b64_tr_b16 v[74:75], v10 offset:8
  v_mfma_f32_16x16x32_bf16 v[60:63], v[76:79], v[232:235], v[60:63]
  v_mfma_f32_16x16x32_bf16 v[64:67], v[76:79], v[240:243], v[64:67]
  v_mfma_f32_16x16x32_bf16 v[68:71], v[76:79], v[248:251], v[68:71]
  s_waitcnt lgkmcnt(2)
  v_mfma_f32_16x16x32_bf16 v[56:59], v[36:39], v[228:231], v[56:59]
  ds_read_b64_tr_b16 v[76:77], v11 offset:8
  ds_read_b64_tr_b16 v[78:79], v15 offset:8
  v_mfma_f32_16x16x32_bf16 v[60:63], v[36:39], v[236:239], v[60:63]
  v_mfma_f32_16x16x32_bf16 v[64:67], v[36:39], v[244:247], v[64:67]
  v_mfma_f32_16x16x32_bf16 v[68:71], v[36:39], v[252:255], v[68:71]
  s_waitcnt lgkmcnt(2)
  v_mfma_f32_16x16x32_bf16 v[16:19], v[72:75], v[160:163], 0
  ds_read_b64_tr_b16 v[36:37], v9 offset:4104
  ds_read_b64_tr_b16 v[38:39], v10 offset:4104
  v_mfma_f32_16x16x32_bf16 v[20:23], v[72:75], v[168:171], 0
  v_mfma_f32_16x16x32_bf16 v[24:27], v[72:75], v[176:179], 0
  v_mfma_f32_16x16x32_bf16 v[28:31], v[72:75], v[184:187], 0
  s_waitcnt lgkmcnt(2)
  v_mfma_f32_16x16x32_bf16 v[16:19], v[76:79], v[164:167], v[16:19]
  ds_read_b64_tr_b16 v[72:73], v11 offset:4104
  ds_read_b64_tr_b16 v[74:75], v15 offset:4104
  v_cvt_pk_bf16_f32 v40, v56, v57
  v_cvt_pk_bf16_f32 v41, v58, v59
  v_mfma_f32_16x16x32_bf16 v[20:23], v[76:79], v[172:175], v[20:23]
  v_cvt_pk_bf16_f32 v44, v60, v61
  v_cvt_pk_bf16_f32 v45, v62, v63
  v_mfma_f32_16x16x32_bf16 v[24:27], v[76:79], v[180:183], v[24:27]
  v_cvt_pk_bf16_f32 v48, v64, v65
  v_cvt_pk_bf16_f32 v49, v66, v67
  v_mfma_f32_16x16x32_bf16 v[28:31], v[76:79], v[188:191], v[28:31]
  v_cvt_pk_bf16_f32 v52, v68, v69
  v_cvt_pk_bf16_f32 v53, v70, v71
  s_waitcnt lgkmcnt(2)
  v_mfma_f32_16x16x32_bf16 v[16:19], v[36:39], v[192:195], v[16:19]
  ds_read_b64_tr_b16 v[76:77], v9 offset:8200
  ds_read_b64_tr_b16 v[78:79], v10 offset:8200
  v_mfma_f32_16x16x32_bf16 v[20:23], v[36:39], v[200:203], v[20:23]
  v_mfma_f32_16x16x32_bf16 v[24:27], v[36:39], v[208:211], v[24:27]
  v_mfma_f32_16x16x32_bf16 v[28:31], v[36:39], v[216:219], v[28:31]
  s_waitcnt lgkmcnt(2)
  v_mfma_f32_16x16x32_bf16 v[16:19], v[72:75], v[196:199], v[16:19]
  ds_read_b64_tr_b16 v[36:37], v11 offset:8200
  ds_read_b64_tr_b16 v[38:39], v15 offset:8200
  v_mfma_f32_16x16x32_bf16 v[20:23], v[72:75], v[204:207], v[20:23]
  v_mfma_f32_16x16x32_bf16 v[24:27], v[72:75], v[212:215], v[24:27]
  v_mfma_f32_16x16x32_bf16 v[28:31], v[72:75], v[220:223], v[28:31]
  s_waitcnt lgkmcnt(2)
  v_mfma_f32_16x16x32_bf16 v[16:19], v[76:79], v[224:227], v[16:19]
  v_mfma_f32_16x16x32_bf16 v[20:23], v[76:79], v[232:235], v[20:23]
  v_mfma_f32_16x16x32_bf16 v[24:27], v[76:79], v[240:243], v[24:27]
  v_mfma_f32_16x16x32_bf16 v[28:31], v[76:79], v[248:251], v[28:31]
  s_waitcnt lgkmcnt(0)
  v_mfma_f32_16x16x32_bf16 v[16:19], v[36:39], v[228:231], v[16:19]
  v_mfma_f32_16x16x32_bf16 v[20:23], v[36:39], v[236:239], v[20:23]
  v_mfma_f32_16x16x32_bf16 v[24:27], v[36:39], v[244:247], v[24:27]
  v_mfma_f32_16x16x32_bf16 v[28:31], v[36:39], v[252:255], v[28:31]
  s_nop 4
  v_cvt_pk_bf16_f32 v42, v16, v17
  v_cvt_pk_bf16_f32 v43, v18, v19
  v_cvt_pk_bf16_f32 v46, v20, v21
  v_cvt_pk_bf16_f32 v47, v22, v23
  v_cvt_pk_bf16_f32 v50, v24, v25
  v_cvt_pk_bf16_f32 v51, v26, v27
  v_cvt_pk_bf16_f32 v54, v28, v29
  v_cvt_pk_bf16_f32 v55, v30, v31
  v_mov_b32 v32, 0
  v_mov_b32 v33, 0
  v_mov_b32 v34, 0
  v_mov_b32 v35, 0
  v_mov_b32 v36, 0
  v_mov_b32 v37, 0
  v_mov_b32 v38, 0
  v_mov_b32 v39, 0
  s_branch Lv_advS
Lv_idleS:
  s_cmp_eq_u32 s22, 63
  s_cbranch_scc1 Lrec_done
  s_barrier
  s_waitcnt vmcnt(0)
  s_barrier
  v_mov_b32 v32, 0
  v_mov_b32 v33, 0
  v_mov_b32 v34, 0
  v_mov_b32 v35, 0
  v_mov_b32 v36, 0
  v_mov_b32 v37, 0
  v_mov_b32 v38, 0
  v_mov_b32 v39, 0
  s_barrier
Lv_advS:
  s_setprio 2
  s_add_u32 s22, s22, 1
  s_xor_b32 s23, s23, 1
  s_mov_b32 s38, s25
  s_mov_b32 s25, s26
  s_mov_b32 s26, s27
  s_mov_b32 s27, s38
  s_mov_b32 s38, s84
  s_mov_b32 s84, s85
  s_mov_b32 s85, s86
  s_mov_b32 s86, s38
  s_barrier
  s_branch Lv_loopS
Lrec_fail:
  s_mov_b32 s24, -1
Lrec_done:
  s_waitcnt vmcnt(0)
  s_endpgm

.section .rodata,"a"
.p2align 6
.amdhsa_kernel parallel_sum__memory_aug_recurrent_mem_tr__glu_gated_bilinear__prompt_kernel
  .amdhsa_next_free_vgpr 256
  .amdhsa_next_free_sgpr 102
  .amdhsa_accum_offset 256
  .amdhsa_group_segment_fixed_size 0
  .amdhsa_kernarg_size 112
  .amdhsa_user_sgpr_count 2
  .amdhsa_user_sgpr_kernarg_segment_ptr 1
  .amdhsa_system_sgpr_workgroup_id_x 1
.end_amdhsa_kernel
```
